```python
import torch

def _softmax(x, axis=-1):
    return torch.softmax(x, dim=axis)

def _gelu(x):
    return torch.nn.functional.gelu(x, approximate='tanh')

def _silu(x):
    return torch.nn.functional.silu(x)

def _sigmoid(x):
    return torch.sigmoid(x)

def _layernorm(x, axis=-1, eps=1e-05):
    m = x.mean(dim=axis, keepdim=True)
    v = x.var(dim=axis, keepdim=True, unbiased=False)
    return (x - m) / torch.sqrt(v + eps)

def _scatter_add(tgt, idx, src, axis=0):
    return tgt.clone().index_add_(axis, idx, src)

def _segment_sum(src, seg, n):
    out = torch.zeros((n,) + src.shape[1:], dtype=src.dtype)
    return out.index_add_(0, seg, src)

def _pad(x, pw):
    flat = tuple((v for pair in reversed(pw) for v in pair))
    return torch.nn.functional.pad(x, flat)
kernel_name = 'gated_mix__sliding_block__memory_aug_recurrent_mem_tr__prompt'

def setup_inputs():

    _w = lambda a: (lambda t: t.to(torch.bfloat16) if t.is_floating_point() else t)(torch.as_tensor(a))

    def _A_setup():
        B, S, D = (1, 2048, 512)
        return {'x': _w((lambda *s: torch.randn(*s, dtype=torch.bfloat16) * 0.05)(B, S, D)), 'wqkv': _w((lambda *s: torch.randn(*s, dtype=torch.bfloat16) * 1.6)(D, 3 * D)), 'wo': _w((lambda *s: torch.randn(*s, dtype=torch.bfloat16) * 0.05)(D, D))}
    _A_in = _A_setup()

    def _B_setup():
        B, S, Dm = (1, 2048, 512)
        H, Dh = (32, 128)
        M, seg = (8, 32)
        seg = min(seg, S)
        S = S // seg * seg
        return {'x': _w((lambda *s: torch.randn(*s, dtype=torch.bfloat16) * 0.05)(B, S, Dm)), 'mem0': _w((lambda *s: torch.randn(*s, dtype=torch.bfloat16) * 1.6)(B, M, Dm)), 'Wq': _w((lambda *s: torch.randn(*s, dtype=torch.bfloat16) * 0.8)(Dm, H, Dh) * Dm ** (-0.5)), 'Wk': _w((lambda *s: torch.randn(*s, dtype=torch.bfloat16) * 0.8)(Dm, H, Dh) * Dm ** (-0.5)), 'Wv': _w((lambda *s: torch.randn(*s, dtype=torch.bfloat16) * 1.6)(Dm, H, Dh) * Dm ** (-0.5)), 'Wo': _w((lambda *s: torch.randn(*s, dtype=torch.bfloat16) * 1.6)(H, Dh, Dm) * (H * Dh) ** (-0.5)), 'seg_len': seg}
    _B_in = _B_setup()
    return {'A_x': _A_in['x'], 'A_wqkv': _A_in['wqkv'], 'A_wo': _A_in['wo'], 'B_x': _B_in['x'], 'B_mem0': _B_in['mem0'], 'B_Wq': _B_in['Wq'], 'B_Wk': _B_in['Wk'], 'B_Wv': _B_in['Wv'], 'B_Wo': _B_in['Wo'], 'B_seg_len': _B_in['seg_len'], 'gate_w': _w((lambda *s: torch.randn(*s, dtype=torch.bfloat16) * 0.05)(512) * 16.0)}

def reference(A_x, A_wqkv, A_wo, B_x, B_mem0, B_Wq, B_Wk, B_Wv, B_Wo, B_seg_len, gate_w):

    def _A_ref(x, wqkv, wo):
        B, S, D = x.shape
        H = 32
        Dh = D // H
        W = 256
        qkv = (lambda x, *d: x.permute(*d))((x @ wqkv).reshape(B, S, 3, H, Dh), 2, 0, 3, 1, 4)
        q, k, v = (qkv[0], qkv[1], qkv[2])
        scores = torch.einsum('bhqd,bhkd->bhqk', q, k) * Dh ** (-0.5)
        idx = torch.arange(S)
        mask = (idx[:, None] - idx[None, :] >= 0) & (idx[:, None] - idx[None, :] < W)
        scores = torch.where(mask[None, None], scores, -1000000000.0)
        p = _softmax(scores, axis=-1)
        o = torch.einsum('bhqk,bhkd->bhqd', p, v)
        return (lambda x, *d: x.permute(*d))(o, 0, 2, 1, 3).reshape(B, S, D) @ wo

    def _B_ref(x, mem0, Wq, Wk, Wv, Wo, seg_len):
        B, S, Dm = x.shape
        H, Dh = (Wq.shape[1], Wq.shape[2])
        M = mem0.shape[1]
        scale = Dh ** (-0.5)
        n_seg = S // seg_len
        L = M + seg_len
        idx = torch.arange(L)
        mask = (idx[:, None] < M) | (idx[:, None] >= idx[None, :])
        mem = mem0
        outs = []
        for s in range(n_seg):
            xs = x[:, s * seg_len:(s + 1) * seg_len, :].clone()
            h = torch.concatenate([mem, xs], axis=1)
            q = torch.einsum('btd,dhe->bhte', h, Wq)
            k = torch.einsum('btd,dhe->bhte', h, Wk)
            v = torch.einsum('btd,dhe->bhte', h, Wv)
            scores = torch.einsum('bhqe,bhke->bhqk', q, k) * scale
            scores = torch.where(mask[None, None], scores, -1000000000.0)
            p = _softmax(scores, axis=-1)
            o = torch.einsum('bhqk,bhke->bhqe', p, v)
            o = torch.einsum('bhte,hed->btd', o, Wo)
            mem = o[:, :M, :].clone()
            outs.append(o[:, M:, :])
        return torch.concatenate(outs, axis=1)
    x = A_x
    g = _sigmoid((x * gate_w).sum(-1, keepdims=True))
    a = _A_ref(x, A_wqkv, A_wo)
    b = _B_ref(x, B_mem0, B_Wq, B_Wk, B_Wv, B_Wo, B_seg_len)
    return g * a + (1 - g) * b
```

```asm
; @launch grid=(256,1,1) block=(256,1,1) lds=163840
.amdgcn_target "amdgcn-amd-amdhsa--gfx950"
.text
.globl gated_mix__sliding_block__memory_aug_recurrent_mem_tr__prompt_kernel
.p2align 8
.type gated_mix__sliding_block__memory_aug_recurrent_mem_tr__prompt_kernel,@function
gated_mix__sliding_block__memory_aug_recurrent_mem_tr__prompt_kernel:
    s_cmp_ge_u32 s2, 256
    s_cbranch_scc1 L_end
    s_load_dwordx4 s[4:7], s[0:1], 0
    s_load_dwordx2 s[8:9], s[0:1], 16
    s_load_dwordx2 s[10:11], s[0:1], 32
    s_load_dwordx8 s[12:19], s[0:1], 40
    s_load_dwordx8 s[20:27], s[0:1], 80
    v_lshrrev_b32 v1, 6, v0
    s_getreg_b32 s78, hwreg(HW_REG_XCC_ID)
    v_readfirstlane_b32 s48, v1
    s_and_b32 s78, s78, 15
    s_waitcnt lgkmcnt(0)
    s_mov_b32 s28, s26
    s_and_b32 s29, s27, 0xffff
    s_mov_b32 s30, 0x10000000
    s_mov_b32 s31, 0x00020000
    s_mov_b32 s36, s4
    s_and_b32 s37, s5, 0xffff
    s_mov_b32 s38, 0x200000
    s_mov_b32 s39, 0x00020000
    s_mov_b32 s40, s24
    s_and_b32 s41, s25, 0xffff
    s_mov_b32 s42, 0x100
    s_mov_b32 s43, 0x00020000
    s_mov_b32 s44, s22
    s_and_b32 s45, s23, 0xffff
    s_mov_b32 s46, 0x200000
    s_mov_b32 s47, 0x00020000
    s_mov_b32 s79, 0x40000
    s_mov_b32 s51, -1
    s_mov_b32 s71, 0
    s_cmp_lg_u32 s78, 0
    s_cbranch_scc1 L_wentry
    s_lshr_b32 s49, s2, 3
    s_and_b32 s49, s49, 31
L_claim:
    s_cmp_eq_u32 s48, 0
    s_cselect_b32 s62, 1, 0
    s_mov_b32 s63, 0
    v_mbcnt_lo_u32_b32 v16, -1, 0
    v_mbcnt_hi_u32_b32 v16, -1, v16
    v_lshrrev_b32 v17, 4, v16
    v_bfe_u32 v18, v16, 2, 2
    v_and_b32 v19, 3, v16
    s_and_b32 s52, s48, 1
    s_lshl_b32 s52, s52, 2
    v_and_b32 v26, 15, v16
    v_xor_b32 v26, s52, v26
    v_lshlrev_b32 v26, 4, v26
    v_lshl_add_u32 v20, v17, 13, v26
    s_lshl_b32 s53, s48, 15
    s_lshl_b32 s54, s49, 8
    s_add_u32 s53, s53, s54
    v_add_u32 v20, s53, v20
    s_and_b32 s52, s48, 1
    s_lshl_b32 s52, s52, 2
    v_xor_b32 v21, s52, v16
    v_xor_b32 v22, 8, v21
    s_lshl_b32 s53, s48, 10
    s_lshl_b32 s54, s49, 17
    s_add_u32 s53, s53, s54
    v_lshl_add_u32 v21, v21, 4, s53
    v_lshl_add_u32 v22, v22, 4, s53
    s_lshl_b32 s70, s48, 10
    s_mov_b32 s32, s18
    s_and_b32 s33, s19, 0xffff
    s_mov_b32 s34, 0x400000
    s_mov_b32 s35, 0x00020000
    s_add_u32 m0, s70, 0
    s_mov_b32 s53, 0
    buffer_load_dwordx4 v21, s[32:35], s53 offen lds
    s_add_u32 m0, s70, 4096
    s_mov_b32 s53, 4096
    buffer_load_dwordx4 v22, s[32:35], s53 offen lds
    s_add_u32 m0, s70, 8192
    s_mov_b32 s53, 8192
    buffer_load_dwordx4 v21, s[32:35], s53 offen lds
    s_add_u32 m0, s70, 12288
    s_mov_b32 s53, 12288
    buffer_load_dwordx4 v22, s[32:35], s53 offen lds
    s_add_u32 m0, s70, 16384
    s_mov_b32 s53, 16384
    buffer_load_dwordx4 v21, s[32:35], s53 offen lds
    s_add_u32 m0, s70, 20480
    s_mov_b32 s53, 20480
    buffer_load_dwordx4 v22, s[32:35], s53 offen lds
    s_add_u32 m0, s70, 24576
    s_mov_b32 s53, 24576
    buffer_load_dwordx4 v21, s[32:35], s53 offen lds
    s_add_u32 m0, s70, 28672
    s_mov_b32 s53, 28672
    buffer_load_dwordx4 v22, s[32:35], s53 offen lds
    s_add_u32 m0, s70, 32768
    s_mov_b32 s53, 32768
    buffer_load_dwordx4 v21, s[32:35], s53 offen lds
    s_add_u32 m0, s70, 36864
    s_mov_b32 s53, 36864
    buffer_load_dwordx4 v22, s[32:35], s53 offen lds
    s_add_u32 m0, s70, 40960
    s_mov_b32 s53, 40960
    buffer_load_dwordx4 v21, s[32:35], s53 offen lds
    s_add_u32 m0, s70, 45056
    s_mov_b32 s53, 45056
    buffer_load_dwordx4 v22, s[32:35], s53 offen lds
    s_add_u32 m0, s70, 49152
    s_mov_b32 s53, 49152
    buffer_load_dwordx4 v21, s[32:35], s53 offen lds
    s_add_u32 m0, s70, 53248
    s_mov_b32 s53, 53248
    buffer_load_dwordx4 v22, s[32:35], s53 offen lds
    s_add_u32 m0, s70, 57344
    s_mov_b32 s53, 57344
    buffer_load_dwordx4 v21, s[32:35], s53 offen lds
    s_add_u32 m0, s70, 61440
    s_mov_b32 s53, 61440
    buffer_load_dwordx4 v22, s[32:35], s53 offen lds
    s_add_u32 m0, s70, 65536
    s_mov_b32 s53, 65536
    buffer_load_dwordx4 v21, s[32:35], s53 offen lds
    s_add_u32 m0, s70, 69632
    s_mov_b32 s53, 69632
    buffer_load_dwordx4 v22, s[32:35], s53 offen lds
    s_add_u32 m0, s70, 73728
    s_mov_b32 s53, 73728
    buffer_load_dwordx4 v21, s[32:35], s53 offen lds
    s_add_u32 m0, s70, 77824
    s_mov_b32 s53, 77824
    buffer_load_dwordx4 v22, s[32:35], s53 offen lds
    s_add_u32 m0, s70, 81920
    s_mov_b32 s53, 81920
    buffer_load_dwordx4 v21, s[32:35], s53 offen lds
    s_add_u32 m0, s70, 86016
    s_mov_b32 s53, 86016
    buffer_load_dwordx4 v22, s[32:35], s53 offen lds
    s_add_u32 m0, s70, 90112
    s_mov_b32 s53, 90112
    buffer_load_dwordx4 v21, s[32:35], s53 offen lds
    s_add_u32 m0, s70, 94208
    s_mov_b32 s53, 94208
    buffer_load_dwordx4 v22, s[32:35], s53 offen lds
    s_add_u32 m0, s70, 98304
    s_mov_b32 s53, 98304
    buffer_load_dwordx4 v21, s[32:35], s53 offen lds
    s_add_u32 m0, s70, 102400
    s_mov_b32 s53, 102400
    buffer_load_dwordx4 v22, s[32:35], s53 offen lds
    s_add_u32 m0, s70, 106496
    s_mov_b32 s53, 106496
    buffer_load_dwordx4 v21, s[32:35], s53 offen lds
    s_add_u32 m0, s70, 110592
    s_mov_b32 s53, 110592
    buffer_load_dwordx4 v22, s[32:35], s53 offen lds
    s_add_u32 m0, s70, 114688
    s_mov_b32 s53, 114688
    buffer_load_dwordx4 v21, s[32:35], s53 offen lds
    s_add_u32 m0, s70, 118784
    s_mov_b32 s53, 118784
    buffer_load_dwordx4 v22, s[32:35], s53 offen lds
    s_add_u32 m0, s70, 122880
    s_mov_b32 s53, 122880
    buffer_load_dwordx4 v21, s[32:35], s53 offen lds
    s_add_u32 m0, s70, 126976
    s_mov_b32 s53, 126976
    buffer_load_dwordx4 v22, s[32:35], s53 offen lds
    v_mbcnt_lo_u32_b32 v0, -1, 0
    v_mbcnt_hi_u32_b32 v0, -1, v0
    s_lshl_b32 s52, s48, 6
    v_add_u32 v0, s52, v0
    v_and_b32 v40, 63, v0
    v_lshlrev_b32 v44, 4, v40
    v_lshlrev_b32 v41, 4, v0
    v_add_u32 v2, 147456, v41
    v_add_u32 v1, 131072, v44
    s_lshl_b32 s52, s48, 11
    v_add_u32 v7, s52, v44
    v_add_u32 v8, 0x10000, v7
    v_lshrrev_b32 v41, 4, v40
    v_and_b32 v42, 15, v40
    v_mul_u32_u24 v3, 272, v41
    v_lshl_add_u32 v3, v42, 2, v3
    s_mul_i32 s52, s48, 1088
    s_add_u32 s52, s52, 155648
    v_add_u32 v3, s52, v3
    v_lshrrev_b32 v43, 2, v42
    v_mul_u32_u24 v5, 272, v43
    v_and_b32 v43, 3, v42
    v_lshl_add_u32 v5, v43, 6, v5
    v_lshl_add_u32 v5, v41, 4, v5
    v_add_u32 v5, 155648, v5
    v_and_b32 v43, 2, v42
    v_lshlrev_b32 v43, 6, v43
    v_sub_u32 v4, v5, v43
    s_mul_i32 s52, s48, 1088
    s_add_u32 s52, s52, 128
    v_add_u32 v4, s52, v4
    v_lshrrev_b32 v43, 2, v42
    v_lshlrev_b32 v6, 6, v43
    v_and_b32 v43, 1, v42
    v_lshl_add_u32 v6, v43, 4, v6
    v_lshrrev_b32 v43, 1, v41
    v_lshl_add_u32 v6, v43, 8, v6
    v_and_b32 v43, 1, v41
    v_lshl_add_u32 v6, v43, 5, v6
    v_xor_b32 v44, 32, v6
    v_add_u32 v44, 162304, v44
    s_lshl_b32 s52, s48, 9
    s_add_u32 s52, s52, 160256
    v_add_u32 v6, s52, v6
    v_and_b32 v43, 2, v42
    v_cmp_ne_u32 vcc, 0, v43
    s_nop 1
    v_cndmask_b32 v6, v6, v44, vcc
    v_and_b32 v43, 3, v42
    v_lshlrev_b32 v9, 4, v43
    v_mul_u32_u24 v43, 2048, v41
    v_add_u32 v9, v43, v9
    v_lshrrev_b32 v43, 2, v42
    v_mul_u32_u24 v43, 8192, v43
    v_add_u32 v9, v43, v9
    s_lshr_b32 s53, s49, 4
    s_xor_b32 s54, s53, 0
    s_mul_i32 s54, s54, 32768
    s_mul_i32 s55, s48, 65536
    s_add_u32 s54, s54, s55
    s_lshl_b32 s55, s49, 6
    s_add_u32 s54, s54, s55
    s_add_u32 s60, s54, 3145728
    s_xor_b32 s54, s53, 1
    s_mul_i32 s54, s54, 32768
    s_mul_i32 s55, s48, 65536
    s_add_u32 s54, s54, s55
    s_lshl_b32 s55, s49, 6
    s_add_u32 s54, s54, s55
    s_add_u32 s61, s54, 3145728
    s_bfe_u32 s53, s49, 0x10002
    s_xor_b32 s54, s53, 0
    s_lshl_b32 s54, s54, 10
    s_mul_i32 s55, s49, 8192
    s_add_u32 s54, s54, s55
    s_mul_i32 s55, s48, 2048
    s_add_u32 s54, s54, s55
    s_add_u32 s64, s54, 3014656
    s_xor_b32 s54, s53, 1
    s_lshl_b32 s54, s54, 10
    s_mul_i32 s55, s49, 8192
    s_add_u32 s54, s54, s55
    s_mul_i32 s55, s48, 2048
    s_add_u32 s54, s54, s55
    s_add_u32 s65, s54, 3014656
    v_bfe_u32 v43, v42, 1, 2
    v_lshlrev_b32 v11, 4, v43
    v_and_b32 v43, 1, v41
    v_lshl_add_u32 v11, v43, 3, v11
    v_lshrrev_b32 v43, 1, v41
    v_lshl_add_u32 v11, v43, 2, v11
    s_lshl_b32 s52, s48, 6
    s_lshl_b32 s53, s49, 8
    s_add_u32 s52, s52, s53
    s_add_u32 s52, s52, 589824
    v_add_u32 v11, s52, v11
    s_mov_b32 s74, 0x00550055
    s_mov_b32 s75, 0x00550055
    s_mov_b32 s56, 0x3e0293ee
    v_and_b32 v41, 2, v40
    v_mov_b32 v42, 0xeeee
    v_cmp_eq_u32 vcc, 2, v41
    v_mov_b32 v0, 0x4444
    s_nop 0
    v_cndmask_b32 v0, v0, v42, vcc
    s_mov_b32 s94, 0x3f803f80
    s_mov_b32 s76, 0x3e0293ee
    s_mov_b32 s77, 0x3e0293ee
    s_mov_b32 s95, 0x3f803f80
    s_xor_b32 s88, s48, 1
    s_lshl_b32 s88, s88, 10
    s_xor_b32 s89, s48, 2
    s_lshl_b32 s89, s89, 10
    s_xor_b32 s90, s48, 3
    s_lshl_b32 s90, s90, 10
    s_mov_b32 s80, 0x3030303
    s_mov_b32 s81, 0x3030303
    s_mov_b32 s82, 0xc0c0c0c
    s_mov_b32 s83, 0xc0c0c0c
    s_mov_b32 s84, 0x30303030
    s_mov_b32 s85, 0x30303030
    s_mov_b32 s86, 0xc0c0c0c0
    s_mov_b32 s87, 0xc0c0c0c0
    s_mov_b32 s36, s10
    s_and_b32 s37, s11, 0xffff
    s_mov_b32 s38, 0x2000
    s_mov_b32 s39, 0x00020000
    v_subrev_u32 v40, 147456, v2
    v_lshrrev_b32 v40, 4, v40
    v_bfe_u32 v41, v40, 2, 2
    v_lshlrev_b32 v41, 11, v41
    v_and_b32 v42, 1, v40
    v_lshl_add_u32 v41, v42, 10, v41
    v_lshrrev_b32 v42, 6, v40
    v_lshl_add_u32 v41, v42, 7, v41
    v_bfe_u32 v42, v40, 1, 1
    v_lshl_add_u32 v41, v42, 6, v41
    v_bfe_u32 v42, v40, 4, 2
    v_lshl_add_u32 v41, v42, 4, v41
    buffer_load_dwordx4 v[112:115], v41, s[36:39], 0 offen
    buffer_load_dwordx4 v[116:119], v41, s[36:39], 0 offen offset:512
    v_lshrrev_b32 v26, 1, v17
    v_lshlrev_b32 v23, 3, v26
    v_lshlrev_b32 v24, 1, v26
    v_and_b32 v26, 1, v17
    v_lshl_add_u32 v23, v26, 1, v23
    v_lshrrev_b32 v26, 1, v18
    v_lshl_add_u32 v23, v26, 5, v23
    v_and_b32 v26, 1, v18
    v_lshl_add_u32 v23, v26, 2, v23
    v_or_b32 v24, v24, v26
    v_lshlrev_b32 v23, 8, v23
    v_xor_b32 v26, s48, v18
    v_lshlrev_b32 v26, 6, v26
    v_add_u32 v24, v23, v26
    v_lshl_add_u32 v23, v19, 4, v24
    v_lshl_add_u32 v24, v19, 3, v24
    v_and_b32 v26, 1, v17
    v_lshlrev_b32 v25, 4, v26
    v_lshrrev_b32 v26, 1, v17
    v_lshl_add_u32 v25, v26, 3, v25
    v_lshrrev_b32 v26, 1, v18
    v_lshl_add_u32 v25, v26, 2, v25
    v_and_b32 v26, 1, v18
    v_add_u32 v25, v25, v26
    v_lshlrev_b32 v25, 10, v25
    v_lshl_add_u32 v25, v19, 4, v25
    s_lshl_b32 s52, s48, 8
    v_add_u32 v25, s52, v25
    s_lshr_b32 s53, s49, 4
    s_lshl_b32 s53, s53, 1
    s_xor_b32 s54, s53, 0
    v_xor_b32 v26, s54, v18
    v_lshl_add_u32 v28, v26, 6, v25
    s_xor_b32 s54, s53, 1
    v_xor_b32 v26, s54, v18
    v_lshl_add_u32 v29, v26, 6, v25
    s_xor_b32 s54, s53, 2
    v_xor_b32 v26, s54, v18
    v_lshl_add_u32 v30, v26, 6, v25
    s_xor_b32 s54, s53, 3
    v_xor_b32 v26, s54, v18
    v_lshl_add_u32 v31, v26, 6, v25
    s_waitcnt vmcnt(26)
    s_barrier
    ds_read_b64_tr_b16 v[168:169], v28 offset:0
    ds_read_b64_tr_b16 v[170:171], v28 offset:2048
    ds_read_b64_tr_b16 v[32:33], v28 offset:8
    ds_read_b64_tr_b16 v[34:35], v28 offset:2056
    ds_read_b64_tr_b16 v[40:41], v29 offset:0
    ds_read_b64_tr_b16 v[42:43], v29 offset:2048
    ds_read_b64_tr_b16 v[192:193], v29 offset:8
    ds_read_b64_tr_b16 v[194:195], v29 offset:2056
    s_waitcnt lgkmcnt(0)
    ds_read_b64_tr_b16 v[208:209], v30 offset:0
    ds_read_b64_tr_b16 v[210:211], v30 offset:2048
    ds_read_b64_tr_b16 v[216:217], v30 offset:8
    ds_read_b64_tr_b16 v[218:219], v30 offset:2056
    ds_read_b64_tr_b16 v[232:233], v31 offset:0
    ds_read_b64_tr_b16 v[234:235], v31 offset:2048
    ds_read_b64_tr_b16 v[48:49], v31 offset:8
    ds_read_b64_tr_b16 v[50:51], v31 offset:2056
    s_waitcnt lgkmcnt(0)
    s_barrier
    s_mov_b32 s32, s16
    s_and_b32 s33, s17, 0xffff
    s_mov_b32 s34, 0x400000
    s_mov_b32 s35, 0x00020000
    s_add_u32 m0, s70, 0
    s_mov_b32 s53, 0
    buffer_load_dwordx4 v20, s[32:35], s53 offen lds
    s_add_u32 m0, s70, 4096
    s_mov_b32 s53, 131072
    buffer_load_dwordx4 v20, s[32:35], s53 offen lds
    s_add_u32 m0, s70, 8192
    s_mov_b32 s53, 262144
    v_xor_b32 v20, 128, v20
    buffer_load_dwordx4 v20, s[32:35], s53 offen lds
    s_add_u32 m0, s70, 12288
    s_mov_b32 s53, 393216
    buffer_load_dwordx4 v20, s[32:35], s53 offen lds
    v_xor_b32 v20, 128, v20
    s_add_u32 m0, s70, 16384
    s_mov_b32 s53, 524288
    buffer_load_dwordx4 v20, s[32:35], s53 offen lds
    s_add_u32 m0, s70, 20480
    s_mov_b32 s53, 655360
    buffer_load_dwordx4 v20, s[32:35], s53 offen lds
    s_add_u32 m0, s70, 24576
    s_mov_b32 s53, 786432
    v_xor_b32 v20, 128, v20
    buffer_load_dwordx4 v20, s[32:35], s53 offen lds
    s_add_u32 m0, s70, 28672
    s_mov_b32 s53, 917504
    buffer_load_dwordx4 v20, s[32:35], s53 offen lds
    v_xor_b32 v20, 128, v20
    s_waitcnt vmcnt(26)
    s_barrier
    ds_read_b64_tr_b16 v[172:173], v28 offset:32768
    ds_read_b64_tr_b16 v[174:175], v28 offset:34816
    ds_read_b64_tr_b16 v[36:37], v28 offset:32776
    ds_read_b64_tr_b16 v[38:39], v28 offset:34824
    ds_read_b64_tr_b16 v[44:45], v29 offset:32768
    ds_read_b64_tr_b16 v[46:47], v29 offset:34816
    ds_read_b64_tr_b16 v[196:197], v29 offset:32776
    ds_read_b64_tr_b16 v[198:199], v29 offset:34824
    s_waitcnt lgkmcnt(0)
    ds_read_b64_tr_b16 v[212:213], v30 offset:32768
    ds_read_b64_tr_b16 v[214:215], v30 offset:34816
    ds_read_b64_tr_b16 v[220:221], v30 offset:32776
    ds_read_b64_tr_b16 v[222:223], v30 offset:34824
    ds_read_b64_tr_b16 v[236:237], v31 offset:32768
    ds_read_b64_tr_b16 v[238:239], v31 offset:34816
    ds_read_b64_tr_b16 v[52:53], v31 offset:32776
    ds_read_b64_tr_b16 v[54:55], v31 offset:34824
    s_waitcnt lgkmcnt(0)
    s_barrier
    s_add_u32 m0, s70, 32768
    s_mov_b32 s53, 1048576
    buffer_load_dwordx4 v20, s[32:35], s53 offen lds
    s_add_u32 m0, s70, 36864
    s_mov_b32 s53, 1179648
    buffer_load_dwordx4 v20, s[32:35], s53 offen lds
    s_add_u32 m0, s70, 40960
    s_mov_b32 s53, 1310720
    v_xor_b32 v20, 128, v20
    buffer_load_dwordx4 v20, s[32:35], s53 offen lds
    s_add_u32 m0, s70, 45056
    s_mov_b32 s53, 1441792
    buffer_load_dwordx4 v20, s[32:35], s53 offen lds
    v_xor_b32 v20, 128, v20
    s_add_u32 m0, s70, 49152
    s_mov_b32 s53, 1572864
    buffer_load_dwordx4 v20, s[32:35], s53 offen lds
    s_add_u32 m0, s70, 53248
    s_mov_b32 s53, 1703936
    buffer_load_dwordx4 v20, s[32:35], s53 offen lds
    s_add_u32 m0, s70, 57344
    s_mov_b32 s53, 1835008
    v_xor_b32 v20, 128, v20
    buffer_load_dwordx4 v20, s[32:35], s53 offen lds
    s_add_u32 m0, s70, 61440
    s_mov_b32 s53, 1966080
    buffer_load_dwordx4 v20, s[32:35], s53 offen lds
    v_xor_b32 v20, 128, v20
    s_waitcnt vmcnt(26)
    s_barrier
    v_add_u32 v28, 0x10000, v28
    ds_read_b64_tr_b16 v[176:177], v28 offset:0
    ds_read_b64_tr_b16 v[178:179], v28 offset:2048
    ds_read_b64_tr_b16 v[184:185], v28 offset:8
    ds_read_b64_tr_b16 v[186:187], v28 offset:2056
    v_add_u32 v29, 0x10000, v29
    ds_read_b64_tr_b16 v[200:201], v29 offset:0
    ds_read_b64_tr_b16 v[202:203], v29 offset:2048
    ds_read_b64_tr_b16 v[56:57], v29 offset:8
    ds_read_b64_tr_b16 v[58:59], v29 offset:2056
    s_waitcnt lgkmcnt(0)
    v_add_u32 v30, 0x10000, v30
    ds_read_b64_tr_b16 v[64:65], v30 offset:0
    ds_read_b64_tr_b16 v[66:67], v30 offset:2048
    ds_read_b64_tr_b16 v[224:225], v30 offset:8
    ds_read_b64_tr_b16 v[226:227], v30 offset:2056
    v_add_u32 v31, 0x10000, v31
    ds_read_b64_tr_b16 v[240:241], v31 offset:0
    ds_read_b64_tr_b16 v[242:243], v31 offset:2048
    ds_read_b64_tr_b16 v[248:249], v31 offset:8
    ds_read_b64_tr_b16 v[250:251], v31 offset:2056
    s_waitcnt lgkmcnt(0)
    s_barrier
    s_add_u32 m0, s70, 65536
    s_mov_b32 s53, 2097152
    buffer_load_dwordx4 v20, s[32:35], s53 offen lds
    s_add_u32 m0, s70, 69632
    s_mov_b32 s53, 2228224
    buffer_load_dwordx4 v20, s[32:35], s53 offen lds
    s_add_u32 m0, s70, 73728
    s_mov_b32 s53, 2359296
    v_xor_b32 v20, 128, v20
    buffer_load_dwordx4 v20, s[32:35], s53 offen lds
    s_add_u32 m0, s70, 77824
    s_mov_b32 s53, 2490368
    buffer_load_dwordx4 v20, s[32:35], s53 offen lds
    v_xor_b32 v20, 128, v20
    s_add_u32 m0, s70, 81920
    s_mov_b32 s53, 2621440
    buffer_load_dwordx4 v20, s[32:35], s53 offen lds
    s_add_u32 m0, s70, 86016
    s_mov_b32 s53, 2752512
    buffer_load_dwordx4 v20, s[32:35], s53 offen lds
    s_add_u32 m0, s70, 90112
    s_mov_b32 s53, 2883584
    v_xor_b32 v20, 128, v20
    buffer_load_dwordx4 v20, s[32:35], s53 offen lds
    s_add_u32 m0, s70, 94208
    s_mov_b32 s53, 3014656
    buffer_load_dwordx4 v20, s[32:35], s53 offen lds
    v_xor_b32 v20, 128, v20
    s_waitcnt vmcnt(26)
    s_barrier
    s_lshl_b32 s55, 1, s49
    v_mov_b32 v27, s55
    v_mov_b32 v12, 0
    s_mov_b64 exec, s[62:63]
    buffer_atomic_or v27, v12, s[40:43], 0 offen sc0
    s_mov_b64 exec, -1
    ds_read_b64_tr_b16 v[180:181], v28 offset:32768
    ds_read_b64_tr_b16 v[182:183], v28 offset:34816
    ds_read_b64_tr_b16 v[188:189], v28 offset:32776
    ds_read_b64_tr_b16 v[190:191], v28 offset:34824
    ds_read_b64_tr_b16 v[204:205], v29 offset:32768
    ds_read_b64_tr_b16 v[206:207], v29 offset:34816
    ds_read_b64_tr_b16 v[60:61], v29 offset:32776
    ds_read_b64_tr_b16 v[62:63], v29 offset:34824
    s_waitcnt lgkmcnt(0)
    ds_read_b64_tr_b16 v[68:69], v30 offset:32768
    ds_read_b64_tr_b16 v[70:71], v30 offset:34816
    ds_read_b64_tr_b16 v[228:229], v30 offset:32776
    ds_read_b64_tr_b16 v[230:231], v30 offset:34824
    ds_read_b64_tr_b16 v[244:245], v31 offset:32768
    ds_read_b64_tr_b16 v[246:247], v31 offset:34816
    ds_read_b64_tr_b16 v[252:253], v31 offset:32776
    ds_read_b64_tr_b16 v[254:255], v31 offset:34824
    s_waitcnt lgkmcnt(0)
    s_barrier
    s_add_u32 m0, s70, 98304
    s_mov_b32 s53, 3145728
    buffer_load_dwordx4 v20, s[32:35], s53 offen lds
    s_add_u32 m0, s70, 102400
    s_mov_b32 s53, 3276800
    buffer_load_dwordx4 v20, s[32:35], s53 offen lds
    s_add_u32 m0, s70, 106496
    s_mov_b32 s53, 3407872
    v_xor_b32 v20, 128, v20
    buffer_load_dwordx4 v20, s[32:35], s53 offen lds
    s_add_u32 m0, s70, 110592
    s_mov_b32 s53, 3538944
    buffer_load_dwordx4 v20, s[32:35], s53 offen lds
    v_xor_b32 v20, 128, v20
    s_add_u32 m0, s70, 114688
    s_mov_b32 s53, 3670016
    buffer_load_dwordx4 v20, s[32:35], s53 offen lds
    s_add_u32 m0, s70, 118784
    s_mov_b32 s53, 3801088
    buffer_load_dwordx4 v20, s[32:35], s53 offen lds
    s_add_u32 m0, s70, 122880
    s_mov_b32 s53, 3932160
    v_xor_b32 v20, 128, v20
    buffer_load_dwordx4 v20, s[32:35], s53 offen lds
    s_add_u32 m0, s70, 126976
    s_mov_b32 s53, 4063232
    buffer_load_dwordx4 v20, s[32:35], s53 offen lds
    v_xor_b32 v20, 128, v20
    s_waitcnt vmcnt(16)
    s_barrier
    s_mov_b32 s52, 0x05040100
    s_mov_b32 s53, 0x07060302
    v_perm_b32 v120, v114, v112, s52
    v_perm_b32 v121, v114, v112, s53
    v_perm_b32 v122, v115, v113, s52
    v_perm_b32 v123, v115, v113, s53
    v_perm_b32 v124, v118, v116, s52
    v_perm_b32 v125, v118, v116, s53
    v_perm_b32 v126, v119, v117, s52
    v_perm_b32 v127, v119, v117, s53
    ds_write_b128 v2, v[120:123]
    ds_write_b128 v2, v[124:127] offset:4096
    v_mov_b32 v13, 16
    buffer_load_dword v112, v13, s[40:43], 0 offen sc1
    s_waitcnt lgkmcnt(0)
    s_xor_b32 s52, s48, 0
    s_lshl_b32 s52, s52, 14
    s_add_u32 s52, s52, 0
    v_add_u32 v25, s52, v24
    ds_read_b64_tr_b16 a[176:177], v25 offset:0
    ds_read_b64_tr_b16 a[178:179], v25 offset:256
    ds_read_b64_tr_b16 a[180:181], v25 offset:4096
    ds_read_b64_tr_b16 a[182:183], v25 offset:4352
    ds_read_b64_tr_b16 a[184:185], v25 offset:32
    ds_read_b64_tr_b16 a[186:187], v25 offset:288
    ds_read_b64_tr_b16 a[188:189], v25 offset:4128
    ds_read_b64_tr_b16 a[190:191], v25 offset:4384
    s_waitcnt lgkmcnt(6)
    s_xor_b32 s52, s48, 1
    s_lshl_b32 s52, s52, 14
    s_add_u32 s52, s52, 0
    v_add_u32 v25, s52, v24
    ds_read_b64_tr_b16 a[208:209], v25 offset:0
    ds_read_b64_tr_b16 a[210:211], v25 offset:256
    ds_read_b64_tr_b16 a[212:213], v25 offset:4096
    ds_read_b64_tr_b16 a[214:215], v25 offset:4352
    ds_read_b64_tr_b16 a[216:217], v25 offset:32
    ds_read_b64_tr_b16 a[218:219], v25 offset:288
    ds_read_b64_tr_b16 a[220:221], v25 offset:4128
    ds_read_b64_tr_b16 a[222:223], v25 offset:4384
    s_waitcnt lgkmcnt(6)
    s_xor_b32 s52, s48, 2
    s_lshl_b32 s52, s52, 14
    s_add_u32 s52, s52, 0
    v_add_u32 v25, s52, v24
    ds_read_b64_tr_b16 a[240:241], v25 offset:0
    ds_read_b64_tr_b16 a[242:243], v25 offset:256
    ds_read_b64_tr_b16 a[244:245], v25 offset:4096
    ds_read_b64_tr_b16 a[246:247], v25 offset:4352
    ds_read_b64_tr_b16 a[248:249], v25 offset:32
    ds_read_b64_tr_b16 a[250:251], v25 offset:288
    ds_read_b64_tr_b16 a[252:253], v25 offset:4128
    ds_read_b64_tr_b16 a[254:255], v25 offset:4384
    s_waitcnt lgkmcnt(6)
    s_xor_b32 s52, s48, 3
    s_lshl_b32 s52, s52, 14
    s_add_u32 s52, s52, 0
    v_add_u32 v25, s52, v24
    ds_read_b64_tr_b16 v[136:137], v25 offset:0
    ds_read_b64_tr_b16 v[138:139], v25 offset:256
    ds_read_b64_tr_b16 v[140:141], v25 offset:4096
    ds_read_b64_tr_b16 v[142:143], v25 offset:4352
    ds_read_b64_tr_b16 v[144:145], v25 offset:32
    ds_read_b64_tr_b16 v[146:147], v25 offset:288
    ds_read_b64_tr_b16 v[148:149], v25 offset:4128
    ds_read_b64_tr_b16 v[150:151], v25 offset:4384
    s_waitcnt lgkmcnt(0)
    s_barrier
    s_mov_b32 s32, s14
    s_and_b32 s33, s15, 0xffff
    s_mov_b32 s34, 0x400000
    s_mov_b32 s35, 0x00020000
    s_add_u32 m0, s70, 0
    s_mov_b32 s53, 0
    buffer_load_dwordx4 v20, s[32:35], s53 offen lds
    s_add_u32 m0, s70, 4096
    s_mov_b32 s53, 131072
    buffer_load_dwordx4 v20, s[32:35], s53 offen lds
    s_add_u32 m0, s70, 8192
    s_mov_b32 s53, 262144
    v_xor_b32 v20, 128, v20
    buffer_load_dwordx4 v20, s[32:35], s53 offen lds
    s_add_u32 m0, s70, 12288
    s_mov_b32 s53, 393216
    buffer_load_dwordx4 v20, s[32:35], s53 offen lds
    v_xor_b32 v20, 128, v20
    s_add_u32 m0, s70, 16384
    s_mov_b32 s53, 524288
    buffer_load_dwordx4 v20, s[32:35], s53 offen lds
    s_add_u32 m0, s70, 20480
    s_mov_b32 s53, 655360
    buffer_load_dwordx4 v20, s[32:35], s53 offen lds
    s_add_u32 m0, s70, 24576
    s_mov_b32 s53, 786432
    v_xor_b32 v20, 128, v20
    buffer_load_dwordx4 v20, s[32:35], s53 offen lds
    s_add_u32 m0, s70, 28672
    s_mov_b32 s53, 917504
    buffer_load_dwordx4 v20, s[32:35], s53 offen lds
    v_xor_b32 v20, 128, v20
    s_add_u32 m0, s70, 32768
    s_mov_b32 s53, 1048576
    buffer_load_dwordx4 v20, s[32:35], s53 offen lds
    s_add_u32 m0, s70, 36864
    s_mov_b32 s53, 1179648
    buffer_load_dwordx4 v20, s[32:35], s53 offen lds
    s_add_u32 m0, s70, 40960
    s_mov_b32 s53, 1310720
    v_xor_b32 v20, 128, v20
    buffer_load_dwordx4 v20, s[32:35], s53 offen lds
    s_add_u32 m0, s70, 45056
    s_mov_b32 s53, 1441792
    buffer_load_dwordx4 v20, s[32:35], s53 offen lds
    v_xor_b32 v20, 128, v20
    s_add_u32 m0, s70, 49152
    s_mov_b32 s53, 1572864
    buffer_load_dwordx4 v20, s[32:35], s53 offen lds
    s_add_u32 m0, s70, 53248
    s_mov_b32 s53, 1703936
    buffer_load_dwordx4 v20, s[32:35], s53 offen lds
    s_add_u32 m0, s70, 57344
    s_mov_b32 s53, 1835008
    v_xor_b32 v20, 128, v20
    buffer_load_dwordx4 v20, s[32:35], s53 offen lds
    s_add_u32 m0, s70, 61440
    s_mov_b32 s53, 1966080
    buffer_load_dwordx4 v20, s[32:35], s53 offen lds
    v_xor_b32 v20, 128, v20
    s_waitcnt vmcnt(17)
    s_barrier
    v_mov_b32 v12, 163328
    s_mov_b64 exec, s[62:63]
    ds_write_b32 v12, v27
    s_mov_b64 exec, -1
    s_waitcnt lgkmcnt(0)
    s_barrier
    ds_read_b32 v27, v12
    s_waitcnt lgkmcnt(0)
    v_readfirstlane_b32 s100, v27
    s_lshl_b32 s55, 1, s49
    s_andn2_b32 s55, s55, s71
    s_and_b32 s52, s100, s55
    s_nop 1
    s_cbranch_scc1 L_claimfail
    v_mov_b32 v12, -1
    v_mov_b32 v13, -1
    v_mov_b32 v14, -1
    v_mov_b32 v15, -1
    s_mov_b32 s53, 8192
    s_lshl_b32 s66, s49, 7
    s_mov_b32 s50, 0
    s_mov_b32 s59, 0
    buffer_store_dwordx4 v[12:15], v1, s[28:31], s64 offen sc1
    buffer_store_dwordx4 v[12:15], v1, s[28:31], s65 offen sc1
    s_mov_b64 exec, s[74:75]
    buffer_store_dword v12, v11, s[28:31], 0 offen sc1
    buffer_store_dword v12, v11, s[28:31], s53 offen sc1
    s_mov_b64 exec, -1
    s_lshl_b32 s52, s48, 11
    s_lshl_b32 s68, s49, 13
    s_add_u32 s68, s68, s52
    s_add_u32 s68, s68, 16646144
    s_lshl_b32 s69, s49, 12
    s_add_u32 s69, s69, s70
    s_add_u32 s69, s69, 67895296
    s_add_u32 s72, s52, 131072
    s_add_u32 s73, s52, 139264
    s_xor_b32 s52, s48, 0
    s_lshl_b32 s52, s52, 14
    s_add_u32 s52, s52, 65536
    v_add_u32 v25, s52, v24
    ds_read_b64_tr_b16 a[192:193], v25 offset:0
    ds_read_b64_tr_b16 a[194:195], v25 offset:256
    ds_read_b64_tr_b16 a[196:197], v25 offset:4096
    ds_read_b64_tr_b16 a[198:199], v25 offset:4352
    ds_read_b64_tr_b16 a[200:201], v25 offset:32
    ds_read_b64_tr_b16 a[202:203], v25 offset:288
    ds_read_b64_tr_b16 a[204:205], v25 offset:4128
    ds_read_b64_tr_b16 a[206:207], v25 offset:4384
    s_waitcnt lgkmcnt(6)
    s_xor_b32 s52, s48, 1
    s_lshl_b32 s52, s52, 14
    s_add_u32 s52, s52, 65536
    v_add_u32 v25, s52, v24
    ds_read_b64_tr_b16 a[224:225], v25 offset:0
    ds_read_b64_tr_b16 a[226:227], v25 offset:256
    ds_read_b64_tr_b16 a[228:229], v25 offset:4096
    ds_read_b64_tr_b16 a[230:231], v25 offset:4352
    ds_read_b64_tr_b16 a[232:233], v25 offset:32
    ds_read_b64_tr_b16 a[234:235], v25 offset:288
    ds_read_b64_tr_b16 a[236:237], v25 offset:4128
    ds_read_b64_tr_b16 a[238:239], v25 offset:4384
    s_waitcnt lgkmcnt(6)
    s_xor_b32 s52, s48, 2
    s_lshl_b32 s52, s52, 14
    s_add_u32 s52, s52, 65536
    v_add_u32 v25, s52, v24
    ds_read_b64_tr_b16 v[72:73], v25 offset:0
    ds_read_b64_tr_b16 v[74:75], v25 offset:256
    ds_read_b64_tr_b16 v[76:77], v25 offset:4096
    ds_read_b64_tr_b16 v[78:79], v25 offset:4352
    ds_read_b64_tr_b16 v[128:129], v25 offset:32
    ds_read_b64_tr_b16 v[130:131], v25 offset:288
    ds_read_b64_tr_b16 v[132:133], v25 offset:4128
    ds_read_b64_tr_b16 v[134:135], v25 offset:4384
    s_waitcnt lgkmcnt(6)
    s_xor_b32 s52, s48, 3
    s_lshl_b32 s52, s52, 14
    s_add_u32 s52, s52, 65536
    v_add_u32 v25, s52, v24
    ds_read_b64_tr_b16 v[152:153], v25 offset:0
    ds_read_b64_tr_b16 v[154:155], v25 offset:256
    ds_read_b64_tr_b16 v[156:157], v25 offset:4096
    ds_read_b64_tr_b16 v[158:159], v25 offset:4352
    ds_read_b64_tr_b16 v[160:161], v25 offset:32
    ds_read_b64_tr_b16 v[162:163], v25 offset:288
    ds_read_b64_tr_b16 v[164:165], v25 offset:4128
    ds_read_b64_tr_b16 v[166:167], v25 offset:4384
    s_waitcnt lgkmcnt(0)
    s_barrier
    s_add_u32 m0, s70, 65536
    s_mov_b32 s53, 2097152
    buffer_load_dwordx4 v20, s[32:35], s53 offen lds
    s_add_u32 m0, s70, 69632
    s_mov_b32 s53, 2228224
    buffer_load_dwordx4 v20, s[32:35], s53 offen lds
    s_add_u32 m0, s70, 73728
    s_mov_b32 s53, 2359296
    v_xor_b32 v20, 128, v20
    buffer_load_dwordx4 v20, s[32:35], s53 offen lds
    s_add_u32 m0, s70, 77824
    s_mov_b32 s53, 2490368
    buffer_load_dwordx4 v20, s[32:35], s53 offen lds
    v_xor_b32 v20, 128, v20
    s_add_u32 m0, s70, 81920
    s_mov_b32 s53, 2621440
    buffer_load_dwordx4 v20, s[32:35], s53 offen lds
    s_add_u32 m0, s70, 86016
    s_mov_b32 s53, 2752512
    buffer_load_dwordx4 v20, s[32:35], s53 offen lds
    s_add_u32 m0, s70, 90112
    s_mov_b32 s53, 2883584
    v_xor_b32 v20, 128, v20
    buffer_load_dwordx4 v20, s[32:35], s53 offen lds
    s_add_u32 m0, s70, 94208
    s_mov_b32 s53, 3014656
    buffer_load_dwordx4 v20, s[32:35], s53 offen lds
    v_xor_b32 v20, 128, v20
    s_add_u32 m0, s70, 98304
    s_mov_b32 s53, 3145728
    buffer_load_dwordx4 v20, s[32:35], s53 offen lds
    s_add_u32 m0, s70, 102400
    s_mov_b32 s53, 3276800
    buffer_load_dwordx4 v20, s[32:35], s53 offen lds
    s_add_u32 m0, s70, 106496
    s_mov_b32 s53, 3407872
    v_xor_b32 v20, 128, v20
    buffer_load_dwordx4 v20, s[32:35], s53 offen lds
    s_add_u32 m0, s70, 110592
    s_mov_b32 s53, 3538944
    buffer_load_dwordx4 v20, s[32:35], s53 offen lds
    v_xor_b32 v20, 128, v20
    s_add_u32 m0, s70, 114688
    s_mov_b32 s53, 3670016
    buffer_load_dwordx4 v20, s[32:35], s53 offen lds
    s_add_u32 m0, s70, 118784
    s_mov_b32 s53, 3801088
    buffer_load_dwordx4 v20, s[32:35], s53 offen lds
    s_add_u32 m0, s70, 122880
    s_mov_b32 s53, 3932160
    v_xor_b32 v20, 128, v20
    buffer_load_dwordx4 v20, s[32:35], s53 offen lds
    s_add_u32 m0, s70, 126976
    s_mov_b32 s53, 4063232
    buffer_load_dwordx4 v20, s[32:35], s53 offen lds
    v_xor_b32 v20, 128, v20
    s_waitcnt vmcnt(20)
    s_barrier
    v_readfirstlane_b32 s91, v112
    s_xor_b32 s52, s48, 0
    s_lshl_b32 s52, s52, 14
    s_add_u32 s52, s52, 0
    v_add_u32 v25, s52, v23
    ds_read_b64_tr_b16 v[80:81], v25 offset:0
    ds_read_b64_tr_b16 v[82:83], v25 offset:256
    ds_read_b64_tr_b16 v[84:85], v25 offset:4096
    ds_read_b64_tr_b16 v[86:87], v25 offset:4352
    ds_read_b64_tr_b16 v[88:89], v25 offset:8
    ds_read_b64_tr_b16 v[90:91], v25 offset:264
    ds_read_b64_tr_b16 v[92:93], v25 offset:4104
    ds_read_b64_tr_b16 v[94:95], v25 offset:4360
    s_waitcnt lgkmcnt(6)
    s_xor_b32 s52, s48, 1
    s_lshl_b32 s52, s52, 14
    s_add_u32 s52, s52, 0
    v_add_u32 v25, s52, v23
    ds_read_b64_tr_b16 a[96:97], v25 offset:0
    ds_read_b64_tr_b16 a[98:99], v25 offset:256
    ds_read_b64_tr_b16 a[100:101], v25 offset:4096
    ds_read_b64_tr_b16 a[102:103], v25 offset:4352
    ds_read_b64_tr_b16 a[104:105], v25 offset:8
    ds_read_b64_tr_b16 a[106:107], v25 offset:264
    ds_read_b64_tr_b16 a[108:109], v25 offset:4104
    ds_read_b64_tr_b16 a[110:111], v25 offset:4360
    s_waitcnt lgkmcnt(6)
    s_xor_b32 s52, s48, 2
    s_lshl_b32 s52, s52, 14
    s_add_u32 s52, s52, 0
    v_add_u32 v25, s52, v23
    ds_read_b64_tr_b16 a[128:129], v25 offset:0
    ds_read_b64_tr_b16 a[130:131], v25 offset:256
    ds_read_b64_tr_b16 a[132:133], v25 offset:4096
    ds_read_b64_tr_b16 a[134:135], v25 offset:4352
    ds_read_b64_tr_b16 v[96:97], v25 offset:8
    ds_read_b64_tr_b16 v[98:99], v25 offset:264
    ds_read_b64_tr_b16 v[100:101], v25 offset:4104
    ds_read_b64_tr_b16 v[102:103], v25 offset:4360
    s_waitcnt lgkmcnt(6)
    s_xor_b32 s52, s48, 3
    s_lshl_b32 s52, s52, 14
    s_add_u32 s52, s52, 0
    v_add_u32 v25, s52, v23
    ds_read_b64_tr_b16 a[152:153], v25 offset:0
    ds_read_b64_tr_b16 a[154:155], v25 offset:256
    ds_read_b64_tr_b16 a[156:157], v25 offset:4096
    ds_read_b64_tr_b16 a[158:159], v25 offset:4352
    ds_read_b64_tr_b16 a[160:161], v25 offset:8
    ds_read_b64_tr_b16 a[162:163], v25 offset:264
    ds_read_b64_tr_b16 a[164:165], v25 offset:4104
    ds_read_b64_tr_b16 a[166:167], v25 offset:4360
    s_waitcnt lgkmcnt(0)
    s_barrier
    s_mov_b32 s32, s12
    s_and_b32 s33, s13, 0xffff
    s_mov_b32 s34, 0x400000
    s_mov_b32 s35, 0x00020000
    s_add_u32 m0, s70, 0
    s_mov_b32 s53, 0
    buffer_load_dwordx4 v20, s[32:35], s53 offen lds
    s_add_u32 m0, s70, 4096
    s_mov_b32 s53, 131072
    buffer_load_dwordx4 v20, s[32:35], s53 offen lds
    s_add_u32 m0, s70, 8192
    s_mov_b32 s53, 262144
    v_xor_b32 v20, 128, v20
    buffer_load_dwordx4 v20, s[32:35], s53 offen lds
    s_add_u32 m0, s70, 12288
    s_mov_b32 s53, 393216
    buffer_load_dwordx4 v20, s[32:35], s53 offen lds
    v_xor_b32 v20, 128, v20
    s_add_u32 m0, s70, 16384
    s_mov_b32 s53, 524288
    buffer_load_dwordx4 v20, s[32:35], s53 offen lds
    s_add_u32 m0, s70, 20480
    s_mov_b32 s53, 655360
    buffer_load_dwordx4 v20, s[32:35], s53 offen lds
    s_add_u32 m0, s70, 24576
    s_mov_b32 s53, 786432
    v_xor_b32 v20, 128, v20
    buffer_load_dwordx4 v20, s[32:35], s53 offen lds
    s_add_u32 m0, s70, 28672
    s_mov_b32 s53, 917504
    buffer_load_dwordx4 v20, s[32:35], s53 offen lds
    v_xor_b32 v20, 128, v20
    s_add_u32 m0, s70, 32768
    s_mov_b32 s53, 1048576
    buffer_load_dwordx4 v20, s[32:35], s53 offen lds
    s_add_u32 m0, s70, 36864
    s_mov_b32 s53, 1179648
    buffer_load_dwordx4 v20, s[32:35], s53 offen lds
    s_add_u32 m0, s70, 40960
    s_mov_b32 s53, 1310720
    v_xor_b32 v20, 128, v20
    buffer_load_dwordx4 v20, s[32:35], s53 offen lds
    s_add_u32 m0, s70, 45056
    s_mov_b32 s53, 1441792
    buffer_load_dwordx4 v20, s[32:35], s53 offen lds
    v_xor_b32 v20, 128, v20
    s_add_u32 m0, s70, 49152
    s_mov_b32 s53, 1572864
    buffer_load_dwordx4 v20, s[32:35], s53 offen lds
    s_add_u32 m0, s70, 53248
    s_mov_b32 s53, 1703936
    buffer_load_dwordx4 v20, s[32:35], s53 offen lds
    s_add_u32 m0, s70, 57344
    s_mov_b32 s53, 1835008
    v_xor_b32 v20, 128, v20
    buffer_load_dwordx4 v20, s[32:35], s53 offen lds
    s_add_u32 m0, s70, 61440
    s_mov_b32 s53, 1966080
    buffer_load_dwordx4 v20, s[32:35], s53 offen lds
    v_xor_b32 v20, 128, v20
    s_waitcnt vmcnt(16)
    s_barrier
    s_cmp_lg_u32 s78, 0
    s_cselect_b32 s52, 0x10001, 1
    v_mov_b32 v112, s52
    v_mov_b32 v113, 8
    s_mov_b64 exec, s[62:63]
    buffer_atomic_add v112, v113, s[40:43], 0 offen
    s_mov_b64 exec, -1
    s_xor_b32 s52, s48, 0
    s_lshl_b32 s52, s52, 14
    s_add_u32 s52, s52, 65536
    v_add_u32 v25, s52, v23
    ds_read_b64_tr_b16 a[80:81], v25 offset:0
    ds_read_b64_tr_b16 a[82:83], v25 offset:256
    ds_read_b64_tr_b16 a[84:85], v25 offset:4096
    ds_read_b64_tr_b16 a[86:87], v25 offset:4352
    ds_read_b64_tr_b16 a[88:89], v25 offset:8
    ds_read_b64_tr_b16 a[90:91], v25 offset:264
    ds_read_b64_tr_b16 a[92:93], v25 offset:4104
    ds_read_b64_tr_b16 a[94:95], v25 offset:4360
    s_waitcnt lgkmcnt(6)
    s_xor_b32 s52, s48, 1
    s_lshl_b32 s52, s52, 14
    s_add_u32 s52, s52, 65536
    v_add_u32 v25, s52, v23
    ds_read_b64_tr_b16 a[112:113], v25 offset:0
    ds_read_b64_tr_b16 a[114:115], v25 offset:256
    ds_read_b64_tr_b16 a[116:117], v25 offset:4096
    ds_read_b64_tr_b16 a[118:119], v25 offset:4352
    ds_read_b64_tr_b16 a[120:121], v25 offset:8
    ds_read_b64_tr_b16 a[122:123], v25 offset:264
    ds_read_b64_tr_b16 a[124:125], v25 offset:4104
    ds_read_b64_tr_b16 a[126:127], v25 offset:4360
    s_waitcnt lgkmcnt(6)
    s_xor_b32 s52, s48, 2
    s_lshl_b32 s52, s52, 14
    s_add_u32 s52, s52, 65536
    v_add_u32 v25, s52, v23
    ds_read_b64_tr_b16 a[136:137], v25 offset:0
    ds_read_b64_tr_b16 a[138:139], v25 offset:256
    ds_read_b64_tr_b16 a[140:141], v25 offset:4096
    ds_read_b64_tr_b16 a[142:143], v25 offset:4352
    ds_read_b64_tr_b16 a[144:145], v25 offset:8
    ds_read_b64_tr_b16 a[146:147], v25 offset:264
    ds_read_b64_tr_b16 a[148:149], v25 offset:4104
    ds_read_b64_tr_b16 a[150:151], v25 offset:4360
    s_waitcnt lgkmcnt(6)
    s_xor_b32 s52, s48, 3
    s_lshl_b32 s52, s52, 14
    s_add_u32 s52, s52, 65536
    v_add_u32 v25, s52, v23
    ds_read_b64_tr_b16 a[168:169], v25 offset:0
    ds_read_b64_tr_b16 a[170:171], v25 offset:256
    ds_read_b64_tr_b16 a[172:173], v25 offset:4096
    ds_read_b64_tr_b16 a[174:175], v25 offset:4352
    ds_read_b64_tr_b16 v[104:105], v25 offset:8
    ds_read_b64_tr_b16 v[106:107], v25 offset:264
    ds_read_b64_tr_b16 v[108:109], v25 offset:4104
    ds_read_b64_tr_b16 v[110:111], v25 offset:4360
    s_waitcnt lgkmcnt(0)
    s_barrier
    s_add_u32 m0, s70, 65536
    s_mov_b32 s53, 2097152
    buffer_load_dwordx4 v20, s[32:35], s53 offen lds
    s_add_u32 m0, s70, 69632
    s_mov_b32 s53, 2228224
    buffer_load_dwordx4 v20, s[32:35], s53 offen lds
    s_add_u32 m0, s70, 73728
    s_mov_b32 s53, 2359296
    v_xor_b32 v20, 128, v20
    buffer_load_dwordx4 v20, s[32:35], s53 offen lds
    s_add_u32 m0, s70, 77824
    s_mov_b32 s53, 2490368
    buffer_load_dwordx4 v20, s[32:35], s53 offen lds
    v_xor_b32 v20, 128, v20
    s_add_u32 m0, s70, 81920
    s_mov_b32 s53, 2621440
    buffer_load_dwordx4 v20, s[32:35], s53 offen lds
    s_add_u32 m0, s70, 86016
    s_mov_b32 s53, 2752512
    buffer_load_dwordx4 v20, s[32:35], s53 offen lds
    s_add_u32 m0, s70, 90112
    s_mov_b32 s53, 2883584
    v_xor_b32 v20, 128, v20
    buffer_load_dwordx4 v20, s[32:35], s53 offen lds
    s_add_u32 m0, s70, 94208
    s_mov_b32 s53, 3014656
    buffer_load_dwordx4 v20, s[32:35], s53 offen lds
    v_xor_b32 v20, 128, v20
    s_add_u32 m0, s70, 98304
    s_mov_b32 s53, 3145728
    buffer_load_dwordx4 v20, s[32:35], s53 offen lds
    s_add_u32 m0, s70, 102400
    s_mov_b32 s53, 3276800
    buffer_load_dwordx4 v20, s[32:35], s53 offen lds
    s_add_u32 m0, s70, 106496
    s_mov_b32 s53, 3407872
    v_xor_b32 v20, 128, v20
    buffer_load_dwordx4 v20, s[32:35], s53 offen lds
    s_add_u32 m0, s70, 110592
    s_mov_b32 s53, 3538944
    buffer_load_dwordx4 v20, s[32:35], s53 offen lds
    v_xor_b32 v20, 128, v20
    s_add_u32 m0, s70, 114688
    s_mov_b32 s53, 3670016
    buffer_load_dwordx4 v20, s[32:35], s53 offen lds
    s_add_u32 m0, s70, 118784
    s_mov_b32 s53, 3801088
    buffer_load_dwordx4 v20, s[32:35], s53 offen lds
    s_add_u32 m0, s70, 122880
    s_mov_b32 s53, 3932160
    v_xor_b32 v20, 128, v20
    buffer_load_dwordx4 v20, s[32:35], s53 offen lds
    s_add_u32 m0, s70, 126976
    s_mov_b32 s53, 4063232
    buffer_load_dwordx4 v20, s[32:35], s53 offen lds
    v_xor_b32 v20, 128, v20
    s_waitcnt vmcnt(16)
    s_barrier
    v_and_b32 v27, 3, v16
    v_lshrrev_b32 v12, 1, v27
    v_lshlrev_b32 v12, 6, v12
    v_and_b32 v27, 1, v27
    v_add_u32 v27, v27, v12
    s_lshl_b32 s54, s49, 1
    v_add_u32 v27, s54, v27
    v_lshlrev_b32 v27, 4, v27
    buffer_load_dwordx4 v[12:15], v27, s[28:31], 0 offen offset:0 sc1
    s_xor_b32 s52, s48, 0
    s_lshl_b32 s52, s52, 14
    s_add_u32 s52, s52, 0
    v_add_u32 v25, s52, v23
    ds_read_b64_tr_b16 v[112:113], v25 offset:0
    ds_read_b64_tr_b16 v[114:115], v25 offset:256
    ds_read_b64_tr_b16 v[116:117], v25 offset:4096
    ds_read_b64_tr_b16 v[118:119], v25 offset:4352
    ds_read_b64_tr_b16 v[120:121], v25 offset:8
    ds_read_b64_tr_b16 v[122:123], v25 offset:264
    ds_read_b64_tr_b16 v[124:125], v25 offset:4104
    ds_read_b64_tr_b16 v[126:127], v25 offset:4360
    s_waitcnt lgkmcnt(6)
    s_xor_b32 s52, s48, 1
    s_lshl_b32 s52, s52, 14
    s_add_u32 s52, s52, 0
    v_add_u32 v25, s52, v23
    ds_read_b64_tr_b16 a[0:1], v25 offset:0
    ds_read_b64_tr_b16 a[2:3], v25 offset:256
    ds_read_b64_tr_b16 a[4:5], v25 offset:4096
    ds_read_b64_tr_b16 a[6:7], v25 offset:4352
    ds_read_b64_tr_b16 a[8:9], v25 offset:8
    ds_read_b64_tr_b16 a[10:11], v25 offset:264
    ds_read_b64_tr_b16 a[12:13], v25 offset:4104
    ds_read_b64_tr_b16 a[14:15], v25 offset:4360
    s_waitcnt lgkmcnt(6)
    s_xor_b32 s52, s48, 2
    s_lshl_b32 s52, s52, 14
    s_add_u32 s52, s52, 0
    v_add_u32 v25, s52, v23
    ds_read_b64_tr_b16 a[32:33], v25 offset:0
    ds_read_b64_tr_b16 a[34:35], v25 offset:256
    ds_read_b64_tr_b16 a[36:37], v25 offset:4096
    ds_read_b64_tr_b16 a[38:39], v25 offset:4352
    ds_read_b64_tr_b16 a[40:41], v25 offset:8
    ds_read_b64_tr_b16 a[42:43], v25 offset:264
    ds_read_b64_tr_b16 a[44:45], v25 offset:4104
    ds_read_b64_tr_b16 a[46:47], v25 offset:4360
    s_waitcnt lgkmcnt(6)
    s_xor_b32 s52, s48, 3
    s_lshl_b32 s52, s52, 14
    s_add_u32 s52, s52, 0
    v_add_u32 v25, s52, v23
    ds_read_b64_tr_b16 a[56:57], v25 offset:0
    ds_read_b64_tr_b16 a[58:59], v25 offset:256
    ds_read_b64_tr_b16 a[60:61], v25 offset:4096
    ds_read_b64_tr_b16 a[62:63], v25 offset:4352
    ds_read_b64_tr_b16 a[64:65], v25 offset:8
    ds_read_b64_tr_b16 a[66:67], v25 offset:264
    ds_read_b64_tr_b16 a[68:69], v25 offset:4104
    ds_read_b64_tr_b16 a[70:71], v25 offset:4360
    s_waitcnt lgkmcnt(0)
    s_barrier
    ds_write_b128 v7, v[32:35] offset:0
    ds_write_b128 v7, v[36:39] offset:1024
    s_waitcnt lgkmcnt(4)
    ds_write_b128 v7, v[40:43] offset:8192
    ds_write_b128 v7, v[44:47] offset:9216
    s_waitcnt lgkmcnt(4)
    ds_write_b128 v7, v[56:59] offset:16384
    ds_write_b128 v7, v[60:63] offset:17408
    s_waitcnt lgkmcnt(4)
    ds_write_b128 v7, v[64:67] offset:24576
    ds_write_b128 v7, v[68:71] offset:25600
    s_waitcnt lgkmcnt(4)
    ds_write_b128 v7, v[48:51] offset:32768
    ds_write_b128 v7, v[52:55] offset:33792
    s_waitcnt lgkmcnt(4)
    ds_write_b128 v7, v[72:75] offset:40960
    ds_write_b128 v7, v[76:79] offset:41984
    s_waitcnt lgkmcnt(4)
    ds_write_b128 v7, v[80:83] offset:49152
    ds_write_b128 v7, v[84:87] offset:50176
    s_waitcnt lgkmcnt(4)
    ds_write_b128 v7, v[88:91] offset:57344
    ds_write_b128 v7, v[92:95] offset:58368
    s_waitcnt lgkmcnt(4)
    s_waitcnt lgkmcnt(0)
    s_waitcnt vmcnt(1)
    s_barrier
    s_waitcnt vmcnt(0)
    v_min_u32 v12, v12, v13
    v_cmp_eq_u32 vcc, 0, v12
    s_cmp_eq_u32 s91, 0
    s_nop 3
    s_cbranch_scc1 nk0_1
    s_cbranch_vccnz nk0_1
    s_mov_b32 s59, 2
    s_mov_b32 s91, 2
    s_mov_b32 m0, s72
    s_nop 0
    buffer_load_dwordx4 v1, s[28:31], s68 offen sc1 lds
    buffer_load_dwordx4 v1, s[28:31], s68 offen offset:1024 sc1 lds
nk0_1:
    v_mov_b32 v13, 8
    buffer_load_dword v27, v13, s[40:43], 0 offen sc1
    s_xor_b32 s52, s48, 0
    s_lshl_b32 s52, s52, 14
    s_add_u32 s52, s52, 65536
    v_add_u32 v25, s52, v23
    ds_read_b64_tr_b16 v[32:33], v25 offset:0
    ds_read_b64_tr_b16 v[34:35], v25 offset:256
    ds_read_b64_tr_b16 v[36:37], v25 offset:4096
    ds_read_b64_tr_b16 v[38:39], v25 offset:4352
    ds_read_b64_tr_b16 v[40:41], v25 offset:8
    ds_read_b64_tr_b16 v[42:43], v25 offset:264
    ds_read_b64_tr_b16 v[44:45], v25 offset:4104
    ds_read_b64_tr_b16 v[46:47], v25 offset:4360
    s_waitcnt lgkmcnt(6)
    s_xor_b32 s52, s48, 1
    s_lshl_b32 s52, s52, 14
    s_add_u32 s52, s52, 65536
    v_add_u32 v25, s52, v23
    ds_read_b64_tr_b16 a[16:17], v25 offset:0
    ds_read_b64_tr_b16 a[18:19], v25 offset:256
    ds_read_b64_tr_b16 a[20:21], v25 offset:4096
    ds_read_b64_tr_b16 a[22:23], v25 offset:4352
    ds_read_b64_tr_b16 a[24:25], v25 offset:8
    ds_read_b64_tr_b16 a[26:27], v25 offset:264
    ds_read_b64_tr_b16 a[28:29], v25 offset:4104
    ds_read_b64_tr_b16 a[30:31], v25 offset:4360
    s_waitcnt lgkmcnt(6)
    s_xor_b32 s52, s48, 2
    s_lshl_b32 s52, s52, 14
    s_add_u32 s52, s52, 65536
    v_add_u32 v25, s52, v23
    ds_read_b64_tr_b16 v[56:57], v25 offset:0
    ds_read_b64_tr_b16 v[58:59], v25 offset:256
    ds_read_b64_tr_b16 v[60:61], v25 offset:4096
    ds_read_b64_tr_b16 v[62:63], v25 offset:4352
    ds_read_b64_tr_b16 a[48:49], v25 offset:8
    ds_read_b64_tr_b16 a[50:51], v25 offset:264
    ds_read_b64_tr_b16 a[52:53], v25 offset:4104
    ds_read_b64_tr_b16 a[54:55], v25 offset:4360
    s_waitcnt lgkmcnt(6)
    s_xor_b32 s52, s48, 3
    s_lshl_b32 s52, s52, 14
    s_add_u32 s52, s52, 65536
    v_add_u32 v25, s52, v23
    ds_read_b64_tr_b16 a[72:73], v25 offset:0
    ds_read_b64_tr_b16 a[74:75], v25 offset:256
    ds_read_b64_tr_b16 a[76:77], v25 offset:4096
    ds_read_b64_tr_b16 a[78:79], v25 offset:4352
    ds_read_b64_tr_b16 v[64:65], v25 offset:8
    ds_read_b64_tr_b16 v[66:67], v25 offset:264
    ds_read_b64_tr_b16 v[68:69], v25 offset:4104
    ds_read_b64_tr_b16 v[70:71], v25 offset:4360
    s_waitcnt lgkmcnt(0)
    s_barrier
    ds_write_b128 v8, v[96:99] offset:0
    ds_write_b128 v8, v[100:103] offset:1024
    s_waitcnt lgkmcnt(4)
    ds_write_b128 v8, v[104:107] offset:8192
    ds_write_b128 v8, v[108:111] offset:9216
    s_waitcnt lgkmcnt(4)
    ds_write_b128 v8, v[112:115] offset:16384
    ds_write_b128 v8, v[116:119] offset:17408
    s_waitcnt lgkmcnt(4)
    ds_write_b128 v8, v[120:123] offset:24576
    ds_write_b128 v8, v[124:127] offset:25600
    s_waitcnt lgkmcnt(4)
    ds_write_b128 v8, v[32:35] offset:32768
    ds_write_b128 v8, v[36:39] offset:33792
    s_waitcnt lgkmcnt(4)
    ds_write_b128 v8, v[40:43] offset:40960
    ds_write_b128 v8, v[44:47] offset:41984
    s_waitcnt lgkmcnt(4)
    ds_write_b128 v8, v[56:59] offset:49152
    ds_write_b128 v8, v[60:63] offset:50176
    s_waitcnt lgkmcnt(4)
    ds_write_b128 v8, v[64:67] offset:57344
    ds_write_b128 v8, v[68:71] offset:58368
    s_waitcnt lgkmcnt(4)
    s_waitcnt lgkmcnt(0)
    s_cmp_eq_u32 s91, 2
    s_cbranch_scc1 k0ok_2
    v_mov_b32 v17, 16
    s_nop 1
gate_3:
    s_sub_u32 s79, s79, 1
    s_cbranch_scc1 L_abort
    buffer_load_dword v16, v17, s[40:43], 0 offen sc1
    s_waitcnt vmcnt(0)
    v_readfirstlane_b32 s52, v16
    s_nop 0
    s_cmp_lg_u32 s52, 0
    s_nop 2
    s_cbranch_scc1 gok_4
    s_sleep 16
    s_branch gate_3
gok_4:
    s_add_u32 s92, s50, 1
    s_min_u32 s92, s92, 63
    s_cmp_lt_u32 s92, s59
    s_cbranch_scc1 kvok_5
    v_mbcnt_lo_u32_b32 v36, -1, 0
    v_mbcnt_hi_u32_b32 v36, -1, v36
    v_and_b32 v36, 3, v36
    v_lshrrev_b32 v37, 1, v36
    v_lshlrev_b32 v37, 6, v37
    v_and_b32 v36, 1, v36
    v_add_u32 v36, v36, v37
    s_lshl_b32 s93, s49, 1
    v_add_u32 v36, s93, v36
    v_lshlrev_b32 v36, 4, v36
    s_nop 1
kvlp_6:
    s_sub_u32 s79, s79, 1
    s_cbranch_scc1 L_abort
    buffer_load_dwordx4 v[32:35], v36, s[28:31], 0 offen offset:0 sc1
    s_waitcnt vmcnt(0)
    v_lshlrev_b32 v32, 2, v32
    v_lshl_add_u32 v33, v33, 2, 1
    v_lshl_add_u32 v34, v34, 2, 2
    v_lshl_add_u32 v35, v35, 2, 3
    v_min3_u32 v32, v32, v33, v34
    v_min_u32 v32, v32, v35
    s_nop 0
    v_readlane_b32 s59, v32, 0
    v_readlane_b32 s93, v32, 1
    s_nop 0
    s_min_u32 s59, s59, s93
    v_readlane_b32 s93, v32, 2
    s_nop 0
    s_min_u32 s59, s59, s93
    v_readlane_b32 s93, v32, 3
    s_nop 0
    s_min_u32 s59, s59, s93
    s_cmp_lt_u32 s92, s59
    s_nop 1
    s_cbranch_scc0 kvlp_6
kvok_5:
    s_mov_b32 m0, s72
    s_nop 0
    buffer_load_dwordx4 v1, s[28:31], s68 offen sc1 lds
    buffer_load_dwordx4 v1, s[28:31], s68 offen offset:1024 sc1 lds
k0ok_2:
    s_waitcnt vmcnt(0)
    s_add_u32 s54, s68, 16777216
    buffer_load_dwordx4 v[120:123], v1, s[28:31], s54 offen sc1
    buffer_load_dwordx4 v[124:127], v1, s[28:31], s54 offen offset:1024 sc1
    s_add_u32 s68, s68, 262144
    v_readfirstlane_b32 s52, v27
    ds_read_b128 v[72:75], v7 offset:49152
    ds_read_b128 v[76:79], v7 offset:50176
    ds_read_b128 v[80:83], v7 offset:57344
    ds_read_b128 v[84:87], v7 offset:58368
    v_mov_b64 v[48:49], 0
    v_mov_b64 v[50:51], 0
    v_mov_b64 v[52:53], 0
    v_mov_b64 v[54:55], 0
    v_mov_b64 v[56:57], 0
    v_mov_b64 v[58:59], 0
    v_mov_b64 v[60:61], 0
    v_mov_b64 v[62:63], 0
    v_mov_b64 v[64:65], 0
    v_mov_b64 v[66:67], 0
    v_mov_b64 v[68:69], 0
    v_mov_b64 v[70:71], 0
    s_nop 1
rw_7:
    s_and_b32 s53, s52, 0xffff
    s_cmp_ge_u32 s53, 32
    s_cbranch_scc1 rgo_8
    s_sub_u32 s79, s79, 1
    s_cbranch_scc1 L_abort
    v_mov_b32 v13, 8
    buffer_load_dword v12, v13, s[40:43], 0 offen sc1
    s_waitcnt vmcnt(0)
    v_readfirstlane_b32 s52, v12
    s_nop 4
    s_branch rw_7
rgo_8:
    s_lshr_b32 s100, s52, 16
    ds_read_b128 v[16:19], v2
    ds_read_b128 v[20:23], v2 offset:4096
    v_add_u32 v104, s88, v1
    v_add_u32 v105, s89, v1
    v_add_u32 v106, s90, v1
    ds_read_b128 v[24:27], v8 offset:16384
    ds_read_b128 v[28:31], v8 offset:17408
    ds_read_b128 v[32:35], v8 offset:24576
    ds_read_b128 v[36:39], v8 offset:25600
    ds_read_b128 v[40:43], v8 offset:32768
    ds_read_b128 v[44:47], v8 offset:33792
    ds_read_b128 v[96:99], v8 offset:40960
    ds_read_b128 v[100:103], v8 offset:41984
    v_bfe_u32 v10, v1, 4, 3
    v_bfe_u32 v14, v1, 7, 1
    v_lshlrev_b32 v10, 2, v10
    v_lshl_add_u32 v10, v14, 10, v10
    s_lshl_b32 s92, s49, 5
    s_add_u32 s92, s92, 0
    v_add_u32 v10, s92, v10
    s_waitcnt lgkmcnt(0)
    s_cmp_eq_u32 s100, 0
    s_cbranch_scc0 slow_9
    s_branch ent_11
slow_9:
    s_branch ent_12
tl_15:
    s_mov_b64 exec, vcc
    buffer_load_dwordx4 v[16:19], v2, s[28:31], s54 offen sc1
    buffer_load_dwordx4 v[20:23], v2, s[28:31], s55 offen sc1
    s_mov_b64 exec, -1
    s_sub_u32 s79, s79, 1
    s_cbranch_scc1 L_abort
t1_14:
    s_waitcnt vmcnt(2) lgkmcnt(0)
    v_max3_u32 v12, v16, v17, v18
    v_max3_u32 v14, v19, v20, v21
    v_max3_u32 v12, v12, v22, v23
    v_max_u32 v12, v12, v14
    v_cmp_eq_u32 vcc, -1, v12
    s_cbranch_vccnz tl_15
ent_11:
    v_smfmac_f32_16x16x64_bf16 v[48:51], v[16:19], v[24:31], v0
    ds_write_b128 v2, v[16:19]
    v_smfmac_f32_16x16x64_bf16 v[52:55], v[16:19], v[32:39], v0
    ds_write_b128 v2, v[20:23] offset:4096
    v_smfmac_f32_16x16x64_bf16 v[48:51], v[20:23], v[40:47], v0
    s_mov_b32 m0, s73
    s_add_u32 s54, s68, 16777216
    v_smfmac_f32_16x16x64_bf16 v[52:55], v[20:23], v[96:103], v0
    buffer_load_dwordx4 v1, s[28:31], s68 offen sc1 lds
    v_smfmac_f32_16x16x64_bf16 v[56:59], v[16:19], v[72:79], v0
    ds_read_b128 v[72:75], v8 offset:49152
    buffer_load_dwordx4 v1, s[28:31], s68 offen offset:1024 sc1 lds
    v_smfmac_f32_16x16x64_bf16 v[60:63], v[16:19], v[80:87], v0
    ds_read_b128 v[80:83], v8 offset:57344
    v_smfmac_f32_16x16x64_bf16 v[56:59], v[20:23], a[80:87], v0
    v_smfmac_f32_16x16x64_bf16 v[60:63], v[20:23], a[88:95], v0
    s_waitcnt lgkmcnt(2)
    s_barrier
    v_smfmac_f32_16x16x64_bf16 v[64:67], v[16:19], a[176:183], v0
    ds_read_b128 v[24:27], v104 offset:16384
    ds_read_b128 v[28:31], v104 offset:20480
    v_smfmac_f32_16x16x64_bf16 v[68:71], v[16:19], a[184:191], v0
    ds_read_b128 v[32:35], v105 offset:16384
    ds_read_b128 v[36:39], v105 offset:20480
    v_smfmac_f32_16x16x64_bf16 v[64:67], v[20:23], a[192:199], v0
    ds_read_b128 v[40:43], v106 offset:16384
    ds_read_b128 v[44:47], v106 offset:20480
    v_smfmac_f32_16x16x64_bf16 v[68:71], v[20:23], a[200:207], v0
    s_waitcnt lgkmcnt(5)
    v_smfmac_f32_16x16x64_bf16 v[48:51], v[24:27], a[0:7], v0
    ds_read_b128 v[76:79], v8 offset:50176
    buffer_load_dwordx4 v[112:115], v1, s[28:31], s54 offen sc1
    v_smfmac_f32_16x16x64_bf16 v[52:55], v[24:27], a[8:15], v0
    ds_read_b128 v[84:87], v8 offset:58368
    s_waitcnt lgkmcnt(6)
    v_smfmac_f32_16x16x64_bf16 v[48:51], v[28:31], a[16:23], v0
    s_add_u32 s68, s68, 262144
    v_smfmac_f32_16x16x64_bf16 v[52:55], v[28:31], a[24:31], v0
    buffer_load_dwordx4 v[116:119], v1, s[28:31], s54 offen offset:1024 sc1
    s_waitcnt lgkmcnt(5)
    v_smfmac_f32_16x16x64_bf16 v[48:51], v[32:35], a[32:39], v0
    v_smfmac_f32_16x16x64_bf16 v[52:55], v[32:35], a[40:47], v0
    s_sub_u32 s53, s50, 1
    s_max_i32 s53, s53, 0
    v_mov_b32 v14, s53
    s_waitcnt lgkmcnt(4)
    s_waitcnt lgkmcnt(1)
    v_smfmac_f32_16x16x64_bf16 v[48:51], v[36:39], v[72:79], v0
    ds_read_b128 v[72:75], v8 offset:0
    v_mov_b32 v15, 24576
    v_smfmac_f32_16x16x64_bf16 v[52:55], v[36:39], a[48:55], v0
    ds_read_b128 v[76:79], v8 offset:1024
    s_mov_b64 exec, s[62:63]
    buffer_store_dword v14, v15, s[28:31], s66 offen sc1
    s_mov_b64 exec, -1
    v_smfmac_f32_16x16x64_bf16 v[48:51], v[40:43], a[56:63], v0
    buffer_load_dword v10, v10, s[28:31], 0 offen sc1
    v_smfmac_f32_16x16x64_bf16 v[52:55], v[40:43], a[64:71], v0
    v_smfmac_f32_16x16x64_bf16 v[48:51], v[44:47], a[72:79], v0
    buffer_store_dwordx4 v[92:95], v1, s[28:31], s69 offen sc1
    s_waitcnt lgkmcnt(2)
    v_smfmac_f32_16x16x64_bf16 v[52:55], v[44:47], v[80:87], v0
    ds_read_b128 v[80:83], v8 offset:8192
    v_smfmac_f32_16x16x64_bf16 v[56:59], v[24:27], a[96:103], v0
    ds_read_b128 v[84:87], v8 offset:9216
    v_smfmac_f32_16x16x64_bf16 v[60:63], v[24:27], a[104:111], v0
    s_add_u32 s55, s69, 9437184
    v_smfmac_f32_16x16x64_bf16 v[56:59], v[28:31], a[112:119], v0
    buffer_store_dwordx4 v[108:111], v1, s[28:31], s55 offen sc1
    v_smfmac_f32_16x16x64_bf16 v[60:63], v[28:31], a[120:127], v0
    s_add_u32 s69, s69, 131072
    v_add_f32 v48, v48, v50
    v_smfmac_f32_16x16x64_bf16 v[56:59], v[32:35], a[128:135], v0
    v_add_f32 v52, v52, v54
    s_waitcnt lgkmcnt(2)
    v_smfmac_f32_16x16x64_bf16 v[60:63], v[32:35], v[72:79], v0
    ds_read_b128 v[72:75], v7 offset:40960
    v_add_f32 v49, v49, v51
    v_smfmac_f32_16x16x64_bf16 v[56:59], v[36:39], a[136:143], v0
    ds_read_b128 v[76:79], v7 offset:41984
    v_add_f32 v53, v53, v55
    v_smfmac_f32_16x16x64_bf16 v[60:63], v[36:39], a[144:151], v0
    v_cvt_pk_bf16_f32 v48, v48, v52
    v_smfmac_f32_16x16x64_bf16 v[56:59], v[40:43], a[152:159], v0
    v_cvt_pk_bf16_f32 v49, v49, v53
    v_smfmac_f32_16x16x64_bf16 v[60:63], v[40:43], a[160:167], v0
    ds_write2_b32 v3, v48, v49 offset0:0 offset1:16
    v_smfmac_f32_16x16x64_bf16 v[56:59], v[44:47], a[168:175], v0
    s_waitcnt vmcnt(8)
    s_waitcnt lgkmcnt(3)
    v_smfmac_f32_16x16x64_bf16 v[60:63], v[44:47], v[80:87], v0
    ds_read_b128 v[80:83], v7 offset:0
    ds_read_b128 v[16:19], v1 offset:0
    ds_read_b128 v[20:23], v1 offset:4096
    ds_read_b128 v[104:107], v1 offset:1024
    v_smfmac_f32_16x16x64_bf16 v[64:67], v[24:27], a[208:215], v0
    ds_read_b128 v[84:87], v7 offset:1024
    ds_read_b128 v[12:15], v1 offset:5120
    v_smfmac_f32_16x16x64_bf16 v[68:71], v[24:27], a[216:223], v0
    v_add_f32 v56, v56, v58
    v_add_f32 v60, v60, v62
    v_smfmac_f32_16x16x64_bf16 v[64:67], v[28:31], a[224:231], v0
    v_add_f32 v57, v57, v59
    v_add_f32 v61, v61, v63
    v_smfmac_f32_16x16x64_bf16 v[68:71], v[28:31], a[232:239], v0
    v_cvt_pk_bf16_f32 v56, v56, v60
    v_cvt_pk_bf16_f32 v57, v57, v61
    v_smfmac_f32_16x16x64_bf16 v[64:67], v[32:35], a[240:247], v0
    ds_write2_b32 v3, v56, v57 offset0:32 offset1:48
    v_smfmac_f32_16x16x64_bf16 v[68:71], v[32:35], a[248:255], v0
    ds_read_b128 v[24:27], v1 offset:2048
    s_waitcnt lgkmcnt(9)
    v_smfmac_f32_16x16x64_bf16 v[64:67], v[36:39], v[72:79], v0
    ds_read_b128 v[72:75], v7 offset:8192
    ds_read_b128 v[28:31], v1 offset:6144
    v_smfmac_f32_16x16x64_bf16 v[68:71], v[36:39], v[128:135], v0
    ds_read_b128 v[76:79], v7 offset:9216
    v_smfmac_f32_16x16x64_bf16 v[64:67], v[40:43], v[136:143], v0
    s_waitcnt lgkmcnt(4)
    s_barrier
    v_smfmac_f32_16x16x64_bf16 v[68:71], v[40:43], v[144:151], v0
    ds_read_b128 v[88:91], v5 offset:0
    ds_read_b128 v[92:95], v5 offset:1088
    v_smfmac_f32_16x16x64_bf16 v[64:67], v[44:47], v[152:159], v0
    ds_read_b128 v[96:99], v5 offset:2176
    ds_read_b128 v[100:103], v5 offset:3264
    v_smfmac_f32_16x16x64_bf16 v[68:71], v[44:47], v[160:167], v0
    ds_read_b128 v[56:59], v1 offset:3072
    ds_read_b128 v[60:63], v1 offset:7168
    s_waitcnt lgkmcnt(5)
    v_mfma_f32_16x16x32_bf16 v[48:51], v[16:19], v[88:91], 0
    v_mfma_f32_16x16x32_bf16 v[52:55], v[20:23], v[88:91], 0
    s_waitcnt lgkmcnt(4)
    v_mfma_f32_16x16x32_bf16 v[48:51], v[104:107], v[92:95], v[48:51]
    v_add_f32 v64, v64, v66
    v_add_f32 v65, v65, v67
    v_mfma_f32_16x16x32_bf16 v[52:55], v[12:15], v[92:95], v[52:55]
    v_add_f32 v68, v68, v70
    v_add_f32 v69, v69, v71
    v_mfma_f32_16x16x32_bf16 v[12:15], v[88:91], v[88:91], 0
    v_cvt_pk_bf16_f32 v108, v64, v65
    v_cvt_pk_bf16_f32 v110, v68, v69
    v_mfma_f32_16x16x32_bf16 v[12:15], v[92:95], v[92:95], v[12:15]
    v_mov_b32 v109, 0
    v_mov_b32 v111, 0
    s_waitcnt lgkmcnt(3)
    v_mfma_f32_16x16x32_bf16 v[48:51], v[24:27], v[96:99], v[48:51]
    v_mov_b64 v[104:105], s[94:95]
    v_mov_b64 v[106:107], s[94:95]
    v_mfma_f32_16x16x32_bf16 v[52:55], v[28:31], v[96:99], v[52:55]
    v_mov_b64 v[32:33], 0
    v_mov_b64 v[34:35], 0
    v_mfma_f32_16x16x32_bf16 v[12:15], v[96:99], v[96:99], v[12:15]
    v_mov_b64 v[36:37], 0
    v_mov_b64 v[38:39], 0
    s_waitcnt lgkmcnt(2)
    v_mfma_f32_16x16x32_bf16 v[12:15], v[100:103], v[100:103], v[12:15]
    v_mov_b64 v[40:41], 0
    v_mov_b64 v[42:43], 0
    s_waitcnt lgkmcnt(1)
    v_mfma_f32_16x16x32_bf16 v[48:51], v[56:59], v[100:103], v[48:51]
    v_mov_b64 v[44:45], 0
    v_mov_b64 v[46:47], 0
    s_waitcnt lgkmcnt(0)
    v_mfma_f32_16x16x32_bf16 v[52:55], v[60:63], v[100:103], v[52:55]
    v_mov_b64 v[16:17], 0
    v_mov_b64 v[18:19], 0
    v_mov_b64 v[20:21], 0
    v_mov_b64 v[22:23], 0
    v_mov_b64 v[24:25], 0
    v_mov_b64 v[26:27], 0
    v_mov_b64 v[28:29], 0
    v_mov_b64 v[30:31], 0
    v_max_f32 v12, v14, v15
    v_max3_f32 v62, v12, v48, v49
    v_max3_f32 v62, v62, v50, v51
    v_max3_f32 v62, v62, v52, v53
    v_max3_f32 v62, v62, v54, v55
    v_mov_b32 v63, v62
    v_mov_b32 v61, 0
    s_nop 0
    v_permlane32_swap_b32 v63, v62
    v_max_f32 v62, v62, v63
    v_mov_b32 v63, v62
    s_nop 1
    v_permlane16_swap_b32 v63, v62
    v_max_f32 v62, v62, v63
    v_mul_f32 v62, s56, v62
    v_pk_fma_f32 v[14:15], v[14:15], s[76:77], v[62:63] op_sel_hi:[1,1,0] neg_lo:[0,0,1] neg_hi:[0,0,1]
    v_pk_fma_f32 v[48:49], v[48:49], s[76:77], v[62:63] op_sel_hi:[1,1,0] neg_lo:[0,0,1] neg_hi:[0,0,1]
    v_pk_fma_f32 v[50:51], v[50:51], s[76:77], v[62:63] op_sel_hi:[1,1,0] neg_lo:[0,0,1] neg_hi:[0,0,1]
    v_pk_fma_f32 v[52:53], v[52:53], s[76:77], v[62:63] op_sel_hi:[1,1,0] neg_lo:[0,0,1] neg_hi:[0,0,1]
    v_pk_fma_f32 v[54:55], v[54:55], s[76:77], v[62:63] op_sel_hi:[1,1,0] neg_lo:[0,0,1] neg_hi:[0,0,1]
    v_exp_f32 v14, v14
    v_exp_f32 v15, v15
    v_exp_f32 v48, v48
    v_cvt_pk_bf16_f32 v60, v14, v15
    v_exp_f32 v49, v49
    v_exp_f32 v50, v50
    v_mfma_f32_16x16x16_bf16 v[96:99], v[104:105], v[60:61], 0
    v_exp_f32 v51, v51
    v_mfma_f32_16x16x16_bf16 v[88:91], v[108:109], v[60:61], 0
    v_exp_f32 v52, v52
    v_mfma_f32_16x16x16_bf16 v[92:95], v[110:111], v[60:61], 0
    v_exp_f32 v53, v53
    v_exp_f32 v54, v54
    v_exp_f32 v55, v55
    v_cvt_pk_bf16_f32 v56, v48, v49
    v_cvt_pk_bf16_f32 v57, v50, v51
    v_cvt_pk_bf16_f32 v58, v52, v53
    v_cvt_pk_bf16_f32 v59, v54, v55
    s_nop 1
    v_mfma_f32_16x16x32_bf16 v[96:99], v[104:107], v[56:59], v[96:99]
    v_mfma_f32_16x16x32_bf16 v[88:91], v[120:123], v[56:59], v[88:91]
    v_mfma_f32_16x16x32_bf16 v[92:95], v[124:127], v[56:59], v[92:95]
    v_rcp_f32 v96, v96
    s_nop 2
    v_mul_f32 v88, v88, v96
    v_mul_f32 v89, v89, v96
    v_mul_f32 v90, v90, v96
    v_mul_f32 v91, v91, v96
    v_cvt_pk_bf16_f32 v100, v88, v89
    v_cvt_pk_bf16_f32 v101, v90, v91
    v_pk_mul_f32 v[92:93], v[92:93], v[96:97] op_sel_hi:[1,0]
    v_pk_mul_f32 v[94:95], v[94:95], v[96:97] op_sel_hi:[1,0]
    v_cvt_pk_bf16_f32 v102, v92, v93
    v_cvt_pk_bf16_f32 v103, v94, v95
    ds_write_b128 v6, v[100:103]
    s_waitcnt lgkmcnt(0)
    s_barrier
    ds_read_b128 v[64:67], v1 offset:29184
    ds_read_b128 v[68:71], v1 offset:30208
    s_waitcnt lgkmcnt(1)
    v_smfmac_f32_16x16x64_bf16 v[16:19], v[64:67], v[168:175], v0
    v_smfmac_f32_16x16x64_bf16 v[20:23], v[64:67], v[80:87], v0
    ds_read_b128 v[80:83], v7 offset:16384
    s_waitcnt lgkmcnt(1)
    v_smfmac_f32_16x16x64_bf16 v[16:19], v[68:71], v[176:183], v0
    ds_read_b128 v[84:87], v7 offset:17408
    v_smfmac_f32_16x16x64_bf16 v[20:23], v[68:71], v[184:191], v0
    v_smfmac_f32_16x16x64_bf16 v[24:27], v[64:67], v[72:79], v0
    ds_read_b128 v[72:75], v7 offset:24576
    v_smfmac_f32_16x16x64_bf16 v[28:31], v[64:67], v[192:199], v0
    ds_read_b128 v[76:79], v7 offset:25600
    v_add_f32 v16, v16, v18
    v_add_f32 v17, v17, v19
    v_smfmac_f32_16x16x64_bf16 v[24:27], v[68:71], v[200:207], v0
    v_add_f32 v20, v20, v22
    v_add_f32 v21, v21, v23
    s_waitcnt lgkmcnt(2)
    v_smfmac_f32_16x16x64_bf16 v[28:31], v[68:71], v[80:87], v0
    ds_read_b128 v[80:83], v7 offset:32768
    v_cvt_pk_bf16_f32 v48, v16, v20
    v_cvt_pk_bf16_f32 v49, v17, v21
    v_smfmac_f32_16x16x64_bf16 v[32:35], v[64:67], v[208:215], v0
    ds_read_b128 v[84:87], v7 offset:33792
    v_smfmac_f32_16x16x64_bf16 v[36:39], v[64:67], v[216:223], v0
    v_add_f32 v24, v24, v26
    v_add_f32 v25, v25, v27
    s_waitcnt lgkmcnt(2)
    v_smfmac_f32_16x16x64_bf16 v[32:35], v[68:71], v[72:79], v0
    ds_read_b128 v[72:75], v7 offset:49152
    v_add_f32 v28, v28, v30
    v_add_f32 v29, v29, v31
    v_smfmac_f32_16x16x64_bf16 v[36:39], v[68:71], v[224:231], v0
    ds_read_b128 v[76:79], v7 offset:50176
    v_cvt_pk_bf16_f32 v51, v25, v29
    v_and_b32 v51, -2, v51
    v_smfmac_f32_16x16x64_bf16 v[40:43], v[64:67], v[232:239], v0
    v_cvt_pk_bf16_f32 v50, v24, v28
    s_waitcnt lgkmcnt(2)
    v_smfmac_f32_16x16x64_bf16 v[44:47], v[64:67], v[80:87], v0
    ds_read_b128 v[80:83], v7 offset:57344
    buffer_store_dwordx4 v[48:51], v9, s[28:31], s60 offen
    v_add_f32 v32, v32, v34
    v_add_f32 v33, v33, v35
    v_smfmac_f32_16x16x64_bf16 v[40:43], v[68:71], v[240:247], v0
    ds_read_b128 v[84:87], v7 offset:58368
    v_add_f32 v36, v36, v38
    v_add_f32 v37, v37, v39
    v_smfmac_f32_16x16x64_bf16 v[44:47], v[68:71], v[248:255], v0
    v_cvt_pk_bf16_f32 v52, v32, v36
    v_cvt_pk_bf16_f32 v53, v33, v37
    s_nop 1
    v_add_f32 v40, v40, v42
    v_add_f32 v41, v41, v43
    s_nop 1
    v_add_f32 v44, v44, v46
    v_add_f32 v45, v45, v47
    v_cvt_pk_bf16_f32 v55, v41, v45
    v_and_b32 v55, -2, v55
    v_cvt_pk_bf16_f32 v54, v40, v44
    buffer_store_dwordx4 v[52:55], v9, s[28:31], s61 offen
    s_movk_i32 s52, 0x3f80
    v_lshlrev_b32 v28, v1, s52
    v_cndmask_b32 v24, 0, v28, s[80:81]
    v_cndmask_b32 v25, 0, v28, s[82:83]
    v_cndmask_b32 v26, 0, v28, s[84:85]
    v_cndmask_b32 v27, 0, v28, s[86:87]
    ds_read_b128 v[92:95], v4
    v_mov_b64 v[48:49], 0
    v_mov_b64 v[50:51], 0
    v_mov_b64 v[52:53], 0
    v_mov_b64 v[54:55], 0
    v_mov_b64 v[56:57], 0
    v_mov_b64 v[58:59], 0
    v_mov_b64 v[60:61], 0
    v_mov_b64 v[62:63], 0
    v_mov_b64 v[64:65], 0
    v_mov_b64 v[66:67], 0
    v_mov_b64 v[68:69], 0
    v_mov_b64 v[70:71], 0
    s_mov_b32 s52, 0
    s_mov_b32 s53, 8192
    s_mov_b32 s54, 442368
    s_mov_b32 s55, 446464
    v_mov_b32 v13, -1
    s_sleep 2
    buffer_load_dwordx4 v[16:19], v1, s[28:31], s64 offen sc1
    buffer_load_dwordx4 v[20:23], v1, s[28:31], s65 offen sc1
    s_sleep 2
    buffer_load_dwordx4 v[16:19], v1, s[28:31], s64 offen sc1
    buffer_load_dwordx4 v[20:23], v1, s[28:31], s65 offen sc1
    s_branch pd_17
pl_16:
    s_mov_b64 exec, vcc
    buffer_load_dwordx4 v[16:19], v1, s[28:31], s64 offen sc1
    buffer_load_dwordx4 v[20:23], v1, s[28:31], s65 offen sc1
    s_mov_b64 exec, -1
    s_sub_u32 s79, s79, 1
    s_cbranch_scc1 L_abort
pd_17:
    s_waitcnt vmcnt(2)
    v_bitop3_b32 v12, v19, v23, 1 bitop3:0xa8
    v_cmp_ne_u32 vcc, 0, v12
    s_cbranch_vccnz pl_16
    v_mfma_f32_16x16x32_bf16 v[28:31], v[16:19], v[24:27], 0
    v_mfma_f32_16x16x32_bf16 v[28:31], v[20:23], v[24:27], v[28:31]
    s_nop 7
    v_permlane32_swap_b32 v28, v29
    v_permlane32_swap_b32 v30, v31
    v_add_f32 v28, v28, v29
    v_add_f32 v30, v30, v31
    s_nop 1
    v_permlane16_swap_b32 v28, v30
    v_add_f32 v28, v28, v30
    s_nop 1
    v_mov_b32_dpp v29, v28 row_shl:1 row_mask:0xf bank_mask:0xf
    v_cvt_pk_bf16_f32 v28, v28, v29
    v_min_u32 v28, -2, v28
    s_mov_b64 exec, s[74:75]
    buffer_store_dword v28, v11, s[28:31], s52 offen
    buffer_store_dword v13, v11, s[28:31], s53 offen
    s_mov_b64 exec, -1
    s_add_u32 s50, s50, 1
    s_cmp_ge_u32 s59, 64
    s_cbranch_scc1 fr_18
    v_bfe_u32 v14, v1, 4, 2
    v_lshl_add_u32 v10, v10, 2, v14
    s_nop 1
    v_min_u32_dpp v10, v10, v10 row_ror:1 row_mask:0xf bank_mask:0xf
    s_nop 1
    v_min_u32_dpp v10, v10, v10 row_ror:2 row_mask:0xf bank_mask:0xf
    s_nop 1
    v_min_u32_dpp v10, v10, v10 row_ror:4 row_mask:0xf bank_mask:0xf
    s_nop 1
    v_min_u32_dpp v10, v10, v10 row_ror:8 row_mask:0xf bank_mask:0xf
    s_nop 0
    v_readfirstlane_b32 s92, v10
    s_nop 0
    s_max_u32 s59, s59, s92
    s_add_u32 s92, s50, 1
    s_min_u32 s92, s92, 63
    s_cmp_lt_u32 s92, s59
    s_cbranch_scc1 kvok_19
    v_mbcnt_lo_u32_b32 v36, -1, 0
    v_mbcnt_hi_u32_b32 v36, -1, v36
    v_and_b32 v36, 3, v36
    v_lshrrev_b32 v37, 1, v36
    v_lshlrev_b32 v37, 6, v37
    v_and_b32 v36, 1, v36
    v_add_u32 v36, v36, v37
    s_lshl_b32 s93, s49, 1
    v_add_u32 v36, s93, v36
    v_lshlrev_b32 v36, 4, v36
    s_nop 1
kvlp_20:
    s_sub_u32 s79, s79, 1
    s_cbranch_scc1 L_abort
    buffer_load_dwordx4 v[32:35], v36, s[28:31], 0 offen offset:0 sc1
    s_waitcnt vmcnt(0)
    v_lshlrev_b32 v32, 2, v32
    v_lshl_add_u32 v33, v33, 2, 1
    v_lshl_add_u32 v34, v34, 2, 2
    v_lshl_add_u32 v35, v35, 2, 3
    v_min3_u32 v32, v32, v33, v34
    v_min_u32 v32, v32, v35
    s_nop 0
    v_readlane_b32 s59, v32, 0
    v_readlane_b32 s93, v32, 1
    s_nop 0
    s_min_u32 s59, s59, s93
    v_readlane_b32 s93, v32, 2
    s_nop 0
    s_min_u32 s59, s59, s93
    v_readlane_b32 s93, v32, 3
    s_nop 0
    s_min_u32 s59, s59, s93
    s_cmp_lt_u32 s92, s59
    s_nop 1
    s_cbranch_scc0 kvlp_20
kvok_19:
fr_18:
    v_bfe_u32 v10, v1, 4, 3
    v_bfe_u32 v14, v1, 7, 1
    v_lshlrev_b32 v10, 2, v10
    v_lshl_add_u32 v10, v14, 10, v10
    s_lshl_b32 s92, s49, 5
    s_add_u32 s92, s92, 0
    v_add_u32 v10, s92, v10
    v_add_u32 v104, s88, v1
    v_add_u32 v105, s89, v1
    v_add_u32 v106, s90, v1
    ds_read_b128 v[24:27], v8 offset:16384
    ds_read_b128 v[28:31], v8 offset:17408
    ds_read_b128 v[32:35], v8 offset:24576
    ds_read_b128 v[36:39], v8 offset:25600
    ds_read_b128 v[40:43], v8 offset:32768
    ds_read_b128 v[44:47], v8 offset:33792
    ds_read_b128 v[96:99], v8 offset:40960
    ds_read_b128 v[100:103], v8 offset:41984
    s_sleep 1
    buffer_load_dwordx4 v[16:19], v2, s[28:31], s54 offen sc1
    buffer_load_dwordx4 v[20:23], v2, s[28:31], s55 offen sc1
    s_sleep 2
    buffer_load_dwordx4 v[16:19], v2, s[28:31], s54 offen sc1
    buffer_load_dwordx4 v[20:23], v2, s[28:31], s55 offen sc1
    s_cmp_eq_u32 s50, 63
    s_cbranch_scc1 fin_10
    s_branch t0_13
tl_21:
    s_mov_b64 exec, vcc
    buffer_load_dwordx4 v[16:19], v2, s[28:31], s54 offen sc1
    buffer_load_dwordx4 v[20:23], v2, s[28:31], s55 offen sc1
    s_mov_b64 exec, -1
    s_sub_u32 s79, s79, 1
    s_cbranch_scc1 L_abort
t0_13:
    s_waitcnt vmcnt(2) lgkmcnt(0)
    v_max3_u32 v12, v16, v17, v18
    v_max3_u32 v14, v19, v20, v21
    v_max3_u32 v12, v12, v22, v23
    v_max_u32 v12, v12, v14
    v_cmp_eq_u32 vcc, -1, v12
    s_cbranch_vccnz tl_21
    v_smfmac_f32_16x16x64_bf16 v[48:51], v[16:19], v[24:31], v0
    ds_write_b128 v2, v[16:19]
    v_smfmac_f32_16x16x64_bf16 v[52:55], v[16:19], v[32:39], v0
    ds_write_b128 v2, v[20:23] offset:4096
    v_smfmac_f32_16x16x64_bf16 v[48:51], v[20:23], v[40:47], v0
    s_mov_b32 m0, s72
    s_add_u32 s54, s68, 16777216
    v_smfmac_f32_16x16x64_bf16 v[52:55], v[20:23], v[96:103], v0
    buffer_load_dwordx4 v1, s[28:31], s68 offen sc1 lds
    v_smfmac_f32_16x16x64_bf16 v[56:59], v[16:19], v[72:79], v0
    ds_read_b128 v[72:75], v8 offset:49152
    buffer_load_dwordx4 v1, s[28:31], s68 offen offset:1024 sc1 lds
    v_smfmac_f32_16x16x64_bf16 v[60:63], v[16:19], v[80:87], v0
    ds_read_b128 v[80:83], v8 offset:57344
    v_smfmac_f32_16x16x64_bf16 v[56:59], v[20:23], a[80:87], v0
    v_smfmac_f32_16x16x64_bf16 v[60:63], v[20:23], a[88:95], v0
    s_waitcnt lgkmcnt(2)
    s_barrier
    v_smfmac_f32_16x16x64_bf16 v[64:67], v[16:19], a[176:183], v0
    ds_read_b128 v[24:27], v104 offset:16384
    ds_read_b128 v[28:31], v104 offset:20480
    v_smfmac_f32_16x16x64_bf16 v[68:71], v[16:19], a[184:191], v0
    ds_read_b128 v[32:35], v105 offset:16384
    ds_read_b128 v[36:39], v105 offset:20480
    v_smfmac_f32_16x16x64_bf16 v[64:67], v[20:23], a[192:199], v0
    ds_read_b128 v[40:43], v106 offset:16384
    ds_read_b128 v[44:47], v106 offset:20480
    v_smfmac_f32_16x16x64_bf16 v[68:71], v[20:23], a[200:207], v0
    s_waitcnt lgkmcnt(5)
    v_smfmac_f32_16x16x64_bf16 v[48:51], v[24:27], a[0:7], v0
    ds_read_b128 v[76:79], v8 offset:50176
    buffer_load_dwordx4 v[120:123], v1, s[28:31], s54 offen sc1
    v_smfmac_f32_16x16x64_bf16 v[52:55], v[24:27], a[8:15], v0
    ds_read_b128 v[84:87], v8 offset:58368
    s_waitcnt lgkmcnt(6)
    v_smfmac_f32_16x16x64_bf16 v[48:51], v[28:31], a[16:23], v0
    s_add_u32 s68, s68, 262144
    v_smfmac_f32_16x16x64_bf16 v[52:55], v[28:31], a[24:31], v0
    buffer_load_dwordx4 v[124:127], v1, s[28:31], s54 offen offset:1024 sc1
    s_waitcnt lgkmcnt(5)
    v_smfmac_f32_16x16x64_bf16 v[48:51], v[32:35], a[32:39], v0
    v_smfmac_f32_16x16x64_bf16 v[52:55], v[32:35], a[40:47], v0
    s_sub_u32 s53, s50, 1
    s_max_i32 s53, s53, 0
    v_mov_b32 v14, s53
    s_waitcnt lgkmcnt(4)
    s_waitcnt lgkmcnt(1)
    v_smfmac_f32_16x16x64_bf16 v[48:51], v[36:39], v[72:79], v0
    ds_read_b128 v[72:75], v8 offset:0
    v_mov_b32 v15, 24576
    v_smfmac_f32_16x16x64_bf16 v[52:55], v[36:39], a[48:55], v0
    ds_read_b128 v[76:79], v8 offset:1024
    s_mov_b64 exec, s[62:63]
    buffer_store_dword v14, v15, s[28:31], s66 offen sc1
    s_mov_b64 exec, -1
    v_smfmac_f32_16x16x64_bf16 v[48:51], v[40:43], a[56:63], v0
    buffer_load_dword v10, v10, s[28:31], 0 offen sc1
    v_smfmac_f32_16x16x64_bf16 v[52:55], v[40:43], a[64:71], v0
    v_smfmac_f32_16x16x64_bf16 v[48:51], v[44:47], a[72:79], v0
    buffer_store_dwordx4 v[92:95], v1, s[28:31], s69 offen sc1
    s_waitcnt lgkmcnt(2)
    v_smfmac_f32_16x16x64_bf16 v[52:55], v[44:47], v[80:87], v0
    ds_read_b128 v[80:83], v8 offset:8192
    v_smfmac_f32_16x16x64_bf16 v[56:59], v[24:27], a[96:103], v0
    ds_read_b128 v[84:87], v8 offset:9216
    v_smfmac_f32_16x16x64_bf16 v[60:63], v[24:27], a[104:111], v0
    s_add_u32 s55, s69, 9437184
    v_smfmac_f32_16x16x64_bf16 v[56:59], v[28:31], a[112:119], v0
    buffer_store_dwordx4 v[108:111], v1, s[28:31], s55 offen sc1
    v_smfmac_f32_16x16x64_bf16 v[60:63], v[28:31], a[120:127], v0
    s_add_u32 s69, s69, 131072
    v_add_f32 v48, v48, v50
    v_smfmac_f32_16x16x64_bf16 v[56:59], v[32:35], a[128:135], v0
    v_add_f32 v52, v52, v54
    s_waitcnt lgkmcnt(2)
    v_smfmac_f32_16x16x64_bf16 v[60:63], v[32:35], v[72:79], v0
    ds_read_b128 v[72:75], v7 offset:40960
    v_add_f32 v49, v49, v51
    v_smfmac_f32_16x16x64_bf16 v[56:59], v[36:39], a[136:143], v0
    ds_read_b128 v[76:79], v7 offset:41984
    v_add_f32 v53, v53, v55
    v_smfmac_f32_16x16x64_bf16 v[60:63], v[36:39], a[144:151], v0
    v_cvt_pk_bf16_f32 v48, v48, v52
    v_smfmac_f32_16x16x64_bf16 v[56:59], v[40:43], a[152:159], v0
    v_cvt_pk_bf16_f32 v49, v49, v53
    v_smfmac_f32_16x16x64_bf16 v[60:63], v[40:43], a[160:167], v0
    ds_write2_b32 v3, v48, v49 offset0:0 offset1:16
    v_smfmac_f32_16x16x64_bf16 v[56:59], v[44:47], a[168:175], v0
    s_waitcnt vmcnt(8)
    s_waitcnt lgkmcnt(3)
    v_smfmac_f32_16x16x64_bf16 v[60:63], v[44:47], v[80:87], v0
    ds_read_b128 v[80:83], v7 offset:0
    ds_read_b128 v[16:19], v1 offset:8192
    ds_read_b128 v[20:23], v1 offset:12288
    ds_read_b128 v[104:107], v1 offset:9216
    v_smfmac_f32_16x16x64_bf16 v[64:67], v[24:27], a[208:215], v0
    ds_read_b128 v[84:87], v7 offset:1024
    ds_read_b128 v[12:15], v1 offset:13312
    v_smfmac_f32_16x16x64_bf16 v[68:71], v[24:27], a[216:223], v0
    v_add_f32 v56, v56, v58
    v_add_f32 v60, v60, v62
    v_smfmac_f32_16x16x64_bf16 v[64:67], v[28:31], a[224:231], v0
    v_add_f32 v57, v57, v59
    v_add_f32 v61, v61, v63
    v_smfmac_f32_16x16x64_bf16 v[68:71], v[28:31], a[232:239], v0
    v_cvt_pk_bf16_f32 v56, v56, v60
    v_cvt_pk_bf16_f32 v57, v57, v61
    v_smfmac_f32_16x16x64_bf16 v[64:67], v[32:35], a[240:247], v0
    ds_write2_b32 v3, v56, v57 offset0:32 offset1:48
    v_smfmac_f32_16x16x64_bf16 v[68:71], v[32:35], a[248:255], v0
    ds_read_b128 v[24:27], v1 offset:10240
    s_waitcnt lgkmcnt(9)
    v_smfmac_f32_16x16x64_bf16 v[64:67], v[36:39], v[72:79], v0
    ds_read_b128 v[72:75], v7 offset:8192
    ds_read_b128 v[28:31], v1 offset:14336
    v_smfmac_f32_16x16x64_bf16 v[68:71], v[36:39], v[128:135], v0
    ds_read_b128 v[76:79], v7 offset:9216
    v_smfmac_f32_16x16x64_bf16 v[64:67], v[40:43], v[136:143], v0
    s_waitcnt lgkmcnt(4)
    s_barrier
    v_smfmac_f32_16x16x64_bf16 v[68:71], v[40:43], v[144:151], v0
    ds_read_b128 v[88:91], v5 offset:0
    ds_read_b128 v[92:95], v5 offset:1088
    v_smfmac_f32_16x16x64_bf16 v[64:67], v[44:47], v[152:159], v0
    ds_read_b128 v[96:99], v5 offset:2176
    ds_read_b128 v[100:103], v5 offset:3264
    v_smfmac_f32_16x16x64_bf16 v[68:71], v[44:47], v[160:167], v0
    ds_read_b128 v[56:59], v1 offset:11264
    ds_read_b128 v[60:63], v1 offset:15360
    s_waitcnt lgkmcnt(5)
    v_mfma_f32_16x16x32_bf16 v[48:51], v[16:19], v[88:91], 0
    v_mfma_f32_16x16x32_bf16 v[52:55], v[20:23], v[88:91], 0
    s_waitcnt lgkmcnt(4)
    v_mfma_f32_16x16x32_bf16 v[48:51], v[104:107], v[92:95], v[48:51]
    v_add_f32 v64, v64, v66
    v_add_f32 v65, v65, v67
    v_mfma_f32_16x16x32_bf16 v[52:55], v[12:15], v[92:95], v[52:55]
    v_add_f32 v68, v68, v70
    v_add_f32 v69, v69, v71
    v_mfma_f32_16x16x32_bf16 v[12:15], v[88:91], v[88:91], 0
    v_cvt_pk_bf16_f32 v108, v64, v65
    v_cvt_pk_bf16_f32 v110, v68, v69
    v_mfma_f32_16x16x32_bf16 v[12:15], v[92:95], v[92:95], v[12:15]
    v_mov_b32 v109, 0
    v_mov_b32 v111, 0
    s_waitcnt lgkmcnt(3)
    v_mfma_f32_16x16x32_bf16 v[48:51], v[24:27], v[96:99], v[48:51]
    v_mov_b64 v[104:105], s[94:95]
    v_mov_b64 v[106:107], s[94:95]
    v_mfma_f32_16x16x32_bf16 v[52:55], v[28:31], v[96:99], v[52:55]
    v_mov_b64 v[32:33], 0
    v_mov_b64 v[34:35], 0
    v_mfma_f32_16x16x32_bf16 v[12:15], v[96:99], v[96:99], v[12:15]
    v_mov_b64 v[36:37], 0
    v_mov_b64 v[38:39], 0
    s_waitcnt lgkmcnt(2)
    v_mfma_f32_16x16x32_bf16 v[12:15], v[100:103], v[100:103], v[12:15]
    v_mov_b64 v[40:41], 0
    v_mov_b64 v[42:43], 0
    s_waitcnt lgkmcnt(1)
    v_mfma_f32_16x16x32_bf16 v[48:51], v[56:59], v[100:103], v[48:51]
    v_mov_b64 v[44:45], 0
    v_mov_b64 v[46:47], 0
    s_waitcnt lgkmcnt(0)
    v_mfma_f32_16x16x32_bf16 v[52:55], v[60:63], v[100:103], v[52:55]
    v_mov_b64 v[16:17], 0
    v_mov_b64 v[18:19], 0
    v_mov_b64 v[20:21], 0
    v_mov_b64 v[22:23], 0
    v_mov_b64 v[24:25], 0
    v_mov_b64 v[26:27], 0
    v_mov_b64 v[28:29], 0
    v_mov_b64 v[30:31], 0
    v_max_f32 v12, v14, v15
    v_max3_f32 v62, v12, v48, v49
    v_max3_f32 v62, v62, v50, v51
    v_max3_f32 v62, v62, v52, v53
    v_max3_f32 v62, v62, v54, v55
    v_mov_b32 v63, v62
    v_mov_b32 v61, 0
    s_nop 0
    v_permlane32_swap_b32 v63, v62
    v_max_f32 v62, v62, v63
    v_mov_b32 v63, v62
    s_nop 1
    v_permlane16_swap_b32 v63, v62
    v_max_f32 v62, v62, v63
    v_mul_f32 v62, s56, v62
    v_pk_fma_f32 v[14:15], v[14:15], s[76:77], v[62:63] op_sel_hi:[1,1,0] neg_lo:[0,0,1] neg_hi:[0,0,1]
    v_pk_fma_f32 v[48:49], v[48:49], s[76:77], v[62:63] op_sel_hi:[1,1,0] neg_lo:[0,0,1] neg_hi:[0,0,1]
    v_pk_fma_f32 v[50:51], v[50:51], s[76:77], v[62:63] op_sel_hi:[1,1,0] neg_lo:[0,0,1] neg_hi:[0,0,1]
    v_pk_fma_f32 v[52:53], v[52:53], s[76:77], v[62:63] op_sel_hi:[1,1,0] neg_lo:[0,0,1] neg_hi:[0,0,1]
    v_pk_fma_f32 v[54:55], v[54:55], s[76:77], v[62:63] op_sel_hi:[1,1,0] neg_lo:[0,0,1] neg_hi:[0,0,1]
    v_exp_f32 v14, v14
    v_exp_f32 v15, v15
    v_exp_f32 v48, v48
    v_cvt_pk_bf16_f32 v60, v14, v15
    v_exp_f32 v49, v49
    v_exp_f32 v50, v50
    v_mfma_f32_16x16x16_bf16 v[96:99], v[104:105], v[60:61], 0
    v_exp_f32 v51, v51
    v_mfma_f32_16x16x16_bf16 v[88:91], v[108:109], v[60:61], 0
    v_exp_f32 v52, v52
    v_mfma_f32_16x16x16_bf16 v[92:95], v[110:111], v[60:61], 0
    v_exp_f32 v53, v53
    v_exp_f32 v54, v54
    v_exp_f32 v55, v55
    v_cvt_pk_bf16_f32 v56, v48, v49
    v_cvt_pk_bf16_f32 v57, v50, v51
    v_cvt_pk_bf16_f32 v58, v52, v53
    v_cvt_pk_bf16_f32 v59, v54, v55
    s_nop 1
    v_mfma_f32_16x16x32_bf16 v[96:99], v[104:107], v[56:59], v[96:99]
    v_mfma_f32_16x16x32_bf16 v[88:91], v[112:115], v[56:59], v[88:91]
    v_mfma_f32_16x16x32_bf16 v[92:95], v[116:119], v[56:59], v[92:95]
    v_rcp_f32 v96, v96
    s_nop 2
    v_mul_f32 v88, v88, v96
    v_mul_f32 v89, v89, v96
    v_mul_f32 v90, v90, v96
    v_mul_f32 v91, v91, v96
    v_cvt_pk_bf16_f32 v100, v88, v89
    v_cvt_pk_bf16_f32 v101, v90, v91
    v_pk_mul_f32 v[92:93], v[92:93], v[96:97] op_sel_hi:[1,0]
    v_pk_mul_f32 v[94:95], v[94:95], v[96:97] op_sel_hi:[1,0]
    v_cvt_pk_bf16_f32 v102, v92, v93
    v_cvt_pk_bf16_f32 v103, v94, v95
    ds_write_b128 v6, v[100:103]
    s_waitcnt lgkmcnt(0)
    s_barrier
    ds_read_b128 v[64:67], v1 offset:29184
    ds_read_b128 v[68:71], v1 offset:30208
    s_waitcnt lgkmcnt(1)
    v_smfmac_f32_16x16x64_bf16 v[16:19], v[64:67], v[168:175], v0
    v_smfmac_f32_16x16x64_bf16 v[20:23], v[64:67], v[80:87], v0
    ds_read_b128 v[80:83], v7 offset:16384
    s_waitcnt lgkmcnt(1)
    v_smfmac_f32_16x16x64_bf16 v[16:19], v[68:71], v[176:183], v0
    ds_read_b128 v[84:87], v7 offset:17408
    v_smfmac_f32_16x16x64_bf16 v[20:23], v[68:71], v[184:191], v0
    v_smfmac_f32_16x16x64_bf16 v[24:27], v[64:67], v[72:79], v0
    ds_read_b128 v[72:75], v7 offset:24576
    v_smfmac_f32_16x16x64_bf16 v[28:31], v[64:67], v[192:199], v0
    ds_read_b128 v[76:79], v7 offset:25600
    v_add_f32 v16, v16, v18
    v_add_f32 v17, v17, v19
    v_smfmac_f32_16x16x64_bf16 v[24:27], v[68:71], v[200:207], v0
    v_add_f32 v20, v20, v22
    v_add_f32 v21, v21, v23
    s_waitcnt lgkmcnt(2)
    v_smfmac_f32_16x16x64_bf16 v[28:31], v[68:71], v[80:87], v0
    ds_read_b128 v[80:83], v7 offset:32768
    v_cvt_pk_bf16_f32 v48, v16, v20
    v_cvt_pk_bf16_f32 v49, v17, v21
    v_smfmac_f32_16x16x64_bf16 v[32:35], v[64:67], v[208:215], v0
    ds_read_b128 v[84:87], v7 offset:33792
    v_smfmac_f32_16x16x64_bf16 v[36:39], v[64:67], v[216:223], v0
    v_add_f32 v24, v24, v26
    v_add_f32 v25, v25, v27
    s_waitcnt lgkmcnt(2)
    v_smfmac_f32_16x16x64_bf16 v[32:35], v[68:71], v[72:79], v0
    ds_read_b128 v[72:75], v7 offset:49152
    v_add_f32 v28, v28, v30
    v_add_f32 v29, v29, v31
    v_smfmac_f32_16x16x64_bf16 v[36:39], v[68:71], v[224:231], v0
    ds_read_b128 v[76:79], v7 offset:50176
    v_cvt_pk_bf16_f32 v51, v25, v29
    v_or_b32 v51, 1, v51
    v_smfmac_f32_16x16x64_bf16 v[40:43], v[64:67], v[232:239], v0
    v_cvt_pk_bf16_f32 v50, v24, v28
    s_waitcnt lgkmcnt(2)
    v_smfmac_f32_16x16x64_bf16 v[44:47], v[64:67], v[80:87], v0
    ds_read_b128 v[80:83], v7 offset:57344
    buffer_store_dwordx4 v[48:51], v9, s[28:31], s60 offen
    v_add_f32 v32, v32, v34
    v_add_f32 v33, v33, v35
    v_smfmac_f32_16x16x64_bf16 v[40:43], v[68:71], v[240:247], v0
    ds_read_b128 v[84:87], v7 offset:58368
    v_add_f32 v36, v36, v38
    v_add_f32 v37, v37, v39
    v_smfmac_f32_16x16x64_bf16 v[44:47], v[68:71], v[248:255], v0
    v_cvt_pk_bf16_f32 v52, v32, v36
    v_cvt_pk_bf16_f32 v53, v33, v37
    s_nop 1
    v_add_f32 v40, v40, v42
    v_add_f32 v41, v41, v43
    s_nop 1
    v_add_f32 v44, v44, v46
    v_add_f32 v45, v45, v47
    v_cvt_pk_bf16_f32 v55, v41, v45
    v_or_b32 v55, 1, v55
    v_cvt_pk_bf16_f32 v54, v40, v44
    buffer_store_dwordx4 v[52:55], v9, s[28:31], s61 offen
    s_movk_i32 s52, 0x3f80
    v_lshlrev_b32 v28, v1, s52
    v_cndmask_b32 v24, 0, v28, s[80:81]
    v_cndmask_b32 v25, 0, v28, s[82:83]
    v_cndmask_b32 v26, 0, v28, s[84:85]
    v_cndmask_b32 v27, 0, v28, s[86:87]
    ds_read_b128 v[92:95], v4
    v_mov_b64 v[48:49], 0
    v_mov_b64 v[50:51], 0
    v_mov_b64 v[52:53], 0
    v_mov_b64 v[54:55], 0
    v_mov_b64 v[56:57], 0
    v_mov_b64 v[58:59], 0
    v_mov_b64 v[60:61], 0
    v_mov_b64 v[62:63], 0
    v_mov_b64 v[64:65], 0
    v_mov_b64 v[66:67], 0
    v_mov_b64 v[68:69], 0
    v_mov_b64 v[70:71], 0
    s_mov_b32 s52, 8192
    s_mov_b32 s53, 0
    s_mov_b32 s54, 450560
    s_mov_b32 s55, 454656
    v_mov_b32 v13, -1
    s_sleep 2
    buffer_load_dwordx4 v[16:19], v1, s[28:31], s64 offen sc1
    buffer_load_dwordx4 v[20:23], v1, s[28:31], s65 offen sc1
    s_sleep 2
    buffer_load_dwordx4 v[16:19], v1, s[28:31], s64 offen sc1
    buffer_load_dwordx4 v[20:23], v1, s[28:31], s65 offen sc1
    s_branch pd_23
pl_22:
    s_mov_b64 exec, vcc
    buffer_load_dwordx4 v[16:19], v1, s[28:31], s64 offen sc1
    buffer_load_dwordx4 v[20:23], v1, s[28:31], s65 offen sc1
    s_mov_b64 exec, -1
    s_sub_u32 s79, s79, 1
    s_cbranch_scc1 L_abort
pd_23:
    s_waitcnt vmcnt(2)
    v_bitop3_b32 v12, v19, v23, 1 bitop3:0x80
    v_cmp_ne_u32 vcc, 1, v12
    s_cbranch_vccnz pl_22
    v_mfma_f32_16x16x32_bf16 v[28:31], v[16:19], v[24:27], 0
    v_mfma_f32_16x16x32_bf16 v[28:31], v[20:23], v[24:27], v[28:31]
    s_nop 7
    v_permlane32_swap_b32 v28, v29
    v_permlane32_swap_b32 v30, v31
    v_add_f32 v28, v28, v29
    v_add_f32 v30, v30, v31
    s_nop 1
    v_permlane16_swap_b32 v28, v30
    v_add_f32 v28, v28, v30
    s_nop 1
    v_mov_b32_dpp v29, v28 row_shl:1 row_mask:0xf bank_mask:0xf
    v_cvt_pk_bf16_f32 v28, v28, v29
    v_min_u32 v28, -2, v28
    s_mov_b64 exec, s[74:75]
    buffer_store_dword v28, v11, s[28:31], s52 offen
    buffer_store_dword v13, v11, s[28:31], s53 offen
    s_mov_b64 exec, -1
    s_add_u32 s50, s50, 1
    s_cmp_ge_u32 s59, 64
    s_cbranch_scc1 fr_24
    v_bfe_u32 v14, v1, 4, 2
    v_lshl_add_u32 v10, v10, 2, v14
    s_nop 1
    v_min_u32_dpp v10, v10, v10 row_ror:1 row_mask:0xf bank_mask:0xf
    s_nop 1
    v_min_u32_dpp v10, v10, v10 row_ror:2 row_mask:0xf bank_mask:0xf
    s_nop 1
    v_min_u32_dpp v10, v10, v10 row_ror:4 row_mask:0xf bank_mask:0xf
    s_nop 1
    v_min_u32_dpp v10, v10, v10 row_ror:8 row_mask:0xf bank_mask:0xf
    s_nop 0
    v_readfirstlane_b32 s92, v10
    s_nop 0
    s_max_u32 s59, s59, s92
    s_add_u32 s92, s50, 1
    s_min_u32 s92, s92, 63
    s_cmp_lt_u32 s92, s59
    s_cbranch_scc1 kvok_25
    v_mbcnt_lo_u32_b32 v36, -1, 0
    v_mbcnt_hi_u32_b32 v36, -1, v36
    v_and_b32 v36, 3, v36
    v_lshrrev_b32 v37, 1, v36
    v_lshlrev_b32 v37, 6, v37
    v_and_b32 v36, 1, v36
    v_add_u32 v36, v36, v37
    s_lshl_b32 s93, s49, 1
    v_add_u32 v36, s93, v36
    v_lshlrev_b32 v36, 4, v36
    s_nop 1
kvlp_26:
    s_sub_u32 s79, s79, 1
    s_cbranch_scc1 L_abort
    buffer_load_dwordx4 v[32:35], v36, s[28:31], 0 offen offset:0 sc1
    s_waitcnt vmcnt(0)
    v_lshlrev_b32 v32, 2, v32
    v_lshl_add_u32 v33, v33, 2, 1
    v_lshl_add_u32 v34, v34, 2, 2
    v_lshl_add_u32 v35, v35, 2, 3
    v_min3_u32 v32, v32, v33, v34
    v_min_u32 v32, v32, v35
    s_nop 0
    v_readlane_b32 s59, v32, 0
    v_readlane_b32 s93, v32, 1
    s_nop 0
    s_min_u32 s59, s59, s93
    v_readlane_b32 s93, v32, 2
    s_nop 0
    s_min_u32 s59, s59, s93
    v_readlane_b32 s93, v32, 3
    s_nop 0
    s_min_u32 s59, s59, s93
    s_cmp_lt_u32 s92, s59
    s_nop 1
    s_cbranch_scc0 kvlp_26
kvok_25:
fr_24:
    v_bfe_u32 v10, v1, 4, 3
    v_bfe_u32 v14, v1, 7, 1
    v_lshlrev_b32 v10, 2, v10
    v_lshl_add_u32 v10, v14, 10, v10
    s_lshl_b32 s92, s49, 5
    s_add_u32 s92, s92, 0
    v_add_u32 v10, s92, v10
    v_add_u32 v104, s88, v1
    v_add_u32 v105, s89, v1
    v_add_u32 v106, s90, v1
    ds_read_b128 v[24:27], v8 offset:16384
    ds_read_b128 v[28:31], v8 offset:17408
    ds_read_b128 v[32:35], v8 offset:24576
    ds_read_b128 v[36:39], v8 offset:25600
    ds_read_b128 v[40:43], v8 offset:32768
    ds_read_b128 v[44:47], v8 offset:33792
    ds_read_b128 v[96:99], v8 offset:40960
    ds_read_b128 v[100:103], v8 offset:41984
    s_sleep 1
    buffer_load_dwordx4 v[16:19], v2, s[28:31], s54 offen sc1
    buffer_load_dwordx4 v[20:23], v2, s[28:31], s55 offen sc1
    s_sleep 2
    buffer_load_dwordx4 v[16:19], v2, s[28:31], s54 offen sc1
    buffer_load_dwordx4 v[20:23], v2, s[28:31], s55 offen sc1
    s_branch t1_14
tl_29:
    s_mov_b64 exec, vcc
    buffer_load_dwordx4 v[16:19], v2, s[28:31], s54 offen sc1
    buffer_load_dwordx4 v[20:23], v2, s[28:31], s55 offen sc1
    s_mov_b64 exec, -1
    s_sub_u32 s79, s79, 1
    s_cbranch_scc1 L_abort
t1_28:
    s_waitcnt vmcnt(2) lgkmcnt(0)
    v_max3_u32 v12, v16, v17, v18
    v_max3_u32 v14, v19, v20, v21
    v_max3_u32 v12, v12, v22, v23
    v_max_u32 v12, v12, v14
    v_cmp_eq_u32 vcc, -1, v12
    s_cbranch_vccnz tl_29
ent_12:
    v_smfmac_f32_16x16x64_bf16 v[48:51], v[16:19], v[24:31], v0
    ds_write_b128 v2, v[16:19]
    v_smfmac_f32_16x16x64_bf16 v[52:55], v[16:19], v[32:39], v0
    ds_write_b128 v2, v[20:23] offset:4096
    v_smfmac_f32_16x16x64_bf16 v[48:51], v[20:23], v[40:47], v0
    s_mov_b32 m0, s73
    s_add_u32 s54, s68, 16777216
    v_smfmac_f32_16x16x64_bf16 v[52:55], v[20:23], v[96:103], v0
    buffer_load_dwordx4 v1, s[28:31], s68 offen sc1 lds
    v_smfmac_f32_16x16x64_bf16 v[56:59], v[16:19], v[72:79], v0
    ds_read_b128 v[72:75], v8 offset:49152
    buffer_load_dwordx4 v1, s[28:31], s68 offen offset:1024 sc1 lds
    v_smfmac_f32_16x16x64_bf16 v[60:63], v[16:19], v[80:87], v0
    ds_read_b128 v[80:83], v8 offset:57344
    v_smfmac_f32_16x16x64_bf16 v[56:59], v[20:23], a[80:87], v0
    v_smfmac_f32_16x16x64_bf16 v[60:63], v[20:23], a[88:95], v0
    s_waitcnt lgkmcnt(2)
    s_barrier
    v_smfmac_f32_16x16x64_bf16 v[64:67], v[16:19], a[176:183], v0
    ds_read_b128 v[24:27], v104 offset:16384
    ds_read_b128 v[28:31], v104 offset:20480
    v_smfmac_f32_16x16x64_bf16 v[68:71], v[16:19], a[184:191], v0
    ds_read_b128 v[32:35], v105 offset:16384
    ds_read_b128 v[36:39], v105 offset:20480
    v_smfmac_f32_16x16x64_bf16 v[64:67], v[20:23], a[192:199], v0
    ds_read_b128 v[40:43], v106 offset:16384
    ds_read_b128 v[44:47], v106 offset:20480
    v_smfmac_f32_16x16x64_bf16 v[68:71], v[20:23], a[200:207], v0
    s_waitcnt lgkmcnt(5)
    v_smfmac_f32_16x16x64_bf16 v[48:51], v[24:27], a[0:7], v0
    ds_read_b128 v[76:79], v8 offset:50176
    buffer_load_dwordx4 v[112:115], v1, s[28:31], s54 offen sc1
    v_smfmac_f32_16x16x64_bf16 v[52:55], v[24:27], a[8:15], v0
    ds_read_b128 v[84:87], v8 offset:58368
    s_waitcnt lgkmcnt(6)
    v_smfmac_f32_16x16x64_bf16 v[48:51], v[28:31], a[16:23], v0
    s_add_u32 s68, s68, 262144
    v_smfmac_f32_16x16x64_bf16 v[52:55], v[28:31], a[24:31], v0
    buffer_load_dwordx4 v[116:119], v1, s[28:31], s54 offen offset:1024 sc1
    s_waitcnt lgkmcnt(5)
    v_smfmac_f32_16x16x64_bf16 v[48:51], v[32:35], a[32:39], v0
    v_smfmac_f32_16x16x64_bf16 v[52:55], v[32:35], a[40:47], v0
    s_sub_u32 s53, s50, 1
    s_max_i32 s53, s53, 0
    v_mov_b32 v14, s53
    s_waitcnt lgkmcnt(4)
    s_waitcnt lgkmcnt(1)
    v_smfmac_f32_16x16x64_bf16 v[48:51], v[36:39], v[72:79], v0
    ds_read_b128 v[72:75], v8 offset:0
    v_mov_b32 v15, 24576
    v_smfmac_f32_16x16x64_bf16 v[52:55], v[36:39], a[48:55], v0
    ds_read_b128 v[76:79], v8 offset:1024
    s_mov_b64 exec, s[62:63]
    buffer_store_dword v14, v15, s[28:31], s66 offen sc1
    s_mov_b64 exec, -1
    v_smfmac_f32_16x16x64_bf16 v[48:51], v[40:43], a[56:63], v0
    buffer_load_dword v10, v10, s[28:31], 0 offen sc1
    v_smfmac_f32_16x16x64_bf16 v[52:55], v[40:43], a[64:71], v0
    v_smfmac_f32_16x16x64_bf16 v[48:51], v[44:47], a[72:79], v0
    buffer_store_dwordx4 v[92:95], v1, s[28:31], s69 offen sc1
    s_waitcnt lgkmcnt(2)
    v_smfmac_f32_16x16x64_bf16 v[52:55], v[44:47], v[80:87], v0
    ds_read_b128 v[80:83], v8 offset:8192
    v_smfmac_f32_16x16x64_bf16 v[56:59], v[24:27], a[96:103], v0
    ds_read_b128 v[84:87], v8 offset:9216
    v_smfmac_f32_16x16x64_bf16 v[60:63], v[24:27], a[104:111], v0
    s_add_u32 s55, s69, 9437184
    v_smfmac_f32_16x16x64_bf16 v[56:59], v[28:31], a[112:119], v0
    buffer_store_dwordx4 v[108:111], v1, s[28:31], s55 offen sc1
    v_smfmac_f32_16x16x64_bf16 v[60:63], v[28:31], a[120:127], v0
    s_add_u32 s69, s69, 131072
    v_add_f32 v48, v48, v50
    v_smfmac_f32_16x16x64_bf16 v[56:59], v[32:35], a[128:135], v0
    v_add_f32 v52, v52, v54
    s_waitcnt lgkmcnt(2)
    v_smfmac_f32_16x16x64_bf16 v[60:63], v[32:35], v[72:79], v0
    ds_read_b128 v[72:75], v7 offset:40960
    v_add_f32 v49, v49, v51
    v_smfmac_f32_16x16x64_bf16 v[56:59], v[36:39], a[136:143], v0
    ds_read_b128 v[76:79], v7 offset:41984
    v_add_f32 v53, v53, v55
    v_smfmac_f32_16x16x64_bf16 v[60:63], v[36:39], a[144:151], v0
    v_cvt_pk_bf16_f32 v48, v48, v52
    v_smfmac_f32_16x16x64_bf16 v[56:59], v[40:43], a[152:159], v0
    v_cvt_pk_bf16_f32 v49, v49, v53
    v_smfmac_f32_16x16x64_bf16 v[60:63], v[40:43], a[160:167], v0
    ds_write2_b32 v3, v48, v49 offset0:0 offset1:16
    v_smfmac_f32_16x16x64_bf16 v[56:59], v[44:47], a[168:175], v0
    s_waitcnt vmcnt(8)
    s_waitcnt lgkmcnt(3)
    v_smfmac_f32_16x16x64_bf16 v[60:63], v[44:47], v[80:87], v0
    ds_read_b128 v[80:83], v7 offset:0
    ds_read_b128 v[16:19], v1 offset:0
    ds_read_b128 v[20:23], v1 offset:4096
    ds_read_b128 v[104:107], v1 offset:1024
    v_smfmac_f32_16x16x64_bf16 v[64:67], v[24:27], a[208:215], v0
    ds_read_b128 v[84:87], v7 offset:1024
    ds_read_b128 v[12:15], v1 offset:5120
    v_smfmac_f32_16x16x64_bf16 v[68:71], v[24:27], a[216:223], v0
    v_add_f32 v56, v56, v58
    v_add_f32 v60, v60, v62
    v_smfmac_f32_16x16x64_bf16 v[64:67], v[28:31], a[224:231], v0
    v_add_f32 v57, v57, v59
    v_add_f32 v61, v61, v63
    v_smfmac_f32_16x16x64_bf16 v[68:71], v[28:31], a[232:239], v0
    v_cvt_pk_bf16_f32 v56, v56, v60
    v_cvt_pk_bf16_f32 v57, v57, v61
    v_smfmac_f32_16x16x64_bf16 v[64:67], v[32:35], a[240:247], v0
    ds_write2_b32 v3, v56, v57 offset0:32 offset1:48
    v_smfmac_f32_16x16x64_bf16 v[68:71], v[32:35], a[248:255], v0
    ds_read_b128 v[24:27], v1 offset:2048
    s_waitcnt lgkmcnt(9)
    v_smfmac_f32_16x16x64_bf16 v[64:67], v[36:39], v[72:79], v0
    ds_read_b128 v[72:75], v7 offset:8192
    ds_read_b128 v[28:31], v1 offset:6144
    v_smfmac_f32_16x16x64_bf16 v[68:71], v[36:39], v[128:135], v0
    ds_read_b128 v[76:79], v7 offset:9216
    v_smfmac_f32_16x16x64_bf16 v[64:67], v[40:43], v[136:143], v0
    s_waitcnt lgkmcnt(4)
    s_barrier
    v_smfmac_f32_16x16x64_bf16 v[68:71], v[40:43], v[144:151], v0
    ds_read_b128 v[88:91], v5 offset:0
    ds_read_b128 v[92:95], v5 offset:1088
    v_smfmac_f32_16x16x64_bf16 v[64:67], v[44:47], v[152:159], v0
    ds_read_b128 v[96:99], v5 offset:2176
    ds_read_b128 v[100:103], v5 offset:3264
    v_smfmac_f32_16x16x64_bf16 v[68:71], v[44:47], v[160:167], v0
    ds_read_b128 v[56:59], v1 offset:3072
    ds_read_b128 v[60:63], v1 offset:7168
    s_waitcnt lgkmcnt(5)
    v_mfma_f32_16x16x32_bf16 v[48:51], v[16:19], v[88:91], 0
    v_mfma_f32_16x16x32_bf16 v[52:55], v[20:23], v[88:91], 0
    s_waitcnt lgkmcnt(4)
    v_mfma_f32_16x16x32_bf16 v[48:51], v[104:107], v[92:95], v[48:51]
    v_add_f32 v64, v64, v66
    v_add_f32 v65, v65, v67
    v_mfma_f32_16x16x32_bf16 v[52:55], v[12:15], v[92:95], v[52:55]
    v_add_f32 v68, v68, v70
    v_add_f32 v69, v69, v71
    v_mfma_f32_16x16x32_bf16 v[12:15], v[88:91], v[88:91], 0
    v_cvt_pk_bf16_f32 v108, v64, v65
    v_cvt_pk_bf16_f32 v110, v68, v69
    v_mfma_f32_16x16x32_bf16 v[12:15], v[92:95], v[92:95], v[12:15]
    v_mov_b32 v109, 0
    v_mov_b32 v111, 0
    s_waitcnt lgkmcnt(3)
    v_mfma_f32_16x16x32_bf16 v[48:51], v[24:27], v[96:99], v[48:51]
    v_mov_b64 v[104:105], s[94:95]
    v_mov_b64 v[106:107], s[94:95]
    v_mfma_f32_16x16x32_bf16 v[52:55], v[28:31], v[96:99], v[52:55]
    v_mov_b64 v[32:33], 0
    v_mov_b64 v[34:35], 0
    v_mfma_f32_16x16x32_bf16 v[12:15], v[96:99], v[96:99], v[12:15]
    v_mov_b64 v[36:37], 0
    v_mov_b64 v[38:39], 0
    s_waitcnt lgkmcnt(2)
    v_mfma_f32_16x16x32_bf16 v[12:15], v[100:103], v[100:103], v[12:15]
    v_mov_b64 v[40:41], 0
    v_mov_b64 v[42:43], 0
    s_waitcnt lgkmcnt(1)
    v_mfma_f32_16x16x32_bf16 v[48:51], v[56:59], v[100:103], v[48:51]
    v_mov_b64 v[44:45], 0
    v_mov_b64 v[46:47], 0
    s_waitcnt lgkmcnt(0)
    v_mfma_f32_16x16x32_bf16 v[52:55], v[60:63], v[100:103], v[52:55]
    v_mov_b64 v[16:17], 0
    v_mov_b64 v[18:19], 0
    v_mov_b64 v[20:21], 0
    v_mov_b64 v[22:23], 0
    v_mov_b64 v[24:25], 0
    v_mov_b64 v[26:27], 0
    v_mov_b64 v[28:29], 0
    v_mov_b64 v[30:31], 0
    v_max_f32 v12, v14, v15
    v_max3_f32 v62, v12, v48, v49
    v_max3_f32 v62, v62, v50, v51
    v_max3_f32 v62, v62, v52, v53
    v_max3_f32 v62, v62, v54, v55
    v_mov_b32 v63, v62
    v_mov_b32 v61, 0
    s_nop 0
    v_permlane32_swap_b32 v63, v62
    v_max_f32 v62, v62, v63
    v_mov_b32 v63, v62
    s_nop 1
    v_permlane16_swap_b32 v63, v62
    v_max_f32 v62, v62, v63
    v_mul_f32 v62, s56, v62
    v_pk_fma_f32 v[14:15], v[14:15], s[76:77], v[62:63] op_sel_hi:[1,1,0] neg_lo:[0,0,1] neg_hi:[0,0,1]
    v_pk_fma_f32 v[48:49], v[48:49], s[76:77], v[62:63] op_sel_hi:[1,1,0] neg_lo:[0,0,1] neg_hi:[0,0,1]
    v_pk_fma_f32 v[50:51], v[50:51], s[76:77], v[62:63] op_sel_hi:[1,1,0] neg_lo:[0,0,1] neg_hi:[0,0,1]
    v_pk_fma_f32 v[52:53], v[52:53], s[76:77], v[62:63] op_sel_hi:[1,1,0] neg_lo:[0,0,1] neg_hi:[0,0,1]
    v_pk_fma_f32 v[54:55], v[54:55], s[76:77], v[62:63] op_sel_hi:[1,1,0] neg_lo:[0,0,1] neg_hi:[0,0,1]
    v_exp_f32 v14, v14
    v_exp_f32 v15, v15
    v_exp_f32 v48, v48
    v_cvt_pk_bf16_f32 v60, v14, v15
    v_exp_f32 v49, v49
    v_exp_f32 v50, v50
    v_mfma_f32_16x16x16_bf16 v[96:99], v[104:105], v[60:61], 0
    v_exp_f32 v51, v51
    v_mfma_f32_16x16x16_bf16 v[88:91], v[108:109], v[60:61], 0
    v_exp_f32 v52, v52
    v_mfma_f32_16x16x16_bf16 v[92:95], v[110:111], v[60:61], 0
    v_exp_f32 v53, v53
    v_exp_f32 v54, v54
    v_exp_f32 v55, v55
    v_cvt_pk_bf16_f32 v56, v48, v49
    v_cvt_pk_bf16_f32 v57, v50, v51
    v_cvt_pk_bf16_f32 v58, v52, v53
    v_cvt_pk_bf16_f32 v59, v54, v55
    s_nop 1
    v_mfma_f32_16x16x32_bf16 v[96:99], v[104:107], v[56:59], v[96:99]
    v_mfma_f32_16x16x32_bf16 v[88:91], v[120:123], v[56:59], v[88:91]
    v_mfma_f32_16x16x32_bf16 v[92:95], v[124:127], v[56:59], v[92:95]
    v_rcp_f32 v96, v96
    s_nop 2
    v_mul_f32 v88, v88, v96
    v_mul_f32 v89, v89, v96
    v_mul_f32 v90, v90, v96
    v_mul_f32 v91, v91, v96
    v_cvt_pk_bf16_f32 v100, v88, v89
    v_cvt_pk_bf16_f32 v101, v90, v91
    v_pk_mul_f32 v[92:93], v[92:93], v[96:97] op_sel_hi:[1,0]
    v_pk_mul_f32 v[94:95], v[94:95], v[96:97] op_sel_hi:[1,0]
    v_cvt_pk_bf16_f32 v102, v92, v93
    v_cvt_pk_bf16_f32 v103, v94, v95
    ds_write_b128 v6, v[100:103]
    s_waitcnt lgkmcnt(0)
    s_barrier
    ds_read_b128 v[64:67], v1 offset:29184
    ds_read_b128 v[68:71], v1 offset:30208
    s_waitcnt lgkmcnt(1)
    v_smfmac_f32_16x16x64_bf16 v[16:19], v[64:67], v[168:175], v0
    v_smfmac_f32_16x16x64_bf16 v[20:23], v[64:67], v[80:87], v0
    ds_read_b128 v[80:83], v7 offset:16384
    s_waitcnt lgkmcnt(1)
    v_smfmac_f32_16x16x64_bf16 v[16:19], v[68:71], v[176:183], v0
    ds_read_b128 v[84:87], v7 offset:17408
    v_smfmac_f32_16x16x64_bf16 v[20:23], v[68:71], v[184:191], v0
    v_smfmac_f32_16x16x64_bf16 v[24:27], v[64:67], v[72:79], v0
    ds_read_b128 v[72:75], v7 offset:24576
    v_smfmac_f32_16x16x64_bf16 v[28:31], v[64:67], v[192:199], v0
    ds_read_b128 v[76:79], v7 offset:25600
    v_add_f32 v16, v16, v18
    v_add_f32 v17, v17, v19
    v_smfmac_f32_16x16x64_bf16 v[24:27], v[68:71], v[200:207], v0
    v_add_f32 v20, v20, v22
    v_add_f32 v21, v21, v23
    s_waitcnt lgkmcnt(2)
    v_smfmac_f32_16x16x64_bf16 v[28:31], v[68:71], v[80:87], v0
    ds_read_b128 v[80:83], v7 offset:32768
    v_cvt_pk_bf16_f32 v48, v16, v20
    v_cvt_pk_bf16_f32 v49, v17, v21
    v_smfmac_f32_16x16x64_bf16 v[32:35], v[64:67], v[208:215], v0
    ds_read_b128 v[84:87], v7 offset:33792
    v_smfmac_f32_16x16x64_bf16 v[36:39], v[64:67], v[216:223], v0
    v_add_f32 v24, v24, v26
    v_add_f32 v25, v25, v27
    s_waitcnt lgkmcnt(2)
    v_smfmac_f32_16x16x64_bf16 v[32:35], v[68:71], v[72:79], v0
    ds_read_b128 v[72:75], v7 offset:49152
    v_add_f32 v28, v28, v30
    v_add_f32 v29, v29, v31
    v_smfmac_f32_16x16x64_bf16 v[36:39], v[68:71], v[224:231], v0
    ds_read_b128 v[76:79], v7 offset:50176
    v_cvt_pk_bf16_f32 v51, v25, v29
    v_and_b32 v51, -2, v51
    v_smfmac_f32_16x16x64_bf16 v[40:43], v[64:67], v[232:239], v0
    v_cvt_pk_bf16_f32 v50, v24, v28
    s_waitcnt lgkmcnt(2)
    v_smfmac_f32_16x16x64_bf16 v[44:47], v[64:67], v[80:87], v0
    ds_read_b128 v[80:83], v7 offset:57344
    buffer_store_dwordx4 v[48:51], v9, s[28:31], s60 offen sc1
    v_add_f32 v32, v32, v34
    v_add_f32 v33, v33, v35
    v_smfmac_f32_16x16x64_bf16 v[40:43], v[68:71], v[240:247], v0
    ds_read_b128 v[84:87], v7 offset:58368
    v_add_f32 v36, v36, v38
    v_add_f32 v37, v37, v39
    v_smfmac_f32_16x16x64_bf16 v[44:47], v[68:71], v[248:255], v0
    v_cvt_pk_bf16_f32 v52, v32, v36
    v_cvt_pk_bf16_f32 v53, v33, v37
    s_nop 1
    v_add_f32 v40, v40, v42
    v_add_f32 v41, v41, v43
    s_nop 1
    v_add_f32 v44, v44, v46
    v_add_f32 v45, v45, v47
    v_cvt_pk_bf16_f32 v55, v41, v45
    v_and_b32 v55, -2, v55
    v_cvt_pk_bf16_f32 v54, v40, v44
    buffer_store_dwordx4 v[52:55], v9, s[28:31], s61 offen sc1
    s_movk_i32 s52, 0x3f80
    v_lshlrev_b32 v28, v1, s52
    v_cndmask_b32 v24, 0, v28, s[80:81]
    v_cndmask_b32 v25, 0, v28, s[82:83]
    v_cndmask_b32 v26, 0, v28, s[84:85]
    v_cndmask_b32 v27, 0, v28, s[86:87]
    ds_read_b128 v[92:95], v4
    v_mov_b64 v[48:49], 0
    v_mov_b64 v[50:51], 0
    v_mov_b64 v[52:53], 0
    v_mov_b64 v[54:55], 0
    v_mov_b64 v[56:57], 0
    v_mov_b64 v[58:59], 0
    v_mov_b64 v[60:61], 0
    v_mov_b64 v[62:63], 0
    v_mov_b64 v[64:65], 0
    v_mov_b64 v[66:67], 0
    v_mov_b64 v[68:69], 0
    v_mov_b64 v[70:71], 0
    s_mov_b32 s52, 0
    s_mov_b32 s53, 8192
    s_mov_b32 s54, 442368
    s_mov_b32 s55, 446464
    v_mov_b32 v13, -1
    s_sleep 2
    buffer_load_dwordx4 v[16:19], v1, s[28:31], s64 offen sc1
    buffer_load_dwordx4 v[20:23], v1, s[28:31], s65 offen sc1
    s_sleep 2
    buffer_load_dwordx4 v[16:19], v1, s[28:31], s64 offen sc1
    buffer_load_dwordx4 v[20:23], v1, s[28:31], s65 offen sc1
    s_branch pd_31
pl_30:
    s_mov_b64 exec, vcc
    buffer_load_dwordx4 v[16:19], v1, s[28:31], s64 offen sc1
    buffer_load_dwordx4 v[20:23], v1, s[28:31], s65 offen sc1
    s_mov_b64 exec, -1
    s_sub_u32 s79, s79, 1
    s_cbranch_scc1 L_abort
pd_31:
    s_waitcnt vmcnt(2)
    v_bitop3_b32 v12, v19, v23, 1 bitop3:0xa8
    v_cmp_ne_u32 vcc, 0, v12
    s_cbranch_vccnz pl_30
    v_mfma_f32_16x16x32_bf16 v[28:31], v[16:19], v[24:27], 0
    v_mfma_f32_16x16x32_bf16 v[28:31], v[20:23], v[24:27], v[28:31]
    s_nop 7
    v_permlane32_swap_b32 v28, v29
    v_permlane32_swap_b32 v30, v31
    v_add_f32 v28, v28, v29
    v_add_f32 v30, v30, v31
    s_nop 1
    v_permlane16_swap_b32 v28, v30
    v_add_f32 v28, v28, v30
    s_nop 1
    v_mov_b32_dpp v29, v28 row_shl:1 row_mask:0xf bank_mask:0xf
    v_cvt_pk_bf16_f32 v28, v28, v29
    v_min_u32 v28, -2, v28
    s_mov_b64 exec, s[74:75]
    buffer_store_dword v28, v11, s[28:31], s52 offen sc1
    buffer_store_dword v13, v11, s[28:31], s53 offen sc1
    s_mov_b64 exec, -1
    s_add_u32 s50, s50, 1
    s_cmp_ge_u32 s59, 64
    s_cbranch_scc1 fr_32
    v_bfe_u32 v14, v1, 4, 2
    v_lshl_add_u32 v10, v10, 2, v14
    s_nop 1
    v_min_u32_dpp v10, v10, v10 row_ror:1 row_mask:0xf bank_mask:0xf
    s_nop 1
    v_min_u32_dpp v10, v10, v10 row_ror:2 row_mask:0xf bank_mask:0xf
    s_nop 1
    v_min_u32_dpp v10, v10, v10 row_ror:4 row_mask:0xf bank_mask:0xf
    s_nop 1
    v_min_u32_dpp v10, v10, v10 row_ror:8 row_mask:0xf bank_mask:0xf
    s_nop 0
    v_readfirstlane_b32 s92, v10
    s_nop 0
    s_max_u32 s59, s59, s92
    s_add_u32 s92, s50, 1
    s_min_u32 s92, s92, 63
    s_cmp_lt_u32 s92, s59
    s_cbranch_scc1 kvok_33
    v_mbcnt_lo_u32_b32 v36, -1, 0
    v_mbcnt_hi_u32_b32 v36, -1, v36
    v_and_b32 v36, 3, v36
    v_lshrrev_b32 v37, 1, v36
    v_lshlrev_b32 v37, 6, v37
    v_and_b32 v36, 1, v36
    v_add_u32 v36, v36, v37
    s_lshl_b32 s93, s49, 1
    v_add_u32 v36, s93, v36
    v_lshlrev_b32 v36, 4, v36
    s_nop 1
kvlp_34:
    s_sub_u32 s79, s79, 1
    s_cbranch_scc1 L_abort
    buffer_load_dwordx4 v[32:35], v36, s[28:31], 0 offen offset:0 sc1
    s_waitcnt vmcnt(0)
    v_lshlrev_b32 v32, 2, v32
    v_lshl_add_u32 v33, v33, 2, 1
    v_lshl_add_u32 v34, v34, 2, 2
    v_lshl_add_u32 v35, v35, 2, 3
    v_min3_u32 v32, v32, v33, v34
    v_min_u32 v32, v32, v35
    s_nop 0
    v_readlane_b32 s59, v32, 0
    v_readlane_b32 s93, v32, 1
    s_nop 0
    s_min_u32 s59, s59, s93
    v_readlane_b32 s93, v32, 2
    s_nop 0
    s_min_u32 s59, s59, s93
    v_readlane_b32 s93, v32, 3
    s_nop 0
    s_min_u32 s59, s59, s93
    s_cmp_lt_u32 s92, s59
    s_nop 1
    s_cbranch_scc0 kvlp_34
kvok_33:
fr_32:
    v_bfe_u32 v10, v1, 4, 3
    v_bfe_u32 v14, v1, 7, 1
    v_lshlrev_b32 v10, 2, v10
    v_lshl_add_u32 v10, v14, 10, v10
    s_lshl_b32 s92, s49, 5
    s_add_u32 s92, s92, 0
    v_add_u32 v10, s92, v10
    v_add_u32 v104, s88, v1
    v_add_u32 v105, s89, v1
    v_add_u32 v106, s90, v1
    ds_read_b128 v[24:27], v8 offset:16384
    ds_read_b128 v[28:31], v8 offset:17408
    ds_read_b128 v[32:35], v8 offset:24576
    ds_read_b128 v[36:39], v8 offset:25600
    ds_read_b128 v[40:43], v8 offset:32768
    ds_read_b128 v[44:47], v8 offset:33792
    ds_read_b128 v[96:99], v8 offset:40960
    ds_read_b128 v[100:103], v8 offset:41984
    s_sleep 1
    buffer_load_dwordx4 v[16:19], v2, s[28:31], s54 offen sc1
    buffer_load_dwordx4 v[20:23], v2, s[28:31], s55 offen sc1
    s_sleep 2
    buffer_load_dwordx4 v[16:19], v2, s[28:31], s54 offen sc1
    buffer_load_dwordx4 v[20:23], v2, s[28:31], s55 offen sc1
    s_cmp_eq_u32 s50, 63
    s_cbranch_scc1 fin_10
    s_branch t0_27
tl_35:
    s_mov_b64 exec, vcc
    buffer_load_dwordx4 v[16:19], v2, s[28:31], s54 offen sc1
    buffer_load_dwordx4 v[20:23], v2, s[28:31], s55 offen sc1
    s_mov_b64 exec, -1
    s_sub_u32 s79, s79, 1
    s_cbranch_scc1 L_abort
t0_27:
    s_waitcnt vmcnt(2) lgkmcnt(0)
    v_max3_u32 v12, v16, v17, v18
    v_max3_u32 v14, v19, v20, v21
    v_max3_u32 v12, v12, v22, v23
    v_max_u32 v12, v12, v14
    v_cmp_eq_u32 vcc, -1, v12
    s_cbranch_vccnz tl_35
    v_smfmac_f32_16x16x64_bf16 v[48:51], v[16:19], v[24:31], v0
    ds_write_b128 v2, v[16:19]
    v_smfmac_f32_16x16x64_bf16 v[52:55], v[16:19], v[32:39], v0
    ds_write_b128 v2, v[20:23] offset:4096
    v_smfmac_f32_16x16x64_bf16 v[48:51], v[20:23], v[40:47], v0
    s_mov_b32 m0, s72
    s_add_u32 s54, s68, 16777216
    v_smfmac_f32_16x16x64_bf16 v[52:55], v[20:23], v[96:103], v0
    buffer_load_dwordx4 v1, s[28:31], s68 offen sc1 lds
    v_smfmac_f32_16x16x64_bf16 v[56:59], v[16:19], v[72:79], v0
    ds_read_b128 v[72:75], v8 offset:49152
    buffer_load_dwordx4 v1, s[28:31], s68 offen offset:1024 sc1 lds
    v_smfmac_f32_16x16x64_bf16 v[60:63], v[16:19], v[80:87], v0
    ds_read_b128 v[80:83], v8 offset:57344
    v_smfmac_f32_16x16x64_bf16 v[56:59], v[20:23], a[80:87], v0
    v_smfmac_f32_16x16x64_bf16 v[60:63], v[20:23], a[88:95], v0
    s_waitcnt lgkmcnt(2)
    s_barrier
    v_smfmac_f32_16x16x64_bf16 v[64:67], v[16:19], a[176:183], v0
    ds_read_b128 v[24:27], v104 offset:16384
    ds_read_b128 v[28:31], v104 offset:20480
    v_smfmac_f32_16x16x64_bf16 v[68:71], v[16:19], a[184:191], v0
    ds_read_b128 v[32:35], v105 offset:16384
    ds_read_b128 v[36:39], v105 offset:20480
    v_smfmac_f32_16x16x64_bf16 v[64:67], v[20:23], a[192:199], v0
    ds_read_b128 v[40:43], v106 offset:16384
    ds_read_b128 v[44:47], v106 offset:20480
    v_smfmac_f32_16x16x64_bf16 v[68:71], v[20:23], a[200:207], v0
    s_waitcnt lgkmcnt(5)
    v_smfmac_f32_16x16x64_bf16 v[48:51], v[24:27], a[0:7], v0
    ds_read_b128 v[76:79], v8 offset:50176
    buffer_load_dwordx4 v[120:123], v1, s[28:31], s54 offen sc1
    v_smfmac_f32_16x16x64_bf16 v[52:55], v[24:27], a[8:15], v0
    ds_read_b128 v[84:87], v8 offset:58368
    s_waitcnt lgkmcnt(6)
    v_smfmac_f32_16x16x64_bf16 v[48:51], v[28:31], a[16:23], v0
    s_add_u32 s68, s68, 262144
    v_smfmac_f32_16x16x64_bf16 v[52:55], v[28:31], a[24:31], v0
    buffer_load_dwordx4 v[124:127], v1, s[28:31], s54 offen offset:1024 sc1
    s_waitcnt lgkmcnt(5)
    v_smfmac_f32_16x16x64_bf16 v[48:51], v[32:35], a[32:39], v0
    v_smfmac_f32_16x16x64_bf16 v[52:55], v[32:35], a[40:47], v0
    s_sub_u32 s53, s50, 1
    s_max_i32 s53, s53, 0
    v_mov_b32 v14, s53
    s_waitcnt lgkmcnt(4)
    s_waitcnt lgkmcnt(1)
    v_smfmac_f32_16x16x64_bf16 v[48:51], v[36:39], v[72:79], v0
    ds_read_b128 v[72:75], v8 offset:0
    v_mov_b32 v15, 24576
    v_smfmac_f32_16x16x64_bf16 v[52:55], v[36:39], a[48:55], v0
    ds_read_b128 v[76:79], v8 offset:1024
    s_mov_b64 exec, s[62:63]
    buffer_store_dword v14, v15, s[28:31], s66 offen sc1
    s_mov_b64 exec, -1
    v_smfmac_f32_16x16x64_bf16 v[48:51], v[40:43], a[56:63], v0
    buffer_load_dword v10, v10, s[28:31], 0 offen sc1
    v_smfmac_f32_16x16x64_bf16 v[52:55], v[40:43], a[64:71], v0
    v_smfmac_f32_16x16x64_bf16 v[48:51], v[44:47], a[72:79], v0
    buffer_store_dwordx4 v[92:95], v1, s[28:31], s69 offen sc1
    s_waitcnt lgkmcnt(2)
    v_smfmac_f32_16x16x64_bf16 v[52:55], v[44:47], v[80:87], v0
    ds_read_b128 v[80:83], v8 offset:8192
    v_smfmac_f32_16x16x64_bf16 v[56:59], v[24:27], a[96:103], v0
    ds_read_b128 v[84:87], v8 offset:9216
    v_smfmac_f32_16x16x64_bf16 v[60:63], v[24:27], a[104:111], v0
    s_add_u32 s55, s69, 9437184
    v_smfmac_f32_16x16x64_bf16 v[56:59], v[28:31], a[112:119], v0
    buffer_store_dwordx4 v[108:111], v1, s[28:31], s55 offen sc1
    v_smfmac_f32_16x16x64_bf16 v[60:63], v[28:31], a[120:127], v0
    s_add_u32 s69, s69, 131072
    v_add_f32 v48, v48, v50
    v_smfmac_f32_16x16x64_bf16 v[56:59], v[32:35], a[128:135], v0
    v_add_f32 v52, v52, v54
    s_waitcnt lgkmcnt(2)
    v_smfmac_f32_16x16x64_bf16 v[60:63], v[32:35], v[72:79], v0
    ds_read_b128 v[72:75], v7 offset:40960
    v_add_f32 v49, v49, v51
    v_smfmac_f32_16x16x64_bf16 v[56:59], v[36:39], a[136:143], v0
    ds_read_b128 v[76:79], v7 offset:41984
    v_add_f32 v53, v53, v55
    v_smfmac_f32_16x16x64_bf16 v[60:63], v[36:39], a[144:151], v0
    v_cvt_pk_bf16_f32 v48, v48, v52
    v_smfmac_f32_16x16x64_bf16 v[56:59], v[40:43], a[152:159], v0
    v_cvt_pk_bf16_f32 v49, v49, v53
    v_smfmac_f32_16x16x64_bf16 v[60:63], v[40:43], a[160:167], v0
    ds_write2_b32 v3, v48, v49 offset0:0 offset1:16
    v_smfmac_f32_16x16x64_bf16 v[56:59], v[44:47], a[168:175], v0
    s_waitcnt vmcnt(8)
    s_waitcnt lgkmcnt(3)
    v_smfmac_f32_16x16x64_bf16 v[60:63], v[44:47], v[80:87], v0
    ds_read_b128 v[80:83], v7 offset:0
    ds_read_b128 v[16:19], v1 offset:8192
    ds_read_b128 v[20:23], v1 offset:12288
    ds_read_b128 v[104:107], v1 offset:9216
    v_smfmac_f32_16x16x64_bf16 v[64:67], v[24:27], a[208:215], v0
    ds_read_b128 v[84:87], v7 offset:1024
    ds_read_b128 v[12:15], v1 offset:13312
    v_smfmac_f32_16x16x64_bf16 v[68:71], v[24:27], a[216:223], v0
    v_add_f32 v56, v56, v58
    v_add_f32 v60, v60, v62
    v_smfmac_f32_16x16x64_bf16 v[64:67], v[28:31], a[224:231], v0
    v_add_f32 v57, v57, v59
    v_add_f32 v61, v61, v63
    v_smfmac_f32_16x16x64_bf16 v[68:71], v[28:31], a[232:239], v0
    v_cvt_pk_bf16_f32 v56, v56, v60
    v_cvt_pk_bf16_f32 v57, v57, v61
    v_smfmac_f32_16x16x64_bf16 v[64:67], v[32:35], a[240:247], v0
    ds_write2_b32 v3, v56, v57 offset0:32 offset1:48
    v_smfmac_f32_16x16x64_bf16 v[68:71], v[32:35], a[248:255], v0
    ds_read_b128 v[24:27], v1 offset:10240
    s_waitcnt lgkmcnt(9)
    v_smfmac_f32_16x16x64_bf16 v[64:67], v[36:39], v[72:79], v0
    ds_read_b128 v[72:75], v7 offset:8192
    ds_read_b128 v[28:31], v1 offset:14336
    v_smfmac_f32_16x16x64_bf16 v[68:71], v[36:39], v[128:135], v0
    ds_read_b128 v[76:79], v7 offset:9216
    v_smfmac_f32_16x16x64_bf16 v[64:67], v[40:43], v[136:143], v0
    s_waitcnt lgkmcnt(4)
    s_barrier
    v_smfmac_f32_16x16x64_bf16 v[68:71], v[40:43], v[144:151], v0
    ds_read_b128 v[88:91], v5 offset:0
    ds_read_b128 v[92:95], v5 offset:1088
    v_smfmac_f32_16x16x64_bf16 v[64:67], v[44:47], v[152:159], v0
    ds_read_b128 v[96:99], v5 offset:2176
    ds_read_b128 v[100:103], v5 offset:3264
    v_smfmac_f32_16x16x64_bf16 v[68:71], v[44:47], v[160:167], v0
    ds_read_b128 v[56:59], v1 offset:11264
    ds_read_b128 v[60:63], v1 offset:15360
    s_waitcnt lgkmcnt(5)
    v_mfma_f32_16x16x32_bf16 v[48:51], v[16:19], v[88:91], 0
    v_mfma_f32_16x16x32_bf16 v[52:55], v[20:23], v[88:91], 0
    s_waitcnt lgkmcnt(4)
    v_mfma_f32_16x16x32_bf16 v[48:51], v[104:107], v[92:95], v[48:51]
    v_add_f32 v64, v64, v66
    v_add_f32 v65, v65, v67
    v_mfma_f32_16x16x32_bf16 v[52:55], v[12:15], v[92:95], v[52:55]
    v_add_f32 v68, v68, v70
    v_add_f32 v69, v69, v71
    v_mfma_f32_16x16x32_bf16 v[12:15], v[88:91], v[88:91], 0
    v_cvt_pk_bf16_f32 v108, v64, v65
    v_cvt_pk_bf16_f32 v110, v68, v69
    v_mfma_f32_16x16x32_bf16 v[12:15], v[92:95], v[92:95], v[12:15]
    v_mov_b32 v109, 0
    v_mov_b32 v111, 0
    s_waitcnt lgkmcnt(3)
    v_mfma_f32_16x16x32_bf16 v[48:51], v[24:27], v[96:99], v[48:51]
    v_mov_b64 v[104:105], s[94:95]
    v_mov_b64 v[106:107], s[94:95]
    v_mfma_f32_16x16x32_bf16 v[52:55], v[28:31], v[96:99], v[52:55]
    v_mov_b64 v[32:33], 0
    v_mov_b64 v[34:35], 0
    v_mfma_f32_16x16x32_bf16 v[12:15], v[96:99], v[96:99], v[12:15]
    v_mov_b64 v[36:37], 0
    v_mov_b64 v[38:39], 0
    s_waitcnt lgkmcnt(2)
    v_mfma_f32_16x16x32_bf16 v[12:15], v[100:103], v[100:103], v[12:15]
    v_mov_b64 v[40:41], 0
    v_mov_b64 v[42:43], 0
    s_waitcnt lgkmcnt(1)
    v_mfma_f32_16x16x32_bf16 v[48:51], v[56:59], v[100:103], v[48:51]
    v_mov_b64 v[44:45], 0
    v_mov_b64 v[46:47], 0
    s_waitcnt lgkmcnt(0)
    v_mfma_f32_16x16x32_bf16 v[52:55], v[60:63], v[100:103], v[52:55]
    v_mov_b64 v[16:17], 0
    v_mov_b64 v[18:19], 0
    v_mov_b64 v[20:21], 0
    v_mov_b64 v[22:23], 0
    v_mov_b64 v[24:25], 0
    v_mov_b64 v[26:27], 0
    v_mov_b64 v[28:29], 0
    v_mov_b64 v[30:31], 0
    v_max_f32 v12, v14, v15
    v_max3_f32 v62, v12, v48, v49
    v_max3_f32 v62, v62, v50, v51
    v_max3_f32 v62, v62, v52, v53
    v_max3_f32 v62, v62, v54, v55
    v_mov_b32 v63, v62
    v_mov_b32 v61, 0
    s_nop 0
    v_permlane32_swap_b32 v63, v62
    v_max_f32 v62, v62, v63
    v_mov_b32 v63, v62
    s_nop 1
    v_permlane16_swap_b32 v63, v62
    v_max_f32 v62, v62, v63
    v_mul_f32 v62, s56, v62
    v_pk_fma_f32 v[14:15], v[14:15], s[76:77], v[62:63] op_sel_hi:[1,1,0] neg_lo:[0,0,1] neg_hi:[0,0,1]
    v_pk_fma_f32 v[48:49], v[48:49], s[76:77], v[62:63] op_sel_hi:[1,1,0] neg_lo:[0,0,1] neg_hi:[0,0,1]
    v_pk_fma_f32 v[50:51], v[50:51], s[76:77], v[62:63] op_sel_hi:[1,1,0] neg_lo:[0,0,1] neg_hi:[0,0,1]
    v_pk_fma_f32 v[52:53], v[52:53], s[76:77], v[62:63] op_sel_hi:[1,1,0] neg_lo:[0,0,1] neg_hi:[0,0,1]
    v_pk_fma_f32 v[54:55], v[54:55], s[76:77], v[62:63] op_sel_hi:[1,1,0] neg_lo:[0,0,1] neg_hi:[0,0,1]
    v_exp_f32 v14, v14
    v_exp_f32 v15, v15
    v_exp_f32 v48, v48
    v_cvt_pk_bf16_f32 v60, v14, v15
    v_exp_f32 v49, v49
    v_exp_f32 v50, v50
    v_mfma_f32_16x16x16_bf16 v[96:99], v[104:105], v[60:61], 0
    v_exp_f32 v51, v51
    v_mfma_f32_16x16x16_bf16 v[88:91], v[108:109], v[60:61], 0
    v_exp_f32 v52, v52
    v_mfma_f32_16x16x16_bf16 v[92:95], v[110:111], v[60:61], 0
    v_exp_f32 v53, v53
    v_exp_f32 v54, v54
    v_exp_f32 v55, v55
    v_cvt_pk_bf16_f32 v56, v48, v49
    v_cvt_pk_bf16_f32 v57, v50, v51
    v_cvt_pk_bf16_f32 v58, v52, v53
    v_cvt_pk_bf16_f32 v59, v54, v55
    s_nop 1
    v_mfma_f32_16x16x32_bf16 v[96:99], v[104:107], v[56:59], v[96:99]
    v_mfma_f32_16x16x32_bf16 v[88:91], v[112:115], v[56:59], v[88:91]
    v_mfma_f32_16x16x32_bf16 v[92:95], v[116:119], v[56:59], v[92:95]
    v_rcp_f32 v96, v96
    s_nop 2
    v_mul_f32 v88, v88, v96
    v_mul_f32 v89, v89, v96
    v_mul_f32 v90, v90, v96
    v_mul_f32 v91, v91, v96
    v_cvt_pk_bf16_f32 v100, v88, v89
    v_cvt_pk_bf16_f32 v101, v90, v91
    v_pk_mul_f32 v[92:93], v[92:93], v[96:97] op_sel_hi:[1,0]
    v_pk_mul_f32 v[94:95], v[94:95], v[96:97] op_sel_hi:[1,0]
    v_cvt_pk_bf16_f32 v102, v92, v93
    v_cvt_pk_bf16_f32 v103, v94, v95
    ds_write_b128 v6, v[100:103]
    s_waitcnt lgkmcnt(0)
    s_barrier
    ds_read_b128 v[64:67], v1 offset:29184
    ds_read_b128 v[68:71], v1 offset:30208
    s_waitcnt lgkmcnt(1)
    v_smfmac_f32_16x16x64_bf16 v[16:19], v[64:67], v[168:175], v0
    v_smfmac_f32_16x16x64_bf16 v[20:23], v[64:67], v[80:87], v0
    ds_read_b128 v[80:83], v7 offset:16384
    s_waitcnt lgkmcnt(1)
    v_smfmac_f32_16x16x64_bf16 v[16:19], v[68:71], v[176:183], v0
    ds_read_b128 v[84:87], v7 offset:17408
    v_smfmac_f32_16x16x64_bf16 v[20:23], v[68:71], v[184:191], v0
    v_smfmac_f32_16x16x64_bf16 v[24:27], v[64:67], v[72:79], v0
    ds_read_b128 v[72:75], v7 offset:24576
    v_smfmac_f32_16x16x64_bf16 v[28:31], v[64:67], v[192:199], v0
    ds_read_b128 v[76:79], v7 offset:25600
    v_add_f32 v16, v16, v18
    v_add_f32 v17, v17, v19
    v_smfmac_f32_16x16x64_bf16 v[24:27], v[68:71], v[200:207], v0
    v_add_f32 v20, v20, v22
    v_add_f32 v21, v21, v23
    s_waitcnt lgkmcnt(2)
    v_smfmac_f32_16x16x64_bf16 v[28:31], v[68:71], v[80:87], v0
    ds_read_b128 v[80:83], v7 offset:32768
    v_cvt_pk_bf16_f32 v48, v16, v20
    v_cvt_pk_bf16_f32 v49, v17, v21
    v_smfmac_f32_16x16x64_bf16 v[32:35], v[64:67], v[208:215], v0
    ds_read_b128 v[84:87], v7 offset:33792
    v_smfmac_f32_16x16x64_bf16 v[36:39], v[64:67], v[216:223], v0
    v_add_f32 v24, v24, v26
    v_add_f32 v25, v25, v27
    s_waitcnt lgkmcnt(2)
    v_smfmac_f32_16x16x64_bf16 v[32:35], v[68:71], v[72:79], v0
    ds_read_b128 v[72:75], v7 offset:49152
    v_add_f32 v28, v28, v30
    v_add_f32 v29, v29, v31
    v_smfmac_f32_16x16x64_bf16 v[36:39], v[68:71], v[224:231], v0
    ds_read_b128 v[76:79], v7 offset:50176
    v_cvt_pk_bf16_f32 v51, v25, v29
    v_or_b32 v51, 1, v51
    v_smfmac_f32_16x16x64_bf16 v[40:43], v[64:67], v[232:239], v0
    v_cvt_pk_bf16_f32 v50, v24, v28
    s_waitcnt lgkmcnt(2)
    v_smfmac_f32_16x16x64_bf16 v[44:47], v[64:67], v[80:87], v0
    ds_read_b128 v[80:83], v7 offset:57344
    buffer_store_dwordx4 v[48:51], v9, s[28:31], s60 offen sc1
    v_add_f32 v32, v32, v34
    v_add_f32 v33, v33, v35
    v_smfmac_f32_16x16x64_bf16 v[40:43], v[68:71], v[240:247], v0
    ds_read_b128 v[84:87], v7 offset:58368
    v_add_f32 v36, v36, v38
    v_add_f32 v37, v37, v39
    v_smfmac_f32_16x16x64_bf16 v[44:47], v[68:71], v[248:255], v0
    v_cvt_pk_bf16_f32 v52, v32, v36
    v_cvt_pk_bf16_f32 v53, v33, v37
    s_nop 1
    v_add_f32 v40, v40, v42
    v_add_f32 v41, v41, v43
    s_nop 1
    v_add_f32 v44, v44, v46
    v_add_f32 v45, v45, v47
    v_cvt_pk_bf16_f32 v55, v41, v45
    v_or_b32 v55, 1, v55
    v_cvt_pk_bf16_f32 v54, v40, v44
    buffer_store_dwordx4 v[52:55], v9, s[28:31], s61 offen sc1
    s_movk_i32 s52, 0x3f80
    v_lshlrev_b32 v28, v1, s52
    v_cndmask_b32 v24, 0, v28, s[80:81]
    v_cndmask_b32 v25, 0, v28, s[82:83]
    v_cndmask_b32 v26, 0, v28, s[84:85]
    v_cndmask_b32 v27, 0, v28, s[86:87]
    ds_read_b128 v[92:95], v4
    v_mov_b64 v[48:49], 0
    v_mov_b64 v[50:51], 0
    v_mov_b64 v[52:53], 0
    v_mov_b64 v[54:55], 0
    v_mov_b64 v[56:57], 0
    v_mov_b64 v[58:59], 0
    v_mov_b64 v[60:61], 0
    v_mov_b64 v[62:63], 0
    v_mov_b64 v[64:65], 0
    v_mov_b64 v[66:67], 0
    v_mov_b64 v[68:69], 0
    v_mov_b64 v[70:71], 0
    s_mov_b32 s52, 8192
    s_mov_b32 s53, 0
    s_mov_b32 s54, 450560
    s_mov_b32 s55, 454656
    v_mov_b32 v13, -1
    s_sleep 2
    buffer_load_dwordx4 v[16:19], v1, s[28:31], s64 offen sc1
    buffer_load_dwordx4 v[20:23], v1, s[28:31], s65 offen sc1
    s_sleep 2
    buffer_load_dwordx4 v[16:19], v1, s[28:31], s64 offen sc1
    buffer_load_dwordx4 v[20:23], v1, s[28:31], s65 offen sc1
    s_branch pd_37
pl_36:
    s_mov_b64 exec, vcc
    buffer_load_dwordx4 v[16:19], v1, s[28:31], s64 offen sc1
    buffer_load_dwordx4 v[20:23], v1, s[28:31], s65 offen sc1
    s_mov_b64 exec, -1
    s_sub_u32 s79, s79, 1
    s_cbranch_scc1 L_abort
pd_37:
    s_waitcnt vmcnt(2)
    v_bitop3_b32 v12, v19, v23, 1 bitop3:0x80
    v_cmp_ne_u32 vcc, 1, v12
    s_cbranch_vccnz pl_36
    v_mfma_f32_16x16x32_bf16 v[28:31], v[16:19], v[24:27], 0
    v_mfma_f32_16x16x32_bf16 v[28:31], v[20:23], v[24:27], v[28:31]
    s_nop 7
    v_permlane32_swap_b32 v28, v29
    v_permlane32_swap_b32 v30, v31
    v_add_f32 v28, v28, v29
    v_add_f32 v30, v30, v31
    s_nop 1
    v_permlane16_swap_b32 v28, v30
    v_add_f32 v28, v28, v30
    s_nop 1
    v_mov_b32_dpp v29, v28 row_shl:1 row_mask:0xf bank_mask:0xf
    v_cvt_pk_bf16_f32 v28, v28, v29
    v_min_u32 v28, -2, v28
    s_mov_b64 exec, s[74:75]
    buffer_store_dword v28, v11, s[28:31], s52 offen sc1
    buffer_store_dword v13, v11, s[28:31], s53 offen sc1
    s_mov_b64 exec, -1
    s_add_u32 s50, s50, 1
    s_cmp_ge_u32 s59, 64
    s_cbranch_scc1 fr_38
    v_bfe_u32 v14, v1, 4, 2
    v_lshl_add_u32 v10, v10, 2, v14
    s_nop 1
    v_min_u32_dpp v10, v10, v10 row_ror:1 row_mask:0xf bank_mask:0xf
    s_nop 1
    v_min_u32_dpp v10, v10, v10 row_ror:2 row_mask:0xf bank_mask:0xf
    s_nop 1
    v_min_u32_dpp v10, v10, v10 row_ror:4 row_mask:0xf bank_mask:0xf
    s_nop 1
    v_min_u32_dpp v10, v10, v10 row_ror:8 row_mask:0xf bank_mask:0xf
    s_nop 0
    v_readfirstlane_b32 s92, v10
    s_nop 0
    s_max_u32 s59, s59, s92
    s_add_u32 s92, s50, 1
    s_min_u32 s92, s92, 63
    s_cmp_lt_u32 s92, s59
    s_cbranch_scc1 kvok_39
    v_mbcnt_lo_u32_b32 v36, -1, 0
    v_mbcnt_hi_u32_b32 v36, -1, v36
    v_and_b32 v36, 3, v36
    v_lshrrev_b32 v37, 1, v36
    v_lshlrev_b32 v37, 6, v37
    v_and_b32 v36, 1, v36
    v_add_u32 v36, v36, v37
    s_lshl_b32 s93, s49, 1
    v_add_u32 v36, s93, v36
    v_lshlrev_b32 v36, 4, v36
    s_nop 1
kvlp_40:
    s_sub_u32 s79, s79, 1
    s_cbranch_scc1 L_abort
    buffer_load_dwordx4 v[32:35], v36, s[28:31], 0 offen offset:0 sc1
    s_waitcnt vmcnt(0)
    v_lshlrev_b32 v32, 2, v32
    v_lshl_add_u32 v33, v33, 2, 1
    v_lshl_add_u32 v34, v34, 2, 2
    v_lshl_add_u32 v35, v35, 2, 3
    v_min3_u32 v32, v32, v33, v34
    v_min_u32 v32, v32, v35
    s_nop 0
    v_readlane_b32 s59, v32, 0
    v_readlane_b32 s93, v32, 1
    s_nop 0
    s_min_u32 s59, s59, s93
    v_readlane_b32 s93, v32, 2
    s_nop 0
    s_min_u32 s59, s59, s93
    v_readlane_b32 s93, v32, 3
    s_nop 0
    s_min_u32 s59, s59, s93
    s_cmp_lt_u32 s92, s59
    s_nop 1
    s_cbranch_scc0 kvlp_40
kvok_39:
fr_38:
    v_bfe_u32 v10, v1, 4, 3
    v_bfe_u32 v14, v1, 7, 1
    v_lshlrev_b32 v10, 2, v10
    v_lshl_add_u32 v10, v14, 10, v10
    s_lshl_b32 s92, s49, 5
    s_add_u32 s92, s92, 0
    v_add_u32 v10, s92, v10
    v_add_u32 v104, s88, v1
    v_add_u32 v105, s89, v1
    v_add_u32 v106, s90, v1
    ds_read_b128 v[24:27], v8 offset:16384
    ds_read_b128 v[28:31], v8 offset:17408
    ds_read_b128 v[32:35], v8 offset:24576
    ds_read_b128 v[36:39], v8 offset:25600
    ds_read_b128 v[40:43], v8 offset:32768
    ds_read_b128 v[44:47], v8 offset:33792
    ds_read_b128 v[96:99], v8 offset:40960
    ds_read_b128 v[100:103], v8 offset:41984
    s_sleep 1
    buffer_load_dwordx4 v[16:19], v2, s[28:31], s54 offen sc1
    buffer_load_dwordx4 v[20:23], v2, s[28:31], s55 offen sc1
    s_sleep 2
    buffer_load_dwordx4 v[16:19], v2, s[28:31], s54 offen sc1
    buffer_load_dwordx4 v[20:23], v2, s[28:31], s55 offen sc1
    s_branch t1_28
tl_41:
    s_mov_b64 exec, vcc
    buffer_load_dwordx4 v[16:19], v2, s[28:31], s54 offen sc1
    buffer_load_dwordx4 v[20:23], v2, s[28:31], s55 offen sc1
    s_mov_b64 exec, -1
    s_sub_u32 s79, s79, 1
    s_cbranch_scc1 L_abort
fin_10:
    s_waitcnt vmcnt(2) lgkmcnt(0)
    v_max3_u32 v12, v16, v17, v18
    v_max3_u32 v14, v19, v20, v21
    v_max3_u32 v12, v12, v22, v23
    v_max_u32 v12, v12, v14
    v_cmp_eq_u32 vcc, -1, v12
    s_cbranch_vccnz tl_41
    v_smfmac_f32_16x16x64_bf16 v[56:59], v[16:19], v[72:79], v0
    ds_write_b128 v2, v[16:19]
    v_smfmac_f32_16x16x64_bf16 v[60:63], v[16:19], v[80:87], v0
    ds_write_b128 v2, v[20:23] offset:4096
    v_smfmac_f32_16x16x64_bf16 v[56:59], v[20:23], a[80:87], v0
    v_smfmac_f32_16x16x64_bf16 v[60:63], v[20:23], a[88:95], v0
    s_waitcnt lgkmcnt(0)
    s_barrier
    v_smfmac_f32_16x16x64_bf16 v[64:67], v[16:19], a[176:183], v0
    ds_read_b128 v[24:27], v104 offset:16384
    ds_read_b128 v[28:31], v104 offset:20480
    v_smfmac_f32_16x16x64_bf16 v[68:71], v[16:19], a[184:191], v0
    ds_read_b128 v[32:35], v105 offset:16384
    ds_read_b128 v[36:39], v105 offset:20480
    v_smfmac_f32_16x16x64_bf16 v[64:67], v[20:23], a[192:199], v0
    ds_read_b128 v[40:43], v106 offset:16384
    ds_read_b128 v[44:47], v106 offset:20480
    v_smfmac_f32_16x16x64_bf16 v[68:71], v[20:23], a[200:207], v0
    buffer_store_dwordx4 v[92:95], v1, s[28:31], s69 offen sc1
    s_add_u32 s55, s69, 9437184
    buffer_store_dwordx4 v[108:111], v1, s[28:31], s55 offen sc1
    s_add_u32 s69, s69, 131072
    s_sub_u32 s53, s50, 1
    s_max_i32 s53, s53, 0
    v_mov_b32 v14, s53
    v_mov_b32 v15, 24576
    s_mov_b64 exec, s[62:63]
    buffer_store_dword v14, v15, s[28:31], s66 offen sc1
    s_mov_b64 exec, -1
    s_waitcnt lgkmcnt(5)
    v_smfmac_f32_16x16x64_bf16 v[56:59], v[24:27], a[96:103], v0
    v_smfmac_f32_16x16x64_bf16 v[60:63], v[24:27], a[104:111], v0
    s_waitcnt lgkmcnt(4)
    v_smfmac_f32_16x16x64_bf16 v[56:59], v[28:31], a[112:119], v0
    v_smfmac_f32_16x16x64_bf16 v[60:63], v[28:31], a[120:127], v0
    s_waitcnt lgkmcnt(3)
    v_smfmac_f32_16x16x64_bf16 v[56:59], v[32:35], a[128:135], v0
    ds_read_b128 v[72:75], v8 offset:0
    ds_read_b128 v[76:79], v8 offset:1024
    s_waitcnt lgkmcnt(0)
    v_smfmac_f32_16x16x64_bf16 v[60:63], v[32:35], v[72:79], v0
    v_smfmac_f32_16x16x64_bf16 v[56:59], v[36:39], a[136:143], v0
    v_smfmac_f32_16x16x64_bf16 v[60:63], v[36:39], a[144:151], v0
    v_smfmac_f32_16x16x64_bf16 v[56:59], v[40:43], a[152:159], v0
    v_smfmac_f32_16x16x64_bf16 v[60:63], v[40:43], a[160:167], v0
    v_smfmac_f32_16x16x64_bf16 v[56:59], v[44:47], a[168:175], v0
    ds_read_b128 v[80:83], v8 offset:8192
    ds_read_b128 v[84:87], v8 offset:9216
    s_waitcnt lgkmcnt(0)
    v_smfmac_f32_16x16x64_bf16 v[60:63], v[44:47], v[80:87], v0
    v_smfmac_f32_16x16x64_bf16 v[64:67], v[24:27], a[208:215], v0
    v_smfmac_f32_16x16x64_bf16 v[68:71], v[24:27], a[216:223], v0
    v_smfmac_f32_16x16x64_bf16 v[64:67], v[28:31], a[224:231], v0
    v_smfmac_f32_16x16x64_bf16 v[68:71], v[28:31], a[232:239], v0
    v_add_f32 v56, v56, v58
    v_smfmac_f32_16x16x64_bf16 v[64:67], v[32:35], a[240:247], v0
    v_add_f32 v60, v60, v62
    v_smfmac_f32_16x16x64_bf16 v[68:71], v[32:35], a[248:255], v0
    v_add_f32 v57, v57, v59
    ds_read_b128 v[72:75], v7 offset:40960
    ds_read_b128 v[76:79], v7 offset:41984
    s_waitcnt lgkmcnt(0)
    v_smfmac_f32_16x16x64_bf16 v[64:67], v[36:39], v[72:79], v0
    v_add_f32 v61, v61, v63
    v_smfmac_f32_16x16x64_bf16 v[68:71], v[36:39], v[128:135], v0
    v_cvt_pk_bf16_f32 v56, v56, v60
    v_smfmac_f32_16x16x64_bf16 v[64:67], v[40:43], v[136:143], v0
    v_cvt_pk_bf16_f32 v57, v57, v61
    v_smfmac_f32_16x16x64_bf16 v[68:71], v[40:43], v[144:151], v0
    ds_write2_b32 v3, v56, v57 offset0:32 offset1:48
    v_smfmac_f32_16x16x64_bf16 v[64:67], v[44:47], v[152:159], v0
    v_smfmac_f32_16x16x64_bf16 v[68:71], v[44:47], v[160:167], v0
    s_nop 3
    v_add_f32 v64, v64, v66
    v_add_f32 v65, v65, v67
    s_nop 1
    v_add_f32 v68, v68, v70
    v_add_f32 v69, v69, v71
    v_cvt_pk_bf16_f32 v108, v64, v65
    v_cvt_pk_bf16_f32 v110, v68, v69
    v_mov_b32 v109, 0
    v_mov_b32 v111, 0
    s_waitcnt lgkmcnt(0)
    s_barrier
    ds_read_b128 v[92:95], v4
    s_waitcnt lgkmcnt(0)
    buffer_store_dwordx4 v[92:95], v1, s[28:31], s69 offen sc1
    s_add_u32 s55, s69, 9437184
    buffer_store_dwordx4 v[108:111], v1, s[28:31], s55 offen sc1
    s_add_u32 s69, s69, 131072
    s_waitcnt vmcnt(0)
    s_barrier
    v_mov_b32 v96, 64
    v_mov_b32 v97, 24576
    s_mov_b64 exec, s[62:63]
    buffer_store_dword v96, v97, s[28:31], s66 offen sc1
    s_mov_b64 exec, -1
    s_load_dwordx4 s[4:7], s[0:1], 0
    s_load_dwordx2 s[8:9], s[0:1], 16
    s_load_dwordx2 s[10:11], s[0:1], 32
    s_load_dwordx8 s[12:19], s[0:1], 40
    s_load_dwordx8 s[20:27], s[0:1], 80
    s_waitcnt lgkmcnt(0)
L_worker2:
    s_mov_b32 s36, s4
    s_and_b32 s37, s5, 0xffff
    s_mov_b32 s38, 0x200000
    s_mov_b32 s39, 0x00020000
    s_cmp_eq_u32 s51, -1
    s_cbranch_scc1 L_worker
    s_mov_b32 s57, s51
    s_mov_b32 s51, -1
    s_branch L_atb_go
L_wentry:
L_worker:
    s_barrier
    s_cmp_lg_u32 s48, 0
    s_cbranch_scc1 at_42
    v_mov_b32 v16, 1
    v_mov_b32 v17, 12
    s_mov_b64 exec, 1
    buffer_atomic_add v16, v17, s[40:43], 0 offen sc0
    s_waitcnt vmcnt(0)
    v_mov_b32 v17, 163328
    ds_write_b32 v17, v16
    s_mov_b64 exec, -1
    s_waitcnt lgkmcnt(0)
at_42:
    s_barrier
    v_mov_b32 v17, 163328
    ds_read_b32 v16, v17
    s_waitcnt lgkmcnt(0)
    v_readfirstlane_b32 s57, v16
    s_nop 0
    s_cmp_ge_u32 s57, 441
    s_nop 2
    s_cbranch_scc1 L_end
    s_cmp_lg_u32 s57, 0
    s_cbranch_scc1 L_nozero
    v_mbcnt_lo_u32_b32 v20, -1, 0
    v_mbcnt_hi_u32_b32 v20, -1, v20
    s_lshl_b32 s52, s48, 6
    v_add_u32 v20, s52, v20
    v_lshlrev_b32 v20, 4, v20
    v_mov_b32 v16, 0
    v_mov_b32 v17, 0
    v_mov_b32 v18, 0
    v_mov_b32 v19, 0
    s_mov_b32 s52, 0
    buffer_store_dwordx4 v[16:19], v20, s[28:31], s52 offen sc1
    s_mov_b32 s52, 4096
    buffer_store_dwordx4 v[16:19], v20, s[28:31], s52 offen sc1
    s_mov_b32 s52, 8192
    buffer_store_dwordx4 v[16:19], v20, s[28:31], s52 offen sc1
    s_mov_b32 s52, 12288
    buffer_store_dwordx4 v[16:19], v20, s[28:31], s52 offen sc1
    s_mov_b32 s52, 16384
    buffer_store_dwordx4 v[16:19], v20, s[28:31], s52 offen sc1
    s_mov_b32 s52, 20480
    buffer_store_dwordx4 v[16:19], v20, s[28:31], s52 offen sc1
    s_mov_b32 s52, 24576
    buffer_store_dwordx4 v[16:19], v20, s[28:31], s52 offen sc1
    s_waitcnt vmcnt(0)
    s_barrier
    v_mov_b32 v16, 1
    v_mov_b32 v17, 16
    s_mov_b64 exec, 1
    buffer_store_dword v16, v17, s[40:43], 0 offen sc1
    s_mov_b64 exec, -1
L_nozero:
    s_cmp_ge_u32 s57, 64
    s_cbranch_scc1 L_noxf
    v_mbcnt_lo_u32_b32 v16, -1, 0
    v_mbcnt_hi_u32_b32 v16, -1, v16
    v_lshrrev_b32 v17, 4, v16
    v_and_b32 v18, 15, v16
    v_lshrrev_b32 v19, 2, v18
    v_lshlrev_b32 v20, 13, v19
    v_and_b32 v19, 3, v18
    v_lshl_add_u32 v20, v19, 10, v20
    v_lshl_add_u32 v20, v17, 4, v20
    v_lshlrev_b32 v21, 4, v16
    s_lshl_b32 s52, s57, 15
    s_lshl_b32 s53, s48, 8
    s_add_u32 s53, s52, s53
    s_add_u32 s54, s53, 4096
    buffer_load_dwordx4 v[32:35], v20, s[36:39], s53 offen offset:0
    buffer_load_dwordx4 v[36:39], v20, s[36:39], s54 offen offset:0
    buffer_load_dwordx4 v[40:43], v20, s[36:39], s53 offen offset:64
    buffer_load_dwordx4 v[44:47], v20, s[36:39], s54 offen offset:64
    buffer_load_dwordx4 v[48:51], v20, s[36:39], s53 offen offset:128
    buffer_load_dwordx4 v[52:55], v20, s[36:39], s54 offen offset:128
    buffer_load_dwordx4 v[56:59], v20, s[36:39], s53 offen offset:192
    buffer_load_dwordx4 v[60:63], v20, s[36:39], s54 offen offset:192
    s_lshl_b32 s53, s48, 13
    s_add_u32 s52, s52, s53
    s_add_u32 s52, s52, 8388608
    s_add_u32 s53, s52, 4096
    s_waitcnt vmcnt(7)
    buffer_store_dwordx4 v[32:35], v21, s[28:31], s52 offen offset:0 sc1
    s_waitcnt vmcnt(7)
    buffer_store_dwordx4 v[36:39], v21, s[28:31], s52 offen offset:1024 sc1
    s_waitcnt vmcnt(7)
    buffer_store_dwordx4 v[40:43], v21, s[28:31], s52 offen offset:2048 sc1
    s_waitcnt vmcnt(7)
    buffer_store_dwordx4 v[44:47], v21, s[28:31], s52 offen offset:3072 sc1
    s_waitcnt vmcnt(7)
    buffer_store_dwordx4 v[48:51], v21, s[28:31], s53 offen offset:0 sc1
    s_waitcnt vmcnt(7)
    buffer_store_dwordx4 v[52:55], v21, s[28:31], s53 offen offset:1024 sc1
    s_waitcnt vmcnt(7)
    buffer_store_dwordx4 v[56:59], v21, s[28:31], s53 offen offset:2048 sc1
    s_waitcnt vmcnt(7)
    buffer_store_dwordx4 v[60:63], v21, s[28:31], s53 offen offset:3072 sc1
    v_mov_b32 v27, 16
    s_nop 1
gate_43:
    s_sub_u32 s79, s79, 1
    s_cbranch_scc1 L_abort
    buffer_load_dword v26, v27, s[40:43], 0 offen sc1
    s_waitcnt vmcnt(0)
    v_readfirstlane_b32 s55, v26
    s_nop 0
    s_cmp_lg_u32 s55, 0
    s_nop 2
    s_cbranch_scc1 gok_44
    s_sleep 16
    s_branch gate_43
gok_44:
    s_waitcnt vmcnt(0)
    s_barrier
    s_lshl_b32 s52, s57, 2
    s_add_u32 s52, s52, 20480
    v_mov_b32 v19, s52
    v_mov_b32 v17, 1
    s_mov_b64 exec, 1
    buffer_store_dword v17, v19, s[28:31], 0 offen sc1
    s_mov_b64 exec, -1
L_noxf:
    s_cmp_ge_u32 s57, 216
    s_cbranch_scc1 L_notg1
    v_mbcnt_lo_u32_b32 v16, -1, 0
    v_mbcnt_hi_u32_b32 v16, -1, v16
    v_lshrrev_b32 v17, 4, v16
    v_and_b32 v18, 15, v16
    s_and_b32 s70, s57, 3
    s_and_b32 s57, s57, -4
    s_add_u32 s57, s57, s48
    v_lshlrev_b32 v23, 4, v16
    s_cmp_ge_u32 s57, 64
    s_nop 0
    s_cbranch_scc1 g1v_45
    s_mov_b32 s32, s14
    s_and_b32 s33, s15, 0xffff
    s_mov_b32 s34, 0x400000
    s_mov_b32 s35, 0x00020000
    s_mov_b32 s60, 8192
    s_sub_u32 s52, s57, 0
    s_lshl_b32 s61, s52, 7
    s_mov_b32 s62, 0
    s_lshr_b32 s53, s52, 1
    s_lshl_b32 s53, s53, 13
    s_and_b32 s54, s52, 1
    s_mov_b32 s64, 262144
    s_lshl_b32 s54, s54, 11
    s_add_u32 s53, s53, s54
    s_add_u32 s66, s53, 16777216
    s_add_u32 s67, s53, 16781312
    s_add_u32 s68, s53, 16778240
    s_add_u32 s69, s53, 16782336
    s_branch g1dec_51
g1v_45:
    s_cmp_ge_u32 s57, 128
    s_cbranch_scc1 g1q_46
    s_mov_b32 s32, s16
    s_and_b32 s33, s17, 0xffff
    s_mov_b32 s34, 0x400000
    s_mov_b32 s35, 0x00020000
    s_mov_b32 s60, 8192
    s_sub_u32 s52, s57, 64
    s_lshl_b32 s61, s52, 7
    s_mov_b32 s62, 1
    s_lshr_b32 s53, s52, 1
    s_lshl_b32 s53, s53, 13
    s_and_b32 s54, s52, 1
    s_mov_b32 s64, 262144
    s_lshl_b32 s54, s54, 12
    s_add_u32 s53, s53, s54
    s_add_u32 s66, s53, 33554432
    s_add_u32 s67, s53, 33555456
    s_add_u32 s68, s53, 33556480
    s_add_u32 s69, s53, 33557504
    s_branch g1dec_51
g1q_46:
    s_cmp_ge_u32 s57, 192
    s_cbranch_scc1 g1aq_47
    s_mov_b32 s32, s12
    s_and_b32 s33, s13, 0xffff
    s_mov_b32 s34, 0x400000
    s_mov_b32 s35, 0x00020000
    s_mov_b32 s60, 8192
    s_sub_u32 s52, s57, 128
    s_lshl_b32 s61, s52, 7
    s_mov_b32 s62, 0
    s_lshr_b32 s53, s52, 1
    s_lshl_b32 s53, s53, 13
    s_and_b32 s54, s52, 1
    s_mov_b32 s64, 262144
    s_lshl_b32 s54, s54, 11
    s_add_u32 s53, s53, s54
    s_add_u32 s66, s53, 50331648
    s_add_u32 s67, s53, 50335744
    s_add_u32 s68, s53, 50332672
    s_add_u32 s69, s53, 50336768
    s_branch g1dec_51
g1aq_47:
    s_cmp_ge_u32 s57, 200
    s_cbranch_scc1 g1ak_48
    s_mov_b32 s32, s6
    s_and_b32 s33, s7, 0xffff
    s_mov_b32 s34, 0x180000
    s_mov_b32 s35, 0x00020000
    s_mov_b32 s60, 3072
    s_sub_u32 s52, s57, 192
    s_lshl_b32 s61, s52, 7
    s_add_u32 s61, s61, 0
    s_mov_b32 s62, 0
    s_lshl_b32 s53, s52, 18
    s_mov_b32 s64, 1024
    v_lshrrev_b32 v19, 1, v17
    v_lshlrev_b32 v23, 16, v19
    v_and_b32 v19, 1, v17
    v_lshl_add_u32 v23, v19, 9, v23
    v_and_b32 v19, 3, v18
    v_lshl_add_u32 v23, v19, 4, v23
    v_lshrrev_b32 v19, 2, v18
    v_lshl_add_u32 v23, v19, 7, v23
    s_add_u32 s66, s53, 88080384
    s_add_u32 s67, s53, 88080448
    s_add_u32 s68, s53, 88211456
    s_add_u32 s69, s53, 88211520
    s_branch g1dec_51
g1ak_48:
    s_cmp_ge_u32 s57, 208
    s_cbranch_scc1 g1av_49
    s_mov_b32 s32, s6
    s_and_b32 s33, s7, 0xffff
    s_mov_b32 s34, 0x180000
    s_mov_b32 s35, 0x00020000
    s_mov_b32 s60, 3072
    s_sub_u32 s52, s57, 200
    s_lshl_b32 s61, s52, 7
    s_add_u32 s61, s61, 1024
    s_mov_b32 s62, 0
    s_lshl_b32 s53, s52, 18
    s_mov_b32 s64, 1024
    v_lshrrev_b32 v19, 1, v17
    v_lshlrev_b32 v23, 16, v19
    v_and_b32 v19, 1, v17
    v_lshl_add_u32 v23, v19, 9, v23
    v_and_b32 v19, 3, v18
    v_lshl_add_u32 v23, v19, 4, v23
    v_lshrrev_b32 v19, 3, v18
    v_lshl_add_u32 v23, v19, 8, v23
    v_bfe_u32 v19, v18, 2, 1
    v_lshl_add_u32 v23, v19, 6, v23
    s_add_u32 s66, s53, 90177536
    s_add_u32 s67, s53, 90177664
    s_add_u32 s68, s53, 90308608
    s_add_u32 s69, s53, 90308736
    s_branch g1dec_51
g1av_49:
    s_mov_b32 s32, s6
    s_and_b32 s33, s7, 0xffff
    s_mov_b32 s34, 0x180000
    s_mov_b32 s35, 0x00020000
    s_mov_b32 s60, 3072
    s_sub_u32 s52, s57, 208
    s_lshl_b32 s61, s52, 7
    s_add_u32 s61, s61, 2048
    s_mov_b32 s62, 1
    s_lshl_b32 s53, s52, 18
    s_mov_b32 s64, 1024
    s_add_u32 s66, s53, 92274688
    s_add_u32 s67, s53, 92340224
    s_add_u32 s68, s53, 92405760
    s_add_u32 s69, s53, 92471296
    s_branch g1dec_51
g1dec_51:
    v_lshrrev_b32 v19, 3, v16
    v_mul_lo_u32 v20, v19, s60
    v_and_b32 v19, 3, v19
    v_lshlrev_b32 v19, 1, v19
    v_and_b32 v22, 7, v16
    v_xor_b32 v19, v19, v22
    v_lshl_add_u32 v20, v19, 4, v20
    v_add_u32 v20, s61, v20
    s_mov_b32 s63, 0
    s_lshl_b32 s60, s60, 3
    s_lshl_b32 s65, s48, 15
    s_add_u32 m0, s65, 0
    s_nop 0
    buffer_load_dwordx4 v20, s[32:35], s63 offen lds
    s_add_u32 s63, s63, s60
    s_add_u32 m0, s65, 1024
    s_nop 0
    buffer_load_dwordx4 v20, s[32:35], s63 offen lds
    s_add_u32 s63, s63, s60
    s_add_u32 m0, s65, 2048
    s_nop 0
    buffer_load_dwordx4 v20, s[32:35], s63 offen lds
    s_add_u32 s63, s63, s60
    s_add_u32 m0, s65, 3072
    s_nop 0
    buffer_load_dwordx4 v20, s[32:35], s63 offen lds
    s_add_u32 s63, s63, s60
    s_add_u32 m0, s65, 4096
    s_nop 0
    buffer_load_dwordx4 v20, s[32:35], s63 offen lds
    s_add_u32 s63, s63, s60
    s_add_u32 m0, s65, 5120
    s_nop 0
    buffer_load_dwordx4 v20, s[32:35], s63 offen lds
    s_add_u32 s63, s63, s60
    s_add_u32 m0, s65, 6144
    s_nop 0
    buffer_load_dwordx4 v20, s[32:35], s63 offen lds
    s_add_u32 s63, s63, s60
    s_add_u32 m0, s65, 7168
    s_nop 0
    buffer_load_dwordx4 v20, s[32:35], s63 offen lds
    s_add_u32 s63, s63, s60
    s_add_u32 m0, s65, 8192
    s_nop 0
    buffer_load_dwordx4 v20, s[32:35], s63 offen lds
    s_add_u32 s63, s63, s60
    s_add_u32 m0, s65, 9216
    s_nop 0
    buffer_load_dwordx4 v20, s[32:35], s63 offen lds
    s_add_u32 s63, s63, s60
    s_add_u32 m0, s65, 10240
    s_nop 0
    buffer_load_dwordx4 v20, s[32:35], s63 offen lds
    s_add_u32 s63, s63, s60
    s_add_u32 m0, s65, 11264
    s_nop 0
    buffer_load_dwordx4 v20, s[32:35], s63 offen lds
    s_add_u32 s63, s63, s60
    s_add_u32 m0, s65, 12288
    s_nop 0
    buffer_load_dwordx4 v20, s[32:35], s63 offen lds
    s_add_u32 s63, s63, s60
    s_add_u32 m0, s65, 13312
    s_nop 0
    buffer_load_dwordx4 v20, s[32:35], s63 offen lds
    s_add_u32 s63, s63, s60
    s_add_u32 m0, s65, 14336
    s_nop 0
    buffer_load_dwordx4 v20, s[32:35], s63 offen lds
    s_add_u32 s63, s63, s60
    s_add_u32 m0, s65, 15360
    s_nop 0
    buffer_load_dwordx4 v20, s[32:35], s63 offen lds
    s_add_u32 s63, s63, s60
    s_add_u32 m0, s65, 16384
    s_nop 0
    buffer_load_dwordx4 v20, s[32:35], s63 offen lds
    s_add_u32 s63, s63, s60
    s_add_u32 m0, s65, 17408
    s_nop 0
    buffer_load_dwordx4 v20, s[32:35], s63 offen lds
    s_add_u32 s63, s63, s60
    s_add_u32 m0, s65, 18432
    s_nop 0
    buffer_load_dwordx4 v20, s[32:35], s63 offen lds
    s_add_u32 s63, s63, s60
    s_add_u32 m0, s65, 19456
    s_nop 0
    buffer_load_dwordx4 v20, s[32:35], s63 offen lds
    s_add_u32 s63, s63, s60
    s_add_u32 m0, s65, 20480
    s_nop 0
    buffer_load_dwordx4 v20, s[32:35], s63 offen lds
    s_add_u32 s63, s63, s60
    s_add_u32 m0, s65, 21504
    s_nop 0
    buffer_load_dwordx4 v20, s[32:35], s63 offen lds
    s_add_u32 s63, s63, s60
    s_add_u32 m0, s65, 22528
    s_nop 0
    buffer_load_dwordx4 v20, s[32:35], s63 offen lds
    s_add_u32 s63, s63, s60
    s_add_u32 m0, s65, 23552
    s_nop 0
    buffer_load_dwordx4 v20, s[32:35], s63 offen lds
    s_add_u32 s63, s63, s60
    s_add_u32 m0, s65, 24576
    s_nop 0
    buffer_load_dwordx4 v20, s[32:35], s63 offen lds
    s_add_u32 s63, s63, s60
    s_add_u32 m0, s65, 25600
    s_nop 0
    buffer_load_dwordx4 v20, s[32:35], s63 offen lds
    s_add_u32 s63, s63, s60
    s_add_u32 m0, s65, 26624
    s_nop 0
    buffer_load_dwordx4 v20, s[32:35], s63 offen lds
    s_add_u32 s63, s63, s60
    s_add_u32 m0, s65, 27648
    s_nop 0
    buffer_load_dwordx4 v20, s[32:35], s63 offen lds
    s_add_u32 s63, s63, s60
    s_add_u32 m0, s65, 28672
    s_nop 0
    buffer_load_dwordx4 v20, s[32:35], s63 offen lds
    s_add_u32 s63, s63, s60
    s_add_u32 m0, s65, 29696
    s_nop 0
    buffer_load_dwordx4 v20, s[32:35], s63 offen lds
    s_add_u32 s63, s63, s60
    s_add_u32 m0, s65, 30720
    s_nop 0
    buffer_load_dwordx4 v20, s[32:35], s63 offen lds
    s_add_u32 s63, s63, s60
    s_add_u32 m0, s65, 31744
    s_nop 0
    buffer_load_dwordx4 v20, s[32:35], s63 offen lds
    s_add_u32 s63, s63, s60
    v_bfe_u32 v19, v16, 2, 2
    v_lshl_add_u32 v21, v17, 3, v19
    v_lshlrev_b32 v21, 7, v21
    v_add_u32 v21, s65, v21
    v_lshlrev_b32 v19, 1, v19
    v_and_b32 v22, 3, v16
    s_cmp_eq_u32 s62, 0
    s_nop 0
    s_cbranch_scc0 trv_52
    v_add_u32 v24, 0, v22
    v_xor_b32 v24, v24, v19
    v_lshl_add_u32 v28, v24, 4, v21
    v_add_u32 v24, 0, v22
    v_xor_b32 v24, v24, v19
    v_lshl_add_u32 v29, v24, 4, v21
    v_add_u32 v29, 8, v29
    v_add_u32 v24, 4, v22
    v_xor_b32 v24, v24, v19
    v_lshl_add_u32 v30, v24, 4, v21
    v_add_u32 v24, 4, v22
    v_xor_b32 v24, v24, v19
    v_lshl_add_u32 v31, v24, 4, v21
    v_add_u32 v31, 8, v31
    s_nop 1
    s_branch trd_53
trv_52:
    v_lshrrev_b32 v24, 1, v22
    v_add_u32 v24, 0, v24
    v_xor_b32 v24, v24, v19
    v_lshl_add_u32 v28, v24, 4, v21
    v_and_b32 v24, 1, v22
    v_lshl_add_u32 v28, v24, 3, v28
    v_lshrrev_b32 v24, 1, v22
    v_add_u32 v24, 2, v24
    v_xor_b32 v24, v24, v19
    v_lshl_add_u32 v29, v24, 4, v21
    v_and_b32 v24, 1, v22
    v_lshl_add_u32 v29, v24, 3, v29
    v_lshrrev_b32 v24, 1, v22
    v_add_u32 v24, 4, v24
    v_xor_b32 v24, v24, v19
    v_lshl_add_u32 v30, v24, 4, v21
    v_and_b32 v24, 1, v22
    v_lshl_add_u32 v30, v24, 3, v30
    v_lshrrev_b32 v24, 1, v22
    v_add_u32 v24, 6, v24
    v_xor_b32 v24, v24, v19
    v_lshl_add_u32 v31, v24, 4, v21
    v_and_b32 v24, 1, v22
    v_lshl_add_u32 v31, v24, 3, v31
    s_nop 1
trd_53:
    s_waitcnt vmcnt(28)
    ds_read_b64_tr_b16 a[0:1], v28 offset:0
    ds_read_b64_tr_b16 a[2:3], v28 offset:512
    ds_read_b64_tr_b16 a[64:65], v29 offset:0
    ds_read_b64_tr_b16 a[66:67], v29 offset:512
    ds_read_b64_tr_b16 a[128:129], v30 offset:0
    ds_read_b64_tr_b16 a[130:131], v30 offset:512
    ds_read_b64_tr_b16 a[192:193], v31 offset:0
    ds_read_b64_tr_b16 a[194:195], v31 offset:512
    s_waitcnt lgkmcnt(0)
    s_waitcnt vmcnt(24)
    ds_read_b64_tr_b16 a[4:5], v28 offset:4096
    ds_read_b64_tr_b16 a[6:7], v28 offset:4608
    ds_read_b64_tr_b16 a[68:69], v29 offset:4096
    ds_read_b64_tr_b16 a[70:71], v29 offset:4608
    ds_read_b64_tr_b16 a[132:133], v30 offset:4096
    ds_read_b64_tr_b16 a[134:135], v30 offset:4608
    ds_read_b64_tr_b16 a[196:197], v31 offset:4096
    ds_read_b64_tr_b16 a[198:199], v31 offset:4608
    s_waitcnt lgkmcnt(0)
    s_waitcnt vmcnt(20)
    ds_read_b64_tr_b16 a[8:9], v28 offset:8192
    ds_read_b64_tr_b16 a[10:11], v28 offset:8704
    ds_read_b64_tr_b16 a[72:73], v29 offset:8192
    ds_read_b64_tr_b16 a[74:75], v29 offset:8704
    ds_read_b64_tr_b16 a[136:137], v30 offset:8192
    ds_read_b64_tr_b16 a[138:139], v30 offset:8704
    ds_read_b64_tr_b16 a[200:201], v31 offset:8192
    ds_read_b64_tr_b16 a[202:203], v31 offset:8704
    s_waitcnt lgkmcnt(0)
    s_waitcnt vmcnt(16)
    ds_read_b64_tr_b16 a[12:13], v28 offset:12288
    ds_read_b64_tr_b16 a[14:15], v28 offset:12800
    ds_read_b64_tr_b16 a[76:77], v29 offset:12288
    ds_read_b64_tr_b16 a[78:79], v29 offset:12800
    ds_read_b64_tr_b16 a[140:141], v30 offset:12288
    ds_read_b64_tr_b16 a[142:143], v30 offset:12800
    ds_read_b64_tr_b16 a[204:205], v31 offset:12288
    ds_read_b64_tr_b16 a[206:207], v31 offset:12800
    s_waitcnt lgkmcnt(0)
    s_waitcnt vmcnt(12)
    ds_read_b64_tr_b16 a[16:17], v28 offset:16384
    ds_read_b64_tr_b16 a[18:19], v28 offset:16896
    ds_read_b64_tr_b16 a[80:81], v29 offset:16384
    ds_read_b64_tr_b16 a[82:83], v29 offset:16896
    ds_read_b64_tr_b16 a[144:145], v30 offset:16384
    ds_read_b64_tr_b16 a[146:147], v30 offset:16896
    ds_read_b64_tr_b16 a[208:209], v31 offset:16384
    ds_read_b64_tr_b16 a[210:211], v31 offset:16896
    s_waitcnt lgkmcnt(0)
    s_waitcnt vmcnt(8)
    ds_read_b64_tr_b16 a[20:21], v28 offset:20480
    ds_read_b64_tr_b16 a[22:23], v28 offset:20992
    ds_read_b64_tr_b16 a[84:85], v29 offset:20480
    ds_read_b64_tr_b16 a[86:87], v29 offset:20992
    ds_read_b64_tr_b16 a[148:149], v30 offset:20480
    ds_read_b64_tr_b16 a[150:151], v30 offset:20992
    ds_read_b64_tr_b16 a[212:213], v31 offset:20480
    ds_read_b64_tr_b16 a[214:215], v31 offset:20992
    s_waitcnt lgkmcnt(0)
    s_waitcnt vmcnt(4)
    ds_read_b64_tr_b16 a[24:25], v28 offset:24576
    ds_read_b64_tr_b16 a[26:27], v28 offset:25088
    ds_read_b64_tr_b16 a[88:89], v29 offset:24576
    ds_read_b64_tr_b16 a[90:91], v29 offset:25088
    ds_read_b64_tr_b16 a[152:153], v30 offset:24576
    ds_read_b64_tr_b16 a[154:155], v30 offset:25088
    ds_read_b64_tr_b16 a[216:217], v31 offset:24576
    ds_read_b64_tr_b16 a[218:219], v31 offset:25088
    s_waitcnt lgkmcnt(0)
    s_waitcnt vmcnt(0)
    ds_read_b64_tr_b16 a[28:29], v28 offset:28672
    ds_read_b64_tr_b16 a[30:31], v28 offset:29184
    ds_read_b64_tr_b16 a[92:93], v29 offset:28672
    ds_read_b64_tr_b16 a[94:95], v29 offset:29184
    ds_read_b64_tr_b16 a[156:157], v30 offset:28672
    ds_read_b64_tr_b16 a[158:159], v30 offset:29184
    ds_read_b64_tr_b16 a[220:221], v31 offset:28672
    ds_read_b64_tr_b16 a[222:223], v31 offset:29184
    s_waitcnt lgkmcnt(0)
    s_add_u32 m0, s65, 0
    s_nop 0
    buffer_load_dwordx4 v20, s[32:35], s63 offen lds
    s_add_u32 s63, s63, s60
    s_add_u32 m0, s65, 1024
    s_nop 0
    buffer_load_dwordx4 v20, s[32:35], s63 offen lds
    s_add_u32 s63, s63, s60
    s_add_u32 m0, s65, 2048
    s_nop 0
    buffer_load_dwordx4 v20, s[32:35], s63 offen lds
    s_add_u32 s63, s63, s60
    s_add_u32 m0, s65, 3072
    s_nop 0
    buffer_load_dwordx4 v20, s[32:35], s63 offen lds
    s_add_u32 s63, s63, s60
    s_add_u32 m0, s65, 4096
    s_nop 0
    buffer_load_dwordx4 v20, s[32:35], s63 offen lds
    s_add_u32 s63, s63, s60
    s_add_u32 m0, s65, 5120
    s_nop 0
    buffer_load_dwordx4 v20, s[32:35], s63 offen lds
    s_add_u32 s63, s63, s60
    s_add_u32 m0, s65, 6144
    s_nop 0
    buffer_load_dwordx4 v20, s[32:35], s63 offen lds
    s_add_u32 s63, s63, s60
    s_add_u32 m0, s65, 7168
    s_nop 0
    buffer_load_dwordx4 v20, s[32:35], s63 offen lds
    s_add_u32 s63, s63, s60
    s_add_u32 m0, s65, 8192
    s_nop 0
    buffer_load_dwordx4 v20, s[32:35], s63 offen lds
    s_add_u32 s63, s63, s60
    s_add_u32 m0, s65, 9216
    s_nop 0
    buffer_load_dwordx4 v20, s[32:35], s63 offen lds
    s_add_u32 s63, s63, s60
    s_add_u32 m0, s65, 10240
    s_nop 0
    buffer_load_dwordx4 v20, s[32:35], s63 offen lds
    s_add_u32 s63, s63, s60
    s_add_u32 m0, s65, 11264
    s_nop 0
    buffer_load_dwordx4 v20, s[32:35], s63 offen lds
    s_add_u32 s63, s63, s60
    s_add_u32 m0, s65, 12288
    s_nop 0
    buffer_load_dwordx4 v20, s[32:35], s63 offen lds
    s_add_u32 s63, s63, s60
    s_add_u32 m0, s65, 13312
    s_nop 0
    buffer_load_dwordx4 v20, s[32:35], s63 offen lds
    s_add_u32 s63, s63, s60
    s_add_u32 m0, s65, 14336
    s_nop 0
    buffer_load_dwordx4 v20, s[32:35], s63 offen lds
    s_add_u32 s63, s63, s60
    s_add_u32 m0, s65, 15360
    s_nop 0
    buffer_load_dwordx4 v20, s[32:35], s63 offen lds
    s_add_u32 s63, s63, s60
    s_add_u32 m0, s65, 16384
    s_nop 0
    buffer_load_dwordx4 v20, s[32:35], s63 offen lds
    s_add_u32 s63, s63, s60
    s_add_u32 m0, s65, 17408
    s_nop 0
    buffer_load_dwordx4 v20, s[32:35], s63 offen lds
    s_add_u32 s63, s63, s60
    s_add_u32 m0, s65, 18432
    s_nop 0
    buffer_load_dwordx4 v20, s[32:35], s63 offen lds
    s_add_u32 s63, s63, s60
    s_add_u32 m0, s65, 19456
    s_nop 0
    buffer_load_dwordx4 v20, s[32:35], s63 offen lds
    s_add_u32 s63, s63, s60
    s_add_u32 m0, s65, 20480
    s_nop 0
    buffer_load_dwordx4 v20, s[32:35], s63 offen lds
    s_add_u32 s63, s63, s60
    s_add_u32 m0, s65, 21504
    s_nop 0
    buffer_load_dwordx4 v20, s[32:35], s63 offen lds
    s_add_u32 s63, s63, s60
    s_add_u32 m0, s65, 22528
    s_nop 0
    buffer_load_dwordx4 v20, s[32:35], s63 offen lds
    s_add_u32 s63, s63, s60
    s_add_u32 m0, s65, 23552
    s_nop 0
    buffer_load_dwordx4 v20, s[32:35], s63 offen lds
    s_add_u32 s63, s63, s60
    s_add_u32 m0, s65, 24576
    s_nop 0
    buffer_load_dwordx4 v20, s[32:35], s63 offen lds
    s_add_u32 s63, s63, s60
    s_add_u32 m0, s65, 25600
    s_nop 0
    buffer_load_dwordx4 v20, s[32:35], s63 offen lds
    s_add_u32 s63, s63, s60
    s_add_u32 m0, s65, 26624
    s_nop 0
    buffer_load_dwordx4 v20, s[32:35], s63 offen lds
    s_add_u32 s63, s63, s60
    s_add_u32 m0, s65, 27648
    s_nop 0
    buffer_load_dwordx4 v20, s[32:35], s63 offen lds
    s_add_u32 s63, s63, s60
    s_add_u32 m0, s65, 28672
    s_nop 0
    buffer_load_dwordx4 v20, s[32:35], s63 offen lds
    s_add_u32 s63, s63, s60
    s_add_u32 m0, s65, 29696
    s_nop 0
    buffer_load_dwordx4 v20, s[32:35], s63 offen lds
    s_add_u32 s63, s63, s60
    s_add_u32 m0, s65, 30720
    s_nop 0
    buffer_load_dwordx4 v20, s[32:35], s63 offen lds
    s_add_u32 s63, s63, s60
    s_add_u32 m0, s65, 31744
    s_nop 0
    buffer_load_dwordx4 v20, s[32:35], s63 offen lds
    s_add_u32 s63, s63, s60
    s_waitcnt vmcnt(28)
    ds_read_b64_tr_b16 a[32:33], v28 offset:0
    ds_read_b64_tr_b16 a[34:35], v28 offset:512
    ds_read_b64_tr_b16 a[96:97], v29 offset:0
    ds_read_b64_tr_b16 a[98:99], v29 offset:512
    ds_read_b64_tr_b16 a[160:161], v30 offset:0
    ds_read_b64_tr_b16 a[162:163], v30 offset:512
    ds_read_b64_tr_b16 a[224:225], v31 offset:0
    ds_read_b64_tr_b16 a[226:227], v31 offset:512
    s_waitcnt lgkmcnt(0)
    s_waitcnt vmcnt(24)
    ds_read_b64_tr_b16 a[36:37], v28 offset:4096
    ds_read_b64_tr_b16 a[38:39], v28 offset:4608
    ds_read_b64_tr_b16 a[100:101], v29 offset:4096
    ds_read_b64_tr_b16 a[102:103], v29 offset:4608
    ds_read_b64_tr_b16 a[164:165], v30 offset:4096
    ds_read_b64_tr_b16 a[166:167], v30 offset:4608
    ds_read_b64_tr_b16 a[228:229], v31 offset:4096
    ds_read_b64_tr_b16 a[230:231], v31 offset:4608
    s_waitcnt lgkmcnt(0)
    s_waitcnt vmcnt(20)
    ds_read_b64_tr_b16 a[40:41], v28 offset:8192
    ds_read_b64_tr_b16 a[42:43], v28 offset:8704
    ds_read_b64_tr_b16 a[104:105], v29 offset:8192
    ds_read_b64_tr_b16 a[106:107], v29 offset:8704
    ds_read_b64_tr_b16 a[168:169], v30 offset:8192
    ds_read_b64_tr_b16 a[170:171], v30 offset:8704
    ds_read_b64_tr_b16 a[232:233], v31 offset:8192
    ds_read_b64_tr_b16 a[234:235], v31 offset:8704
    s_waitcnt lgkmcnt(0)
    s_waitcnt vmcnt(16)
    ds_read_b64_tr_b16 a[44:45], v28 offset:12288
    ds_read_b64_tr_b16 a[46:47], v28 offset:12800
    ds_read_b64_tr_b16 a[108:109], v29 offset:12288
    ds_read_b64_tr_b16 a[110:111], v29 offset:12800
    ds_read_b64_tr_b16 a[172:173], v30 offset:12288
    ds_read_b64_tr_b16 a[174:175], v30 offset:12800
    ds_read_b64_tr_b16 a[236:237], v31 offset:12288
    ds_read_b64_tr_b16 a[238:239], v31 offset:12800
    s_waitcnt lgkmcnt(0)
    s_waitcnt vmcnt(12)
    ds_read_b64_tr_b16 a[48:49], v28 offset:16384
    ds_read_b64_tr_b16 a[50:51], v28 offset:16896
    ds_read_b64_tr_b16 a[112:113], v29 offset:16384
    ds_read_b64_tr_b16 a[114:115], v29 offset:16896
    ds_read_b64_tr_b16 a[176:177], v30 offset:16384
    ds_read_b64_tr_b16 a[178:179], v30 offset:16896
    ds_read_b64_tr_b16 a[240:241], v31 offset:16384
    ds_read_b64_tr_b16 a[242:243], v31 offset:16896
    s_waitcnt lgkmcnt(0)
    s_waitcnt vmcnt(8)
    ds_read_b64_tr_b16 a[52:53], v28 offset:20480
    ds_read_b64_tr_b16 a[54:55], v28 offset:20992
    ds_read_b64_tr_b16 a[116:117], v29 offset:20480
    ds_read_b64_tr_b16 a[118:119], v29 offset:20992
    ds_read_b64_tr_b16 a[180:181], v30 offset:20480
    ds_read_b64_tr_b16 a[182:183], v30 offset:20992
    ds_read_b64_tr_b16 a[244:245], v31 offset:20480
    ds_read_b64_tr_b16 a[246:247], v31 offset:20992
    s_waitcnt lgkmcnt(0)
    s_waitcnt vmcnt(4)
    ds_read_b64_tr_b16 a[56:57], v28 offset:24576
    ds_read_b64_tr_b16 a[58:59], v28 offset:25088
    ds_read_b64_tr_b16 a[120:121], v29 offset:24576
    ds_read_b64_tr_b16 a[122:123], v29 offset:25088
    ds_read_b64_tr_b16 a[184:185], v30 offset:24576
    ds_read_b64_tr_b16 a[186:187], v30 offset:25088
    ds_read_b64_tr_b16 a[248:249], v31 offset:24576
    ds_read_b64_tr_b16 a[250:251], v31 offset:25088
    s_waitcnt lgkmcnt(0)
    s_waitcnt vmcnt(0)
    ds_read_b64_tr_b16 a[60:61], v28 offset:28672
    ds_read_b64_tr_b16 a[62:63], v28 offset:29184
    ds_read_b64_tr_b16 a[124:125], v29 offset:28672
    ds_read_b64_tr_b16 a[126:127], v29 offset:29184
    ds_read_b64_tr_b16 a[188:189], v30 offset:28672
    ds_read_b64_tr_b16 a[190:191], v30 offset:29184
    ds_read_b64_tr_b16 a[252:253], v31 offset:28672
    ds_read_b64_tr_b16 a[254:255], v31 offset:29184
    s_waitcnt lgkmcnt(0)
    s_lshl_b32 s52, s57, 4
    s_lshl_b32 s53, s70, 2
    s_add_u32 s52, s52, s53
    s_add_u32 s52, s52, 0
    v_mov_b32 v24, s52
    v_lshlrev_b32 v22, 4, v16
    v_mov_b32 v27, 16
    s_nop 1
gate_54:
    s_sub_u32 s79, s79, 1
    s_cbranch_scc1 L_abort
    buffer_load_dword v26, v27, s[40:43], 0 offen sc1
    s_waitcnt vmcnt(0)
    v_readfirstlane_b32 s55, v26
    s_nop 0
    s_cmp_lg_u32 s55, 0
    s_nop 2
    s_cbranch_scc1 gok_55
    s_sleep 16
    s_branch gate_54
gok_55:
    v_lshlrev_b32 v26, 2, v16
    v_add_u32 v26, 20480, v26
    v_mov_b32 v27, 1
    s_nop 1
pf_56:
    buffer_load_dword v25, v26, s[28:31], 0 offen sc1
    s_waitcnt vmcnt(0)
    v_cmp_lt_u32 vcc, v25, v27
    s_nop 4
    s_cbranch_vccz pfok_57
    s_sub_u32 s79, s79, 1
    s_cbranch_scc1 L_abort
    s_sleep 1
    s_branch pf_56
pfok_57:
    s_barrier
    s_cmp_eq_u32 s62, 0
    s_cbranch_scc0 g1V_58
    s_lshl_b32 s65, s70, 15
    s_lshl_b32 s52, s48, 13
    s_add_u32 s65, s65, s52
    s_add_u32 s65, s65, 8388608
    s_mov_b32 s63, s52
    s_mov_b32 s50, 0
    s_mul_i32 s52, s70, s64
    v_mov_b32 v25, v22
    s_add_u32 s66, s66, s52
    s_add_u32 s67, s67, s52
    s_add_u32 s68, s68, s52
    s_add_u32 s69, s69, s52
    s_lshl_b32 s64, s64, 2
    s_add_u32 m0, s63, 0
    s_add_u32 s53, s65, 0
    buffer_load_dwordx4 v22, s[28:31], s53 offen offset:0 lds
    buffer_load_dwordx4 v22, s[28:31], s53 offen offset:1024 lds
    buffer_load_dwordx4 v22, s[28:31], s53 offen offset:2048 lds
    buffer_load_dwordx4 v22, s[28:31], s53 offen offset:3072 lds
    s_add_u32 m0, s63, 4096
    s_add_u32 s53, s65, 4096
    buffer_load_dwordx4 v22, s[28:31], s53 offen offset:0 lds
    buffer_load_dwordx4 v22, s[28:31], s53 offen offset:1024 lds
    buffer_load_dwordx4 v22, s[28:31], s53 offen offset:2048 lds
    buffer_load_dwordx4 v22, s[28:31], s53 offen offset:3072 lds
    s_add_u32 s65, s65, 131072
    s_add_u32 s63, s63, 32768
    s_and_b32 s63, s63, 0x1ffff
    buffer_load_dword v209, v22, s[28:31], s65 offen
    buffer_load_dword v209, v22, s[28:31], s65 offen
    buffer_load_dword v209, v22, s[28:31], s65 offen
    buffer_load_dword v209, v22, s[28:31], s65 offen
    buffer_load_dword v209, v22, s[28:31], s65 offen
    s_add_u32 m0, s63, 0
    s_add_u32 s53, s65, 0
    buffer_load_dwordx4 v22, s[28:31], s53 offen offset:0 lds
    buffer_load_dwordx4 v22, s[28:31], s53 offen offset:1024 lds
    buffer_load_dwordx4 v22, s[28:31], s53 offen offset:2048 lds
    buffer_load_dwordx4 v22, s[28:31], s53 offen offset:3072 lds
    s_add_u32 m0, s63, 4096
    s_add_u32 s53, s65, 4096
    buffer_load_dwordx4 v22, s[28:31], s53 offen offset:0 lds
    buffer_load_dwordx4 v22, s[28:31], s53 offen offset:1024 lds
    buffer_load_dwordx4 v22, s[28:31], s53 offen offset:2048 lds
    buffer_load_dwordx4 v22, s[28:31], s53 offen offset:3072 lds
    s_add_u32 s65, s65, 131072
    s_add_u32 s63, s63, 32768
    s_and_b32 s63, s63, 0x1ffff
    buffer_load_dword v209, v22, s[28:31], s65 offen
    buffer_load_dword v209, v22, s[28:31], s65 offen
    buffer_load_dword v209, v22, s[28:31], s65 offen
    buffer_load_dword v209, v22, s[28:31], s65 offen
    buffer_load_dword v209, v22, s[28:31], s65 offen
    s_add_u32 m0, s63, 0
    s_add_u32 s53, s65, 0
    buffer_load_dwordx4 v22, s[28:31], s53 offen offset:0 lds
    buffer_load_dwordx4 v22, s[28:31], s53 offen offset:1024 lds
    buffer_load_dwordx4 v22, s[28:31], s53 offen offset:2048 lds
    buffer_load_dwordx4 v22, s[28:31], s53 offen offset:3072 lds
    s_add_u32 m0, s63, 4096
    s_add_u32 s53, s65, 4096
    buffer_load_dwordx4 v22, s[28:31], s53 offen offset:0 lds
    buffer_load_dwordx4 v22, s[28:31], s53 offen offset:1024 lds
    buffer_load_dwordx4 v22, s[28:31], s53 offen offset:2048 lds
    buffer_load_dwordx4 v22, s[28:31], s53 offen offset:3072 lds
    s_add_u32 s65, s65, 131072
    s_add_u32 s63, s63, 32768
    s_and_b32 s63, s63, 0x1ffff
    buffer_load_dword v209, v22, s[28:31], s65 offen
    buffer_load_dword v209, v22, s[28:31], s65 offen
    buffer_load_dword v209, v22, s[28:31], s65 offen
    buffer_load_dword v209, v22, s[28:31], s65 offen
    buffer_load_dword v209, v22, s[28:31], s65 offen
g1top_60:
    s_waitcnt vmcnt(31)
    s_barrier
    ds_read_b128 v[64:67], v25 offset:0
    ds_read_b128 v[68:71], v25 offset:1024
    ds_read_b128 v[72:75], v25 offset:2048
    ds_read_b128 v[76:79], v25 offset:3072
    ds_read_b128 v[80:83], v25 offset:4096
    ds_read_b128 v[84:87], v25 offset:5120
    s_waitcnt lgkmcnt(4)
    v_mfma_f32_16x16x32_bf16 v[32:35], a[0:3], v[64:67], 0
    ds_read_b128 v[88:91], v25 offset:6144
    v_mfma_f32_16x16x32_bf16 v[36:39], a[0:3], v[68:71], 0
    v_mfma_f32_16x16x32_bf16 v[40:43], a[64:67], v[64:67], 0
    ds_read_b128 v[92:95], v25 offset:7168
    v_mfma_f32_16x16x32_bf16 v[44:47], a[64:67], v[68:71], 0
    v_mfma_f32_16x16x32_bf16 v[48:51], a[128:131], v[64:67], 0
    v_mfma_f32_16x16x32_bf16 v[52:55], a[128:131], v[68:71], 0
    v_mfma_f32_16x16x32_bf16 v[56:59], a[192:195], v[64:67], 0
    v_mfma_f32_16x16x32_bf16 v[60:63], a[192:195], v[68:71], 0
    s_waitcnt lgkmcnt(4)
    v_mfma_f32_16x16x32_bf16 v[32:35], a[4:7], v[72:75], v[32:35]
    ds_read_b128 v[64:67], v25 offset:8192
    v_mfma_f32_16x16x32_bf16 v[36:39], a[4:7], v[76:79], v[36:39]
    v_mfma_f32_16x16x32_bf16 v[40:43], a[68:71], v[72:75], v[40:43]
    ds_read_b128 v[68:71], v25 offset:9216
    v_mfma_f32_16x16x32_bf16 v[44:47], a[68:71], v[76:79], v[44:47]
    v_mfma_f32_16x16x32_bf16 v[48:51], a[132:135], v[72:75], v[48:51]
    s_add_u32 m0, s63, 0
    s_add_u32 s53, s65, 0
    buffer_load_dwordx4 v22, s[28:31], s53 offen offset:0 lds
    v_mfma_f32_16x16x32_bf16 v[52:55], a[132:135], v[76:79], v[52:55]
    v_mfma_f32_16x16x32_bf16 v[56:59], a[196:199], v[72:75], v[56:59]
    v_mfma_f32_16x16x32_bf16 v[60:63], a[196:199], v[76:79], v[60:63]
    s_waitcnt lgkmcnt(4)
    v_mfma_f32_16x16x32_bf16 v[32:35], a[8:11], v[80:83], v[32:35]
    ds_read_b128 v[72:75], v25 offset:10240
    v_mfma_f32_16x16x32_bf16 v[36:39], a[8:11], v[84:87], v[36:39]
    v_mfma_f32_16x16x32_bf16 v[40:43], a[72:75], v[80:83], v[40:43]
    ds_read_b128 v[76:79], v25 offset:11264
    v_mfma_f32_16x16x32_bf16 v[44:47], a[72:75], v[84:87], v[44:47]
    v_mfma_f32_16x16x32_bf16 v[48:51], a[136:139], v[80:83], v[48:51]
    buffer_load_dwordx4 v22, s[28:31], s53 offen offset:1024 lds
    v_mfma_f32_16x16x32_bf16 v[52:55], a[136:139], v[84:87], v[52:55]
    v_mfma_f32_16x16x32_bf16 v[56:59], a[200:203], v[80:83], v[56:59]
    v_mfma_f32_16x16x32_bf16 v[60:63], a[200:203], v[84:87], v[60:63]
    s_waitcnt lgkmcnt(4)
    v_mfma_f32_16x16x32_bf16 v[32:35], a[12:15], v[88:91], v[32:35]
    ds_read_b128 v[80:83], v25 offset:12288
    v_mfma_f32_16x16x32_bf16 v[36:39], a[12:15], v[92:95], v[36:39]
    v_mfma_f32_16x16x32_bf16 v[40:43], a[76:79], v[88:91], v[40:43]
    ds_read_b128 v[84:87], v25 offset:13312
    v_mfma_f32_16x16x32_bf16 v[44:47], a[76:79], v[92:95], v[44:47]
    v_mfma_f32_16x16x32_bf16 v[48:51], a[140:143], v[88:91], v[48:51]
    buffer_load_dwordx4 v22, s[28:31], s53 offen offset:2048 lds
    v_mfma_f32_16x16x32_bf16 v[52:55], a[140:143], v[92:95], v[52:55]
    v_mfma_f32_16x16x32_bf16 v[56:59], a[204:207], v[88:91], v[56:59]
    v_mfma_f32_16x16x32_bf16 v[60:63], a[204:207], v[92:95], v[60:63]
    s_waitcnt lgkmcnt(4)
    v_mfma_f32_16x16x32_bf16 v[32:35], a[16:19], v[64:67], v[32:35]
    ds_read_b128 v[88:91], v25 offset:14336
    v_mfma_f32_16x16x32_bf16 v[36:39], a[16:19], v[68:71], v[36:39]
    v_mfma_f32_16x16x32_bf16 v[40:43], a[80:83], v[64:67], v[40:43]
    ds_read_b128 v[92:95], v25 offset:15360
    v_mfma_f32_16x16x32_bf16 v[44:47], a[80:83], v[68:71], v[44:47]
    v_mfma_f32_16x16x32_bf16 v[48:51], a[144:147], v[64:67], v[48:51]
    buffer_load_dwordx4 v22, s[28:31], s53 offen offset:3072 lds
    v_mfma_f32_16x16x32_bf16 v[52:55], a[144:147], v[68:71], v[52:55]
    v_mfma_f32_16x16x32_bf16 v[56:59], a[208:211], v[64:67], v[56:59]
    v_mfma_f32_16x16x32_bf16 v[60:63], a[208:211], v[68:71], v[60:63]
    s_waitcnt lgkmcnt(4)
    v_mfma_f32_16x16x32_bf16 v[32:35], a[20:23], v[72:75], v[32:35]
    ds_read_b128 v[64:67], v25 offset:16384
    v_mfma_f32_16x16x32_bf16 v[36:39], a[20:23], v[76:79], v[36:39]
    v_mfma_f32_16x16x32_bf16 v[40:43], a[84:87], v[72:75], v[40:43]
    ds_read_b128 v[68:71], v25 offset:17408
    v_mfma_f32_16x16x32_bf16 v[44:47], a[84:87], v[76:79], v[44:47]
    v_mfma_f32_16x16x32_bf16 v[48:51], a[148:151], v[72:75], v[48:51]
    s_add_u32 m0, s63, 4096
    s_add_u32 s53, s65, 4096
    buffer_load_dwordx4 v22, s[28:31], s53 offen offset:0 lds
    v_mfma_f32_16x16x32_bf16 v[52:55], a[148:151], v[76:79], v[52:55]
    v_mfma_f32_16x16x32_bf16 v[56:59], a[212:215], v[72:75], v[56:59]
    v_mfma_f32_16x16x32_bf16 v[60:63], a[212:215], v[76:79], v[60:63]
    s_waitcnt lgkmcnt(4)
    v_mfma_f32_16x16x32_bf16 v[32:35], a[24:27], v[80:83], v[32:35]
    ds_read_b128 v[72:75], v25 offset:18432
    v_mfma_f32_16x16x32_bf16 v[36:39], a[24:27], v[84:87], v[36:39]
    v_mfma_f32_16x16x32_bf16 v[40:43], a[88:91], v[80:83], v[40:43]
    ds_read_b128 v[76:79], v25 offset:19456
    v_mfma_f32_16x16x32_bf16 v[44:47], a[88:91], v[84:87], v[44:47]
    v_mfma_f32_16x16x32_bf16 v[48:51], a[152:155], v[80:83], v[48:51]
    buffer_load_dwordx4 v22, s[28:31], s53 offen offset:1024 lds
    v_mfma_f32_16x16x32_bf16 v[52:55], a[152:155], v[84:87], v[52:55]
    v_mfma_f32_16x16x32_bf16 v[56:59], a[216:219], v[80:83], v[56:59]
    v_mfma_f32_16x16x32_bf16 v[60:63], a[216:219], v[84:87], v[60:63]
    s_waitcnt lgkmcnt(4)
    v_mfma_f32_16x16x32_bf16 v[32:35], a[28:31], v[88:91], v[32:35]
    ds_read_b128 v[80:83], v25 offset:20480
    v_mfma_f32_16x16x32_bf16 v[36:39], a[28:31], v[92:95], v[36:39]
    v_mfma_f32_16x16x32_bf16 v[40:43], a[92:95], v[88:91], v[40:43]
    ds_read_b128 v[84:87], v25 offset:21504
    v_mfma_f32_16x16x32_bf16 v[44:47], a[92:95], v[92:95], v[44:47]
    v_mfma_f32_16x16x32_bf16 v[48:51], a[156:159], v[88:91], v[48:51]
    buffer_load_dwordx4 v22, s[28:31], s53 offen offset:2048 lds
    v_mfma_f32_16x16x32_bf16 v[52:55], a[156:159], v[92:95], v[52:55]
    v_mfma_f32_16x16x32_bf16 v[56:59], a[220:223], v[88:91], v[56:59]
    v_mfma_f32_16x16x32_bf16 v[60:63], a[220:223], v[92:95], v[60:63]
    s_waitcnt lgkmcnt(4)
    v_mfma_f32_16x16x32_bf16 v[32:35], a[32:35], v[64:67], v[32:35]
    ds_read_b128 v[88:91], v25 offset:22528
    v_mfma_f32_16x16x32_bf16 v[36:39], a[32:35], v[68:71], v[36:39]
    v_mfma_f32_16x16x32_bf16 v[40:43], a[96:99], v[64:67], v[40:43]
    ds_read_b128 v[92:95], v25 offset:23552
    v_mfma_f32_16x16x32_bf16 v[44:47], a[96:99], v[68:71], v[44:47]
    v_mfma_f32_16x16x32_bf16 v[48:51], a[160:163], v[64:67], v[48:51]
    buffer_load_dwordx4 v22, s[28:31], s53 offen offset:3072 lds
    v_mfma_f32_16x16x32_bf16 v[52:55], a[160:163], v[68:71], v[52:55]
    v_mfma_f32_16x16x32_bf16 v[56:59], a[224:227], v[64:67], v[56:59]
    v_mfma_f32_16x16x32_bf16 v[60:63], a[224:227], v[68:71], v[60:63]
    s_waitcnt lgkmcnt(4)
    v_mfma_f32_16x16x32_bf16 v[32:35], a[36:39], v[72:75], v[32:35]
    ds_read_b128 v[64:67], v25 offset:24576
    v_mfma_f32_16x16x32_bf16 v[36:39], a[36:39], v[76:79], v[36:39]
    v_mfma_f32_16x16x32_bf16 v[40:43], a[100:103], v[72:75], v[40:43]
    ds_read_b128 v[68:71], v25 offset:25600
    v_mfma_f32_16x16x32_bf16 v[44:47], a[100:103], v[76:79], v[44:47]
    v_mfma_f32_16x16x32_bf16 v[48:51], a[164:167], v[72:75], v[48:51]
    v_mfma_f32_16x16x32_bf16 v[52:55], a[164:167], v[76:79], v[52:55]
    v_mfma_f32_16x16x32_bf16 v[56:59], a[228:231], v[72:75], v[56:59]
    v_mfma_f32_16x16x32_bf16 v[60:63], a[228:231], v[76:79], v[60:63]
    s_add_u32 s65, s65, 131072
    s_add_u32 s63, s63, 32768
    s_and_b32 s63, s63, 0x1ffff
    s_nop 0
    s_waitcnt lgkmcnt(4)
    v_mfma_f32_16x16x32_bf16 v[32:35], a[40:43], v[80:83], v[32:35]
    ds_read_b128 v[72:75], v25 offset:26624
    v_mfma_f32_16x16x32_bf16 v[36:39], a[40:43], v[84:87], v[36:39]
    v_mfma_f32_16x16x32_bf16 v[40:43], a[104:107], v[80:83], v[40:43]
    ds_read_b128 v[76:79], v25 offset:27648
    v_mfma_f32_16x16x32_bf16 v[44:47], a[104:107], v[84:87], v[44:47]
    v_mfma_f32_16x16x32_bf16 v[48:51], a[168:171], v[80:83], v[48:51]
    v_mfma_f32_16x16x32_bf16 v[52:55], a[168:171], v[84:87], v[52:55]
    v_mfma_f32_16x16x32_bf16 v[56:59], a[232:235], v[80:83], v[56:59]
    v_mfma_f32_16x16x32_bf16 v[60:63], a[232:235], v[84:87], v[60:63]
    s_waitcnt lgkmcnt(4)
    v_mfma_f32_16x16x32_bf16 v[32:35], a[44:47], v[88:91], v[32:35]
    ds_read_b128 v[80:83], v25 offset:28672
    v_mfma_f32_16x16x32_bf16 v[36:39], a[44:47], v[92:95], v[36:39]
    v_mfma_f32_16x16x32_bf16 v[40:43], a[108:111], v[88:91], v[40:43]
    ds_read_b128 v[84:87], v25 offset:29696
    v_mfma_f32_16x16x32_bf16 v[44:47], a[108:111], v[92:95], v[44:47]
    v_mfma_f32_16x16x32_bf16 v[48:51], a[172:175], v[88:91], v[48:51]
    v_mfma_f32_16x16x32_bf16 v[52:55], a[172:175], v[92:95], v[52:55]
    v_mfma_f32_16x16x32_bf16 v[56:59], a[236:239], v[88:91], v[56:59]
    v_mfma_f32_16x16x32_bf16 v[60:63], a[236:239], v[92:95], v[60:63]
    s_waitcnt lgkmcnt(4)
    v_mfma_f32_16x16x32_bf16 v[32:35], a[48:51], v[64:67], v[32:35]
    ds_read_b128 v[88:91], v25 offset:30720
    v_mfma_f32_16x16x32_bf16 v[36:39], a[48:51], v[68:71], v[36:39]
    v_mfma_f32_16x16x32_bf16 v[40:43], a[112:115], v[64:67], v[40:43]
    ds_read_b128 v[92:95], v25 offset:31744
    v_mfma_f32_16x16x32_bf16 v[44:47], a[112:115], v[68:71], v[44:47]
    v_mfma_f32_16x16x32_bf16 v[48:51], a[176:179], v[64:67], v[48:51]
    v_mfma_f32_16x16x32_bf16 v[52:55], a[176:179], v[68:71], v[52:55]
    v_mfma_f32_16x16x32_bf16 v[56:59], a[240:243], v[64:67], v[56:59]
    v_mfma_f32_16x16x32_bf16 v[60:63], a[240:243], v[68:71], v[60:63]
    s_waitcnt vmcnt(8)
    v_mov_b32 v208, s50
    s_mov_b64 exec, 1
    buffer_store_dword v208, v24, s[28:31], 0 offen sc1
    s_mov_b64 exec, -1
    s_waitcnt lgkmcnt(4)
    v_mfma_f32_16x16x32_bf16 v[32:35], a[52:55], v[72:75], v[32:35]
    v_mfma_f32_16x16x32_bf16 v[36:39], a[52:55], v[76:79], v[36:39]
    v_mfma_f32_16x16x32_bf16 v[40:43], a[116:119], v[72:75], v[40:43]
    v_mfma_f32_16x16x32_bf16 v[44:47], a[116:119], v[76:79], v[44:47]
    v_mfma_f32_16x16x32_bf16 v[48:51], a[180:183], v[72:75], v[48:51]
    v_mfma_f32_16x16x32_bf16 v[52:55], a[180:183], v[76:79], v[52:55]
    v_mfma_f32_16x16x32_bf16 v[56:59], a[244:247], v[72:75], v[56:59]
    v_mfma_f32_16x16x32_bf16 v[60:63], a[244:247], v[76:79], v[60:63]
    s_waitcnt lgkmcnt(2)
    v_mfma_f32_16x16x32_bf16 v[32:35], a[56:59], v[80:83], v[32:35]
    v_mfma_f32_16x16x32_bf16 v[36:39], a[56:59], v[84:87], v[36:39]
    v_mfma_f32_16x16x32_bf16 v[40:43], a[120:123], v[80:83], v[40:43]
    v_mfma_f32_16x16x32_bf16 v[44:47], a[120:123], v[84:87], v[44:47]
    v_mfma_f32_16x16x32_bf16 v[48:51], a[184:187], v[80:83], v[48:51]
    v_mfma_f32_16x16x32_bf16 v[52:55], a[184:187], v[84:87], v[52:55]
    v_mfma_f32_16x16x32_bf16 v[56:59], a[248:251], v[80:83], v[56:59]
    v_mfma_f32_16x16x32_bf16 v[60:63], a[248:251], v[84:87], v[60:63]
    s_waitcnt lgkmcnt(0)
    v_mfma_f32_16x16x32_bf16 v[32:35], a[60:63], v[88:91], v[32:35]
    v_mfma_f32_16x16x32_bf16 v[36:39], a[60:63], v[92:95], v[36:39]
    v_mfma_f32_16x16x32_bf16 v[40:43], a[124:127], v[88:91], v[40:43]
    v_mfma_f32_16x16x32_bf16 v[44:47], a[124:127], v[92:95], v[44:47]
    v_mfma_f32_16x16x32_bf16 v[48:51], a[188:191], v[88:91], v[48:51]
    v_mfma_f32_16x16x32_bf16 v[52:55], a[188:191], v[92:95], v[52:55]
    v_mfma_f32_16x16x32_bf16 v[56:59], a[252:255], v[88:91], v[56:59]
    v_mfma_f32_16x16x32_bf16 v[60:63], a[252:255], v[92:95], v[60:63]
    v_add_u32 v25, 32768, v25
    v_and_b32 v25, 0x1ffff, v25
    v_cvt_pk_bf16_f32 v192, v32, v40
    v_cvt_pk_bf16_f32 v193, v33, v41
    v_cvt_pk_bf16_f32 v194, v34, v42
    v_cvt_pk_bf16_f32 v195, v35, v43
    buffer_store_dwordx4 v[192:195], v23, s[28:31], s66 offen sc1
    s_add_u32 s66, s66, s64
    v_cvt_pk_bf16_f32 v196, v36, v44
    v_cvt_pk_bf16_f32 v197, v37, v45
    v_cvt_pk_bf16_f32 v198, v38, v46
    v_cvt_pk_bf16_f32 v199, v39, v47
    buffer_store_dwordx4 v[196:199], v23, s[28:31], s67 offen sc1
    s_add_u32 s67, s67, s64
    v_cvt_pk_bf16_f32 v200, v48, v56
    v_cvt_pk_bf16_f32 v201, v49, v57
    v_cvt_pk_bf16_f32 v202, v50, v58
    v_cvt_pk_bf16_f32 v203, v51, v59
    buffer_store_dwordx4 v[200:203], v23, s[28:31], s68 offen sc1
    s_add_u32 s68, s68, s64
    v_cvt_pk_bf16_f32 v204, v52, v60
    v_cvt_pk_bf16_f32 v205, v53, v61
    v_cvt_pk_bf16_f32 v206, v54, v62
    v_cvt_pk_bf16_f32 v207, v55, v63
    buffer_store_dwordx4 v[204:207], v23, s[28:31], s69 offen sc1
    s_add_u32 s69, s69, s64
    s_add_u32 s50, s50, 1
    s_cmp_lt_u32 s50, 16
    s_cbranch_scc1 g1top_60
    s_waitcnt vmcnt(0)
    v_mov_b32 v208, 16
    s_mov_b64 exec, 1
    buffer_store_dword v208, v24, s[28:31], 0 offen sc1
    s_mov_b64 exec, -1
    s_branch g1E_59
g1V_58:
    s_lshl_b32 s65, s70, 15
    s_lshl_b32 s52, s48, 13
    s_add_u32 s65, s65, s52
    s_add_u32 s65, s65, 8388608
    s_mov_b32 s63, s52
    s_mov_b32 s50, 0
    s_mul_i32 s52, s70, s64
    v_mov_b32 v25, v22
    s_add_u32 s66, s66, s52
    s_add_u32 s67, s67, s52
    s_add_u32 s68, s68, s52
    s_add_u32 s69, s69, s52
    s_lshl_b32 s64, s64, 2
    s_add_u32 m0, s63, 0
    s_add_u32 s53, s65, 0
    buffer_load_dwordx4 v22, s[28:31], s53 offen offset:0 lds
    buffer_load_dwordx4 v22, s[28:31], s53 offen offset:1024 lds
    buffer_load_dwordx4 v22, s[28:31], s53 offen offset:2048 lds
    buffer_load_dwordx4 v22, s[28:31], s53 offen offset:3072 lds
    s_add_u32 m0, s63, 4096
    s_add_u32 s53, s65, 4096
    buffer_load_dwordx4 v22, s[28:31], s53 offen offset:0 lds
    buffer_load_dwordx4 v22, s[28:31], s53 offen offset:1024 lds
    buffer_load_dwordx4 v22, s[28:31], s53 offen offset:2048 lds
    buffer_load_dwordx4 v22, s[28:31], s53 offen offset:3072 lds
    s_add_u32 s65, s65, 131072
    s_add_u32 s63, s63, 32768
    s_and_b32 s63, s63, 0x1ffff
    buffer_load_dword v209, v22, s[28:31], s65 offen
    buffer_load_dword v209, v22, s[28:31], s65 offen
    buffer_load_dword v209, v22, s[28:31], s65 offen
    buffer_load_dword v209, v22, s[28:31], s65 offen
    buffer_load_dword v209, v22, s[28:31], s65 offen
    s_add_u32 m0, s63, 0
    s_add_u32 s53, s65, 0
    buffer_load_dwordx4 v22, s[28:31], s53 offen offset:0 lds
    buffer_load_dwordx4 v22, s[28:31], s53 offen offset:1024 lds
    buffer_load_dwordx4 v22, s[28:31], s53 offen offset:2048 lds
    buffer_load_dwordx4 v22, s[28:31], s53 offen offset:3072 lds
    s_add_u32 m0, s63, 4096
    s_add_u32 s53, s65, 4096
    buffer_load_dwordx4 v22, s[28:31], s53 offen offset:0 lds
    buffer_load_dwordx4 v22, s[28:31], s53 offen offset:1024 lds
    buffer_load_dwordx4 v22, s[28:31], s53 offen offset:2048 lds
    buffer_load_dwordx4 v22, s[28:31], s53 offen offset:3072 lds
    s_add_u32 s65, s65, 131072
    s_add_u32 s63, s63, 32768
    s_and_b32 s63, s63, 0x1ffff
    buffer_load_dword v209, v22, s[28:31], s65 offen
    buffer_load_dword v209, v22, s[28:31], s65 offen
    buffer_load_dword v209, v22, s[28:31], s65 offen
    buffer_load_dword v209, v22, s[28:31], s65 offen
    buffer_load_dword v209, v22, s[28:31], s65 offen
    s_add_u32 m0, s63, 0
    s_add_u32 s53, s65, 0
    buffer_load_dwordx4 v22, s[28:31], s53 offen offset:0 lds
    buffer_load_dwordx4 v22, s[28:31], s53 offen offset:1024 lds
    buffer_load_dwordx4 v22, s[28:31], s53 offen offset:2048 lds
    buffer_load_dwordx4 v22, s[28:31], s53 offen offset:3072 lds
    s_add_u32 m0, s63, 4096
    s_add_u32 s53, s65, 4096
    buffer_load_dwordx4 v22, s[28:31], s53 offen offset:0 lds
    buffer_load_dwordx4 v22, s[28:31], s53 offen offset:1024 lds
    buffer_load_dwordx4 v22, s[28:31], s53 offen offset:2048 lds
    buffer_load_dwordx4 v22, s[28:31], s53 offen offset:3072 lds
    s_add_u32 s65, s65, 131072
    s_add_u32 s63, s63, 32768
    s_and_b32 s63, s63, 0x1ffff
    buffer_load_dword v209, v22, s[28:31], s65 offen
    buffer_load_dword v209, v22, s[28:31], s65 offen
    buffer_load_dword v209, v22, s[28:31], s65 offen
    buffer_load_dword v209, v22, s[28:31], s65 offen
    buffer_load_dword v209, v22, s[28:31], s65 offen
g1top_61:
    s_waitcnt vmcnt(31)
    s_barrier
    ds_read_b128 v[64:67], v25 offset:0
    ds_read_b128 v[68:71], v25 offset:1024
    ds_read_b128 v[72:75], v25 offset:2048
    ds_read_b128 v[76:79], v25 offset:3072
    ds_read_b128 v[80:83], v25 offset:4096
    ds_read_b128 v[84:87], v25 offset:5120
    s_waitcnt lgkmcnt(4)
    v_mfma_f32_16x16x32_bf16 v[32:35], v[64:67], a[0:3], 0
    ds_read_b128 v[88:91], v25 offset:6144
    v_mfma_f32_16x16x32_bf16 v[36:39], v[68:71], a[0:3], 0
    v_mfma_f32_16x16x32_bf16 v[40:43], v[64:67], a[64:67], 0
    ds_read_b128 v[92:95], v25 offset:7168
    v_mfma_f32_16x16x32_bf16 v[44:47], v[68:71], a[64:67], 0
    v_mfma_f32_16x16x32_bf16 v[48:51], v[64:67], a[128:131], 0
    v_mfma_f32_16x16x32_bf16 v[52:55], v[68:71], a[128:131], 0
    v_mfma_f32_16x16x32_bf16 v[56:59], v[64:67], a[192:195], 0
    v_mfma_f32_16x16x32_bf16 v[60:63], v[68:71], a[192:195], 0
    s_waitcnt lgkmcnt(4)
    v_mfma_f32_16x16x32_bf16 v[32:35], v[72:75], a[4:7], v[32:35]
    ds_read_b128 v[64:67], v25 offset:8192
    v_mfma_f32_16x16x32_bf16 v[36:39], v[76:79], a[4:7], v[36:39]
    v_mfma_f32_16x16x32_bf16 v[40:43], v[72:75], a[68:71], v[40:43]
    ds_read_b128 v[68:71], v25 offset:9216
    v_mfma_f32_16x16x32_bf16 v[44:47], v[76:79], a[68:71], v[44:47]
    v_mfma_f32_16x16x32_bf16 v[48:51], v[72:75], a[132:135], v[48:51]
    s_add_u32 m0, s63, 0
    s_add_u32 s53, s65, 0
    buffer_load_dwordx4 v22, s[28:31], s53 offen offset:0 lds
    v_mfma_f32_16x16x32_bf16 v[52:55], v[76:79], a[132:135], v[52:55]
    v_mfma_f32_16x16x32_bf16 v[56:59], v[72:75], a[196:199], v[56:59]
    v_mfma_f32_16x16x32_bf16 v[60:63], v[76:79], a[196:199], v[60:63]
    s_waitcnt lgkmcnt(4)
    v_mfma_f32_16x16x32_bf16 v[32:35], v[80:83], a[8:11], v[32:35]
    ds_read_b128 v[72:75], v25 offset:10240
    v_mfma_f32_16x16x32_bf16 v[36:39], v[84:87], a[8:11], v[36:39]
    v_mfma_f32_16x16x32_bf16 v[40:43], v[80:83], a[72:75], v[40:43]
    ds_read_b128 v[76:79], v25 offset:11264
    v_mfma_f32_16x16x32_bf16 v[44:47], v[84:87], a[72:75], v[44:47]
    v_mfma_f32_16x16x32_bf16 v[48:51], v[80:83], a[136:139], v[48:51]
    buffer_load_dwordx4 v22, s[28:31], s53 offen offset:1024 lds
    v_mfma_f32_16x16x32_bf16 v[52:55], v[84:87], a[136:139], v[52:55]
    v_mfma_f32_16x16x32_bf16 v[56:59], v[80:83], a[200:203], v[56:59]
    v_mfma_f32_16x16x32_bf16 v[60:63], v[84:87], a[200:203], v[60:63]
    s_waitcnt lgkmcnt(4)
    v_mfma_f32_16x16x32_bf16 v[32:35], v[88:91], a[12:15], v[32:35]
    ds_read_b128 v[80:83], v25 offset:12288
    v_mfma_f32_16x16x32_bf16 v[36:39], v[92:95], a[12:15], v[36:39]
    v_mfma_f32_16x16x32_bf16 v[40:43], v[88:91], a[76:79], v[40:43]
    ds_read_b128 v[84:87], v25 offset:13312
    v_mfma_f32_16x16x32_bf16 v[44:47], v[92:95], a[76:79], v[44:47]
    v_mfma_f32_16x16x32_bf16 v[48:51], v[88:91], a[140:143], v[48:51]
    buffer_load_dwordx4 v22, s[28:31], s53 offen offset:2048 lds
    v_mfma_f32_16x16x32_bf16 v[52:55], v[92:95], a[140:143], v[52:55]
    v_mfma_f32_16x16x32_bf16 v[56:59], v[88:91], a[204:207], v[56:59]
    v_mfma_f32_16x16x32_bf16 v[60:63], v[92:95], a[204:207], v[60:63]
    s_waitcnt lgkmcnt(4)
    v_mfma_f32_16x16x32_bf16 v[32:35], v[64:67], a[16:19], v[32:35]
    ds_read_b128 v[88:91], v25 offset:14336
    v_mfma_f32_16x16x32_bf16 v[36:39], v[68:71], a[16:19], v[36:39]
    v_mfma_f32_16x16x32_bf16 v[40:43], v[64:67], a[80:83], v[40:43]
    ds_read_b128 v[92:95], v25 offset:15360
    v_mfma_f32_16x16x32_bf16 v[44:47], v[68:71], a[80:83], v[44:47]
    v_mfma_f32_16x16x32_bf16 v[48:51], v[64:67], a[144:147], v[48:51]
    buffer_load_dwordx4 v22, s[28:31], s53 offen offset:3072 lds
    v_mfma_f32_16x16x32_bf16 v[52:55], v[68:71], a[144:147], v[52:55]
    v_mfma_f32_16x16x32_bf16 v[56:59], v[64:67], a[208:211], v[56:59]
    v_mfma_f32_16x16x32_bf16 v[60:63], v[68:71], a[208:211], v[60:63]
    s_waitcnt lgkmcnt(4)
    v_mfma_f32_16x16x32_bf16 v[32:35], v[72:75], a[20:23], v[32:35]
    ds_read_b128 v[64:67], v25 offset:16384
    v_mfma_f32_16x16x32_bf16 v[36:39], v[76:79], a[20:23], v[36:39]
    v_mfma_f32_16x16x32_bf16 v[40:43], v[72:75], a[84:87], v[40:43]
    ds_read_b128 v[68:71], v25 offset:17408
    v_mfma_f32_16x16x32_bf16 v[44:47], v[76:79], a[84:87], v[44:47]
    v_mfma_f32_16x16x32_bf16 v[48:51], v[72:75], a[148:151], v[48:51]
    s_add_u32 m0, s63, 4096
    s_add_u32 s53, s65, 4096
    buffer_load_dwordx4 v22, s[28:31], s53 offen offset:0 lds
    v_mfma_f32_16x16x32_bf16 v[52:55], v[76:79], a[148:151], v[52:55]
    v_mfma_f32_16x16x32_bf16 v[56:59], v[72:75], a[212:215], v[56:59]
    v_mfma_f32_16x16x32_bf16 v[60:63], v[76:79], a[212:215], v[60:63]
    s_waitcnt lgkmcnt(4)
    v_mfma_f32_16x16x32_bf16 v[32:35], v[80:83], a[24:27], v[32:35]
    ds_read_b128 v[72:75], v25 offset:18432
    v_mfma_f32_16x16x32_bf16 v[36:39], v[84:87], a[24:27], v[36:39]
    v_mfma_f32_16x16x32_bf16 v[40:43], v[80:83], a[88:91], v[40:43]
    ds_read_b128 v[76:79], v25 offset:19456
    v_mfma_f32_16x16x32_bf16 v[44:47], v[84:87], a[88:91], v[44:47]
    v_mfma_f32_16x16x32_bf16 v[48:51], v[80:83], a[152:155], v[48:51]
    buffer_load_dwordx4 v22, s[28:31], s53 offen offset:1024 lds
    v_mfma_f32_16x16x32_bf16 v[52:55], v[84:87], a[152:155], v[52:55]
    v_mfma_f32_16x16x32_bf16 v[56:59], v[80:83], a[216:219], v[56:59]
    v_mfma_f32_16x16x32_bf16 v[60:63], v[84:87], a[216:219], v[60:63]
    s_waitcnt lgkmcnt(4)
    v_mfma_f32_16x16x32_bf16 v[32:35], v[88:91], a[28:31], v[32:35]
    ds_read_b128 v[80:83], v25 offset:20480
    v_mfma_f32_16x16x32_bf16 v[36:39], v[92:95], a[28:31], v[36:39]
    v_mfma_f32_16x16x32_bf16 v[40:43], v[88:91], a[92:95], v[40:43]
    ds_read_b128 v[84:87], v25 offset:21504
    v_mfma_f32_16x16x32_bf16 v[44:47], v[92:95], a[92:95], v[44:47]
    v_mfma_f32_16x16x32_bf16 v[48:51], v[88:91], a[156:159], v[48:51]
    buffer_load_dwordx4 v22, s[28:31], s53 offen offset:2048 lds
    v_mfma_f32_16x16x32_bf16 v[52:55], v[92:95], a[156:159], v[52:55]
    v_mfma_f32_16x16x32_bf16 v[56:59], v[88:91], a[220:223], v[56:59]
    v_mfma_f32_16x16x32_bf16 v[60:63], v[92:95], a[220:223], v[60:63]
    s_waitcnt lgkmcnt(4)
    v_mfma_f32_16x16x32_bf16 v[32:35], v[64:67], a[32:35], v[32:35]
    ds_read_b128 v[88:91], v25 offset:22528
    v_mfma_f32_16x16x32_bf16 v[36:39], v[68:71], a[32:35], v[36:39]
    v_mfma_f32_16x16x32_bf16 v[40:43], v[64:67], a[96:99], v[40:43]
    ds_read_b128 v[92:95], v25 offset:23552
    v_mfma_f32_16x16x32_bf16 v[44:47], v[68:71], a[96:99], v[44:47]
    v_mfma_f32_16x16x32_bf16 v[48:51], v[64:67], a[160:163], v[48:51]
    buffer_load_dwordx4 v22, s[28:31], s53 offen offset:3072 lds
    v_mfma_f32_16x16x32_bf16 v[52:55], v[68:71], a[160:163], v[52:55]
    v_mfma_f32_16x16x32_bf16 v[56:59], v[64:67], a[224:227], v[56:59]
    v_mfma_f32_16x16x32_bf16 v[60:63], v[68:71], a[224:227], v[60:63]
    s_waitcnt lgkmcnt(4)
    v_mfma_f32_16x16x32_bf16 v[32:35], v[72:75], a[36:39], v[32:35]
    ds_read_b128 v[64:67], v25 offset:24576
    v_mfma_f32_16x16x32_bf16 v[36:39], v[76:79], a[36:39], v[36:39]
    v_mfma_f32_16x16x32_bf16 v[40:43], v[72:75], a[100:103], v[40:43]
    ds_read_b128 v[68:71], v25 offset:25600
    v_mfma_f32_16x16x32_bf16 v[44:47], v[76:79], a[100:103], v[44:47]
    v_mfma_f32_16x16x32_bf16 v[48:51], v[72:75], a[164:167], v[48:51]
    v_mfma_f32_16x16x32_bf16 v[52:55], v[76:79], a[164:167], v[52:55]
    v_mfma_f32_16x16x32_bf16 v[56:59], v[72:75], a[228:231], v[56:59]
    v_mfma_f32_16x16x32_bf16 v[60:63], v[76:79], a[228:231], v[60:63]
    s_add_u32 s65, s65, 131072
    s_add_u32 s63, s63, 32768
    s_and_b32 s63, s63, 0x1ffff
    s_nop 0
    s_waitcnt lgkmcnt(4)
    v_mfma_f32_16x16x32_bf16 v[32:35], v[80:83], a[40:43], v[32:35]
    ds_read_b128 v[72:75], v25 offset:26624
    v_mfma_f32_16x16x32_bf16 v[36:39], v[84:87], a[40:43], v[36:39]
    v_mfma_f32_16x16x32_bf16 v[40:43], v[80:83], a[104:107], v[40:43]
    ds_read_b128 v[76:79], v25 offset:27648
    v_mfma_f32_16x16x32_bf16 v[44:47], v[84:87], a[104:107], v[44:47]
    v_mfma_f32_16x16x32_bf16 v[48:51], v[80:83], a[168:171], v[48:51]
    v_mfma_f32_16x16x32_bf16 v[52:55], v[84:87], a[168:171], v[52:55]
    v_mfma_f32_16x16x32_bf16 v[56:59], v[80:83], a[232:235], v[56:59]
    v_mfma_f32_16x16x32_bf16 v[60:63], v[84:87], a[232:235], v[60:63]
    s_waitcnt lgkmcnt(4)
    v_mfma_f32_16x16x32_bf16 v[32:35], v[88:91], a[44:47], v[32:35]
    ds_read_b128 v[80:83], v25 offset:28672
    v_mfma_f32_16x16x32_bf16 v[36:39], v[92:95], a[44:47], v[36:39]
    v_mfma_f32_16x16x32_bf16 v[40:43], v[88:91], a[108:111], v[40:43]
    ds_read_b128 v[84:87], v25 offset:29696
    v_mfma_f32_16x16x32_bf16 v[44:47], v[92:95], a[108:111], v[44:47]
    v_mfma_f32_16x16x32_bf16 v[48:51], v[88:91], a[172:175], v[48:51]
    v_mfma_f32_16x16x32_bf16 v[52:55], v[92:95], a[172:175], v[52:55]
    v_mfma_f32_16x16x32_bf16 v[56:59], v[88:91], a[236:239], v[56:59]
    v_mfma_f32_16x16x32_bf16 v[60:63], v[92:95], a[236:239], v[60:63]
    s_waitcnt lgkmcnt(4)
    v_mfma_f32_16x16x32_bf16 v[32:35], v[64:67], a[48:51], v[32:35]
    ds_read_b128 v[88:91], v25 offset:30720
    v_mfma_f32_16x16x32_bf16 v[36:39], v[68:71], a[48:51], v[36:39]
    v_mfma_f32_16x16x32_bf16 v[40:43], v[64:67], a[112:115], v[40:43]
    ds_read_b128 v[92:95], v25 offset:31744
    v_mfma_f32_16x16x32_bf16 v[44:47], v[68:71], a[112:115], v[44:47]
    v_mfma_f32_16x16x32_bf16 v[48:51], v[64:67], a[176:179], v[48:51]
    v_mfma_f32_16x16x32_bf16 v[52:55], v[68:71], a[176:179], v[52:55]
    v_mfma_f32_16x16x32_bf16 v[56:59], v[64:67], a[240:243], v[56:59]
    v_mfma_f32_16x16x32_bf16 v[60:63], v[68:71], a[240:243], v[60:63]
    s_waitcnt vmcnt(8)
    v_mov_b32 v208, s50
    s_mov_b64 exec, 1
    buffer_store_dword v208, v24, s[28:31], 0 offen sc1
    s_mov_b64 exec, -1
    s_waitcnt lgkmcnt(4)
    v_mfma_f32_16x16x32_bf16 v[32:35], v[72:75], a[52:55], v[32:35]
    v_mfma_f32_16x16x32_bf16 v[36:39], v[76:79], a[52:55], v[36:39]
    v_mfma_f32_16x16x32_bf16 v[40:43], v[72:75], a[116:119], v[40:43]
    v_mfma_f32_16x16x32_bf16 v[44:47], v[76:79], a[116:119], v[44:47]
    v_mfma_f32_16x16x32_bf16 v[48:51], v[72:75], a[180:183], v[48:51]
    v_mfma_f32_16x16x32_bf16 v[52:55], v[76:79], a[180:183], v[52:55]
    v_mfma_f32_16x16x32_bf16 v[56:59], v[72:75], a[244:247], v[56:59]
    v_mfma_f32_16x16x32_bf16 v[60:63], v[76:79], a[244:247], v[60:63]
    s_waitcnt lgkmcnt(2)
    v_mfma_f32_16x16x32_bf16 v[32:35], v[80:83], a[56:59], v[32:35]
    v_mfma_f32_16x16x32_bf16 v[36:39], v[84:87], a[56:59], v[36:39]
    v_mfma_f32_16x16x32_bf16 v[40:43], v[80:83], a[120:123], v[40:43]
    v_mfma_f32_16x16x32_bf16 v[44:47], v[84:87], a[120:123], v[44:47]
    v_mfma_f32_16x16x32_bf16 v[48:51], v[80:83], a[184:187], v[48:51]
    v_mfma_f32_16x16x32_bf16 v[52:55], v[84:87], a[184:187], v[52:55]
    v_mfma_f32_16x16x32_bf16 v[56:59], v[80:83], a[248:251], v[56:59]
    v_mfma_f32_16x16x32_bf16 v[60:63], v[84:87], a[248:251], v[60:63]
    s_waitcnt lgkmcnt(0)
    v_mfma_f32_16x16x32_bf16 v[32:35], v[88:91], a[60:63], v[32:35]
    v_mfma_f32_16x16x32_bf16 v[36:39], v[92:95], a[60:63], v[36:39]
    v_mfma_f32_16x16x32_bf16 v[40:43], v[88:91], a[124:127], v[40:43]
    v_mfma_f32_16x16x32_bf16 v[44:47], v[92:95], a[124:127], v[44:47]
    v_mfma_f32_16x16x32_bf16 v[48:51], v[88:91], a[188:191], v[48:51]
    v_mfma_f32_16x16x32_bf16 v[52:55], v[92:95], a[188:191], v[52:55]
    v_mfma_f32_16x16x32_bf16 v[56:59], v[88:91], a[252:255], v[56:59]
    v_mfma_f32_16x16x32_bf16 v[60:63], v[92:95], a[252:255], v[60:63]
    v_add_u32 v25, 32768, v25
    v_and_b32 v25, 0x1ffff, v25
    v_cvt_pk_bf16_f32 v192, v32, v33
    v_cvt_pk_bf16_f32 v193, v34, v35
    v_cvt_pk_bf16_f32 v194, v36, v37
    v_cvt_pk_bf16_f32 v195, v38, v39
    buffer_store_dwordx4 v[192:195], v23, s[28:31], s66 offen sc1
    s_add_u32 s66, s66, s64
    v_cvt_pk_bf16_f32 v196, v40, v41
    v_cvt_pk_bf16_f32 v197, v42, v43
    v_cvt_pk_bf16_f32 v198, v44, v45
    v_cvt_pk_bf16_f32 v199, v46, v47
    buffer_store_dwordx4 v[196:199], v23, s[28:31], s67 offen sc1
    s_add_u32 s67, s67, s64
    v_cvt_pk_bf16_f32 v200, v48, v49
    v_cvt_pk_bf16_f32 v201, v50, v51
    v_cvt_pk_bf16_f32 v202, v52, v53
    v_cvt_pk_bf16_f32 v203, v54, v55
    buffer_store_dwordx4 v[200:203], v23, s[28:31], s68 offen sc1
    s_add_u32 s68, s68, s64
    v_cvt_pk_bf16_f32 v204, v56, v57
    v_cvt_pk_bf16_f32 v205, v58, v59
    v_cvt_pk_bf16_f32 v206, v60, v61
    v_cvt_pk_bf16_f32 v207, v62, v63
    buffer_store_dwordx4 v[204:207], v23, s[28:31], s69 offen sc1
    s_add_u32 s69, s69, s64
    s_add_u32 s50, s50, 1
    s_cmp_lt_u32 s50, 16
    s_cbranch_scc1 g1top_61
    s_waitcnt vmcnt(0)
    v_mov_b32 v208, 16
    s_mov_b64 exec, 1
    buffer_store_dword v208, v24, s[28:31], 0 offen sc1
    s_mov_b64 exec, -1
g1E_59:
    s_branch L_worker
L_notg1:
    s_cmp_lg_u32 s57, 216
    s_cbranch_scc1 L_notgate
    v_mbcnt_lo_u32_b32 v16, -1, 0
    v_mbcnt_hi_u32_b32 v16, -1, v16
    s_mov_b32 s32, s20
    s_and_b32 s33, s21, 0xffff
    s_mov_b32 s34, 0x400
    s_mov_b32 s35, 0x00020000
    v_lshrrev_b32 v17, 4, v16
    v_and_b32 v18, 15, v16
    v_lshlrev_b32 v20, 4, v17
    v_mov_b32 v19, 0x100000
    v_cmp_eq_u32 vcc, 0, v18
    s_nop 1
    v_cndmask_b32 v20, v19, v20, vcc
    v_lshlrev_b32 v23, 3, v16
    s_mov_b32 s66, 655360
    s_mov_b32 s64, 128
    buffer_load_dwordx4 a[0:3], v20, s[32:35], 0 offen offset:0
    buffer_load_dwordx4 a[4:7], v20, s[32:35], 0 offen offset:64
    buffer_load_dwordx4 a[8:11], v20, s[32:35], 0 offen offset:128
    buffer_load_dwordx4 a[12:15], v20, s[32:35], 0 offen offset:192
    buffer_load_dwordx4 a[16:19], v20, s[32:35], 0 offen offset:256
    buffer_load_dwordx4 a[20:23], v20, s[32:35], 0 offen offset:320
    buffer_load_dwordx4 a[24:27], v20, s[32:35], 0 offen offset:384
    buffer_load_dwordx4 a[28:31], v20, s[32:35], 0 offen offset:448
    buffer_load_dwordx4 a[32:35], v20, s[32:35], 0 offen offset:512
    buffer_load_dwordx4 a[36:39], v20, s[32:35], 0 offen offset:576
    buffer_load_dwordx4 a[40:43], v20, s[32:35], 0 offen offset:640
    buffer_load_dwordx4 a[44:47], v20, s[32:35], 0 offen offset:704
    buffer_load_dwordx4 a[48:51], v20, s[32:35], 0 offen offset:768
    buffer_load_dwordx4 a[52:55], v20, s[32:35], 0 offen offset:832
    buffer_load_dwordx4 a[56:59], v20, s[32:35], 0 offen offset:896
    buffer_load_dwordx4 a[60:63], v20, s[32:35], 0 offen offset:960
    v_lshlrev_b32 v212, 4, v16
    v_add_u32 v213, 4096, v212
    v_add_u32 v214, 8192, v212
    v_add_u32 v215, 12288, v212
    v_add_u32 v216, 16384, v212
    v_add_u32 v217, 20480, v212
    v_add_u32 v218, 24576, v212
    v_add_u32 v219, 28672, v212
    s_lshl_b32 s52, s57, 4
    s_lshl_b32 s53, s48, 2
    s_add_u32 s52, s52, s53
    s_add_u32 s52, s52, 0
    v_mov_b32 v24, s52
    v_mov_b32 v27, 16
    s_nop 1
gate_62:
    s_sub_u32 s79, s79, 1
    s_cbranch_scc1 L_abort
    buffer_load_dword v26, v27, s[40:43], 0 offen sc1
    s_waitcnt vmcnt(0)
    v_readfirstlane_b32 s55, v26
    s_nop 0
    s_cmp_lg_u32 s55, 0
    s_nop 2
    s_cbranch_scc1 gok_63
    s_sleep 16
    s_branch gate_62
gok_63:
    v_lshlrev_b32 v26, 2, v16
    v_add_u32 v26, 20480, v26
    v_mov_b32 v27, 1
    s_nop 1
pf_64:
    buffer_load_dword v25, v26, s[28:31], 0 offen sc1
    s_waitcnt vmcnt(0)
    v_cmp_lt_u32 vcc, v25, v27
    s_nop 4
    s_cbranch_vccz pfok_65
    s_sub_u32 s79, s79, 1
    s_cbranch_scc1 L_abort
    s_sleep 1
    s_branch pf_64
pfok_65:
    s_waitcnt vmcnt(0)
    s_lshl_b32 s65, s48, 15
    s_add_u32 s65, s65, 8388608
    s_mov_b32 s50, 0
    s_mul_i32 s52, s48, s64
    s_add_u32 s66, s66, s52
    s_add_u32 s67, s67, s52
    s_add_u32 s68, s68, s52
    s_add_u32 s69, s69, s52
    s_lshl_b32 s64, s64, 2
    buffer_load_dwordx4 v[64:67], v212, s[28:31], s65 offen offset:0
    buffer_load_dwordx4 v[68:71], v212, s[28:31], s65 offen offset:1024
    buffer_load_dwordx4 v[72:75], v212, s[28:31], s65 offen offset:2048
    buffer_load_dwordx4 v[76:79], v212, s[28:31], s65 offen offset:3072
    buffer_load_dwordx4 v[80:83], v213, s[28:31], s65 offen offset:0
    buffer_load_dwordx4 v[84:87], v213, s[28:31], s65 offen offset:1024
    buffer_load_dwordx4 v[88:91], v213, s[28:31], s65 offen offset:2048
    buffer_load_dwordx4 v[92:95], v213, s[28:31], s65 offen offset:3072
    buffer_load_dwordx4 v[96:99], v214, s[28:31], s65 offen offset:0
    buffer_load_dwordx4 v[100:103], v214, s[28:31], s65 offen offset:1024
    buffer_load_dwordx4 v[104:107], v214, s[28:31], s65 offen offset:2048
    buffer_load_dwordx4 v[108:111], v214, s[28:31], s65 offen offset:3072
    buffer_load_dwordx4 v[112:115], v215, s[28:31], s65 offen offset:0
    buffer_load_dwordx4 v[116:119], v215, s[28:31], s65 offen offset:1024
    buffer_load_dwordx4 v[120:123], v215, s[28:31], s65 offen offset:2048
    buffer_load_dwordx4 v[124:127], v215, s[28:31], s65 offen offset:3072
    buffer_load_dwordx4 v[128:131], v216, s[28:31], s65 offen offset:0
    buffer_load_dwordx4 v[132:135], v216, s[28:31], s65 offen offset:1024
    buffer_load_dwordx4 v[136:139], v216, s[28:31], s65 offen offset:2048
    buffer_load_dwordx4 v[140:143], v216, s[28:31], s65 offen offset:3072
    buffer_load_dwordx4 v[144:147], v217, s[28:31], s65 offen offset:0
    buffer_load_dwordx4 v[148:151], v217, s[28:31], s65 offen offset:1024
    buffer_load_dwordx4 v[152:155], v217, s[28:31], s65 offen offset:2048
    buffer_load_dwordx4 v[156:159], v217, s[28:31], s65 offen offset:3072
    buffer_load_dwordx4 v[160:163], v218, s[28:31], s65 offen offset:0
    buffer_load_dwordx4 v[164:167], v218, s[28:31], s65 offen offset:1024
    buffer_load_dwordx4 v[168:171], v218, s[28:31], s65 offen offset:2048
    buffer_load_dwordx4 v[172:175], v218, s[28:31], s65 offen offset:3072
    buffer_load_dwordx4 v[176:179], v219, s[28:31], s65 offen offset:0
    buffer_load_dwordx4 v[180:183], v219, s[28:31], s65 offen offset:1024
    buffer_load_dwordx4 v[184:187], v219, s[28:31], s65 offen offset:2048
    buffer_load_dwordx4 v[188:191], v219, s[28:31], s65 offen offset:3072
    buffer_load_dword v209, v212, s[28:31], s65 offen
g1top_66:
    s_add_u32 s65, s65, 131072
    s_waitcnt vmcnt(31)
    v_mfma_f32_16x16x32_bf16 v[32:35], a[0:3], v[64:67], 0
    v_mfma_f32_16x16x32_bf16 v[36:39], a[0:3], v[68:71], 0
    buffer_load_dwordx4 v[64:67], v212, s[28:31], s65 offen offset:0
    buffer_load_dwordx4 v[68:71], v212, s[28:31], s65 offen offset:1024
    s_waitcnt vmcnt(31)
    v_mfma_f32_16x16x32_bf16 v[32:35], a[4:7], v[72:75], v[32:35]
    v_mfma_f32_16x16x32_bf16 v[36:39], a[4:7], v[76:79], v[36:39]
    buffer_load_dwordx4 v[72:75], v212, s[28:31], s65 offen offset:2048
    buffer_load_dwordx4 v[76:79], v212, s[28:31], s65 offen offset:3072
    s_waitcnt vmcnt(31)
    v_mfma_f32_16x16x32_bf16 v[32:35], a[8:11], v[80:83], v[32:35]
    v_mfma_f32_16x16x32_bf16 v[36:39], a[8:11], v[84:87], v[36:39]
    buffer_load_dwordx4 v[80:83], v213, s[28:31], s65 offen offset:0
    buffer_load_dwordx4 v[84:87], v213, s[28:31], s65 offen offset:1024
    s_waitcnt vmcnt(31)
    v_mfma_f32_16x16x32_bf16 v[32:35], a[12:15], v[88:91], v[32:35]
    v_mfma_f32_16x16x32_bf16 v[36:39], a[12:15], v[92:95], v[36:39]
    buffer_load_dwordx4 v[88:91], v213, s[28:31], s65 offen offset:2048
    buffer_load_dwordx4 v[92:95], v213, s[28:31], s65 offen offset:3072
    s_waitcnt vmcnt(31)
    v_mfma_f32_16x16x32_bf16 v[32:35], a[16:19], v[96:99], v[32:35]
    v_mfma_f32_16x16x32_bf16 v[36:39], a[16:19], v[100:103], v[36:39]
    buffer_load_dwordx4 v[96:99], v214, s[28:31], s65 offen offset:0
    buffer_load_dwordx4 v[100:103], v214, s[28:31], s65 offen offset:1024
    s_waitcnt vmcnt(10)
    v_mov_b32 v208, s50
    s_mov_b64 exec, 1
    buffer_store_dword v208, v24, s[28:31], 0 offen sc1
    s_mov_b64 exec, -1
    s_waitcnt vmcnt(32)
    v_mfma_f32_16x16x32_bf16 v[32:35], a[20:23], v[104:107], v[32:35]
    v_mfma_f32_16x16x32_bf16 v[36:39], a[20:23], v[108:111], v[36:39]
    buffer_load_dwordx4 v[104:107], v214, s[28:31], s65 offen offset:2048
    buffer_load_dwordx4 v[108:111], v214, s[28:31], s65 offen offset:3072
    s_waitcnt vmcnt(32)
    v_mfma_f32_16x16x32_bf16 v[32:35], a[24:27], v[112:115], v[32:35]
    v_mfma_f32_16x16x32_bf16 v[36:39], a[24:27], v[116:119], v[36:39]
    buffer_load_dwordx4 v[112:115], v215, s[28:31], s65 offen offset:0
    buffer_load_dwordx4 v[116:119], v215, s[28:31], s65 offen offset:1024
    s_waitcnt vmcnt(32)
    v_mfma_f32_16x16x32_bf16 v[32:35], a[28:31], v[120:123], v[32:35]
    v_mfma_f32_16x16x32_bf16 v[36:39], a[28:31], v[124:127], v[36:39]
    buffer_load_dwordx4 v[120:123], v215, s[28:31], s65 offen offset:2048
    buffer_load_dwordx4 v[124:127], v215, s[28:31], s65 offen offset:3072
    s_waitcnt vmcnt(32)
    v_mfma_f32_16x16x32_bf16 v[32:35], a[32:35], v[128:131], v[32:35]
    v_mfma_f32_16x16x32_bf16 v[36:39], a[32:35], v[132:135], v[36:39]
    buffer_load_dwordx4 v[128:131], v216, s[28:31], s65 offen offset:0
    buffer_load_dwordx4 v[132:135], v216, s[28:31], s65 offen offset:1024
    s_waitcnt vmcnt(32)
    v_mfma_f32_16x16x32_bf16 v[32:35], a[36:39], v[136:139], v[32:35]
    v_mfma_f32_16x16x32_bf16 v[36:39], a[36:39], v[140:143], v[36:39]
    buffer_load_dwordx4 v[136:139], v216, s[28:31], s65 offen offset:2048
    buffer_load_dwordx4 v[140:143], v216, s[28:31], s65 offen offset:3072
    s_waitcnt vmcnt(32)
    v_mfma_f32_16x16x32_bf16 v[32:35], a[40:43], v[144:147], v[32:35]
    v_mfma_f32_16x16x32_bf16 v[36:39], a[40:43], v[148:151], v[36:39]
    buffer_load_dwordx4 v[144:147], v217, s[28:31], s65 offen offset:0
    buffer_load_dwordx4 v[148:151], v217, s[28:31], s65 offen offset:1024
    s_waitcnt vmcnt(32)
    v_mfma_f32_16x16x32_bf16 v[32:35], a[44:47], v[152:155], v[32:35]
    v_mfma_f32_16x16x32_bf16 v[36:39], a[44:47], v[156:159], v[36:39]
    buffer_load_dwordx4 v[152:155], v217, s[28:31], s65 offen offset:2048
    buffer_load_dwordx4 v[156:159], v217, s[28:31], s65 offen offset:3072
    s_waitcnt vmcnt(32)
    v_mfma_f32_16x16x32_bf16 v[32:35], a[48:51], v[160:163], v[32:35]
    v_mfma_f32_16x16x32_bf16 v[36:39], a[48:51], v[164:167], v[36:39]
    buffer_load_dwordx4 v[160:163], v218, s[28:31], s65 offen offset:0
    buffer_load_dwordx4 v[164:167], v218, s[28:31], s65 offen offset:1024
    s_waitcnt vmcnt(32)
    v_mfma_f32_16x16x32_bf16 v[32:35], a[52:55], v[168:171], v[32:35]
    v_mfma_f32_16x16x32_bf16 v[36:39], a[52:55], v[172:175], v[36:39]
    buffer_load_dwordx4 v[168:171], v218, s[28:31], s65 offen offset:2048
    buffer_load_dwordx4 v[172:175], v218, s[28:31], s65 offen offset:3072
    s_waitcnt vmcnt(32)
    v_mfma_f32_16x16x32_bf16 v[32:35], a[56:59], v[176:179], v[32:35]
    v_mfma_f32_16x16x32_bf16 v[36:39], a[56:59], v[180:183], v[36:39]
    buffer_load_dwordx4 v[176:179], v219, s[28:31], s65 offen offset:0
    buffer_load_dwordx4 v[180:183], v219, s[28:31], s65 offen offset:1024
    s_waitcnt vmcnt(32)
    v_mfma_f32_16x16x32_bf16 v[32:35], a[60:63], v[184:187], v[32:35]
    v_mfma_f32_16x16x32_bf16 v[36:39], a[60:63], v[188:191], v[36:39]
    buffer_load_dwordx4 v[184:187], v219, s[28:31], s65 offen offset:2048
    buffer_load_dwordx4 v[188:191], v219, s[28:31], s65 offen offset:3072
    s_nop 1
    v_mul_f32 v32, 0xbfb8aa3b, v32
    v_exp_f32 v32, v32
    s_nop 0
    v_add_f32 v32, 1.0, v32
    v_rcp_f32 v192, v32
    v_mul_f32 v36, 0xbfb8aa3b, v36
    v_exp_f32 v36, v36
    s_nop 0
    v_add_f32 v36, 1.0, v36
    v_rcp_f32 v193, v36
    s_mov_b64 exec, 0xffff
    buffer_store_dwordx2 v[192:193], v23, s[28:31], s66 offen sc1
    s_mov_b64 exec, -1
    s_add_u32 s66, s66, s64
    s_add_u32 s50, s50, 1
    s_cmp_lt_u32 s50, 16
    s_cbranch_scc1 g1top_66
    s_waitcnt vmcnt(0)
    v_mov_b32 v208, 16
    s_mov_b64 exec, 1
    buffer_store_dword v208, v24, s[28:31], 0 offen sc1
    s_mov_b64 exec, -1
    s_branch L_worker
L_notgate:
    v_mov_b32 v17, 16
    s_nop 1
gate_67:
    s_sub_u32 s79, s79, 1
    s_cbranch_scc1 L_abort
    buffer_load_dword v16, v17, s[40:43], 0 offen sc1
    s_waitcnt vmcnt(0)
    v_readfirstlane_b32 s52, v16
    s_nop 0
    s_cmp_lg_u32 s52, 0
    s_nop 2
    s_cbranch_scc1 gok_68
    s_sleep 16
    s_branch gate_67
gok_68:
    s_add_u32 s62, s78, 6
    s_cmp_ge_u32 s62, 7
    s_cselect_b32 s52, 7, 0
    s_sub_u32 s62, s62, s52
    s_min_u32 s62, s62, 6
    s_mov_b32 s64, 0
L_g2try:
    s_lshl_b32 s63, s62, 2
    s_barrier
    s_cmp_lg_u32 s48, 0
    s_cbranch_scc1 at_69
    v_mov_b32 v16, 1
    v_mov_b32 v17, 32
    s_mov_b64 exec, 1
    buffer_atomic_add v16, v17, s[40:43], s63 offen sc0
    s_waitcnt vmcnt(0)
    v_mov_b32 v17, 163328
    ds_write_b32 v17, v16
    s_mov_b64 exec, -1
    s_waitcnt lgkmcnt(0)
at_69:
    s_barrier
    v_mov_b32 v17, 163328
    ds_read_b32 v16, v17
    s_waitcnt lgkmcnt(0)
    v_readfirstlane_b32 s61, v16
    s_nop 0
    s_cmp_lt_u32 s61, 16
    s_nop 2
    s_cbranch_scc1 L_g2go
    s_cmp_lg_u32 s64, 0
    s_cbranch_scc1 L_g2next
    s_barrier
    s_cmp_lg_u32 s48, 0
    s_cbranch_scc1 at_70
    v_mov_b32 v16, 1
    v_mov_b32 v17, 20
    s_mov_b64 exec, 1
    buffer_atomic_add v16, v17, s[40:43], 0 offen sc0
    s_waitcnt vmcnt(0)
    v_mov_b32 v17, 163328
    ds_write_b32 v17, v16
    s_mov_b64 exec, -1
    s_waitcnt lgkmcnt(0)
at_70:
    s_barrier
    v_mov_b32 v17, 163328
    ds_read_b32 v16, v17
    s_waitcnt lgkmcnt(0)
    v_readfirstlane_b32 s57, v16
    s_nop 0
    s_cmp_lt_u32 s57, 112
    s_nop 2
    s_cbranch_scc1 L_notg2
L_g2next:
    s_add_u32 s64, s64, 1
    s_cmp_ge_u32 s64, 7
    s_cbranch_scc1 L_end
    s_add_u32 s62, s62, 1
    s_cmp_ge_u32 s62, 7
    s_cselect_b32 s62, 0, s62
    s_branch L_g2try
L_g2go:
    s_lshl_b32 s57, s62, 4
    s_add_u32 s57, s57, s61
    v_mbcnt_lo_u32_b32 v16, -1, 0
    v_mbcnt_hi_u32_b32 v16, -1, v16
    v_lshrrev_b32 v17, 4, v16
    v_and_b32 v18, 15, v16
    v_lshlrev_b32 v23, 4, v16
    s_and_b32 s60, s57, 15
    s_lshl_b32 s60, s60, 6
    v_lshrrev_b32 v19, 2, v16
    v_lshlrev_b32 v20, 10, v19
    v_and_b32 v19, 3, v16
    v_lshl_add_u32 v20, v19, 4, v20
    v_add_u32 v20, s60, v20
    s_mul_i32 s61, s48, 36864
    v_bfe_u32 v19, v16, 2, 2
    v_lshl_add_u32 v22, v17, 2, v19
    v_lshlrev_b32 v22, 6, v22
    v_lshrrev_b32 v27, 1, v17
    v_lshl_add_u32 v21, v27, 4, v19
    v_and_b32 v27, 1, v17
    v_lshl_add_u32 v21, v27, 2, v21
    v_lshlrev_b32 v21, 6, v21
    v_and_b32 v19, 3, v16
    v_lshl_add_u32 v21, v19, 4, v21
    v_lshl_add_u32 v22, v19, 4, v22
    v_add_u32 v21, s61, v21
    v_add_u32 v22, s61, v22
    s_barrier
    s_mov_b32 s32, s18
    s_and_b32 s33, s19, 0xffff
    s_mov_b32 s34, 0x400000
    s_mov_b32 s35, 0x00020000
    s_mov_b32 s36, s8
    s_and_b32 s37, s9, 0xffff
    s_mov_b32 s38, 0x80000
    s_mov_b32 s39, 0x00020000
    s_cmp_eq_u32 s48, 0
    s_cbranch_scc1 g2w0_71
    s_mul_i32 s52, s48, 1179648
    s_sub_u32 s52, s52, 524288
    s_add_u32 m0, s61, 0
    s_add_u32 s53, s52, 0
    buffer_load_dwordx4 v20, s[32:35], s53 offen lds
    s_add_u32 m0, s61, 1024
    s_add_u32 s53, s52, 16384
    buffer_load_dwordx4 v20, s[32:35], s53 offen lds
    s_add_u32 m0, s61, 2048
    s_add_u32 s53, s52, 32768
    buffer_load_dwordx4 v20, s[32:35], s53 offen lds
    s_add_u32 m0, s61, 3072
    s_add_u32 s53, s52, 49152
    buffer_load_dwordx4 v20, s[32:35], s53 offen lds
    s_add_u32 m0, s61, 4096
    s_add_u32 s53, s52, 65536
    buffer_load_dwordx4 v20, s[32:35], s53 offen lds
    s_add_u32 m0, s61, 5120
    s_add_u32 s53, s52, 81920
    buffer_load_dwordx4 v20, s[32:35], s53 offen lds
    s_add_u32 m0, s61, 6144
    s_add_u32 s53, s52, 98304
    buffer_load_dwordx4 v20, s[32:35], s53 offen lds
    s_add_u32 m0, s61, 7168
    s_add_u32 s53, s52, 114688
    buffer_load_dwordx4 v20, s[32:35], s53 offen lds
    s_add_u32 m0, s61, 8192
    s_add_u32 s53, s52, 131072
    buffer_load_dwordx4 v20, s[32:35], s53 offen lds
    s_add_u32 m0, s61, 9216
    s_add_u32 s53, s52, 147456
    buffer_load_dwordx4 v20, s[32:35], s53 offen lds
    s_add_u32 m0, s61, 10240
    s_add_u32 s53, s52, 163840
    buffer_load_dwordx4 v20, s[32:35], s53 offen lds
    s_add_u32 m0, s61, 11264
    s_add_u32 s53, s52, 180224
    buffer_load_dwordx4 v20, s[32:35], s53 offen lds
    s_add_u32 m0, s61, 12288
    s_add_u32 s53, s52, 196608
    buffer_load_dwordx4 v20, s[32:35], s53 offen lds
    s_add_u32 m0, s61, 13312
    s_add_u32 s53, s52, 212992
    buffer_load_dwordx4 v20, s[32:35], s53 offen lds
    s_add_u32 m0, s61, 14336
    s_add_u32 s53, s52, 229376
    buffer_load_dwordx4 v20, s[32:35], s53 offen lds
    s_add_u32 m0, s61, 15360
    s_add_u32 s53, s52, 245760
    buffer_load_dwordx4 v20, s[32:35], s53 offen lds
    s_add_u32 m0, s61, 16384
    s_add_u32 s53, s52, 262144
    buffer_load_dwordx4 v20, s[32:35], s53 offen lds
    s_add_u32 m0, s61, 17408
    s_add_u32 s53, s52, 278528
    buffer_load_dwordx4 v20, s[32:35], s53 offen lds
    s_add_u32 m0, s61, 18432
    s_add_u32 s53, s52, 294912
    buffer_load_dwordx4 v20, s[32:35], s53 offen lds
    s_add_u32 m0, s61, 19456
    s_add_u32 s53, s52, 311296
    buffer_load_dwordx4 v20, s[32:35], s53 offen lds
    s_add_u32 m0, s61, 20480
    s_add_u32 s53, s52, 327680
    buffer_load_dwordx4 v20, s[32:35], s53 offen lds
    s_add_u32 m0, s61, 21504
    s_add_u32 s53, s52, 344064
    buffer_load_dwordx4 v20, s[32:35], s53 offen lds
    s_add_u32 m0, s61, 22528
    s_add_u32 s53, s52, 360448
    buffer_load_dwordx4 v20, s[32:35], s53 offen lds
    s_add_u32 m0, s61, 23552
    s_add_u32 s53, s52, 376832
    buffer_load_dwordx4 v20, s[32:35], s53 offen lds
    s_add_u32 m0, s61, 24576
    s_add_u32 s53, s52, 393216
    buffer_load_dwordx4 v20, s[32:35], s53 offen lds
    s_add_u32 m0, s61, 25600
    s_add_u32 s53, s52, 409600
    buffer_load_dwordx4 v20, s[32:35], s53 offen lds
    s_add_u32 m0, s61, 26624
    s_add_u32 s53, s52, 425984
    buffer_load_dwordx4 v20, s[32:35], s53 offen lds
    s_add_u32 m0, s61, 27648
    s_add_u32 s53, s52, 442368
    buffer_load_dwordx4 v20, s[32:35], s53 offen lds
    s_add_u32 m0, s61, 28672
    s_add_u32 s53, s52, 458752
    buffer_load_dwordx4 v20, s[32:35], s53 offen lds
    s_add_u32 m0, s61, 29696
    s_add_u32 s53, s52, 475136
    buffer_load_dwordx4 v20, s[32:35], s53 offen lds
    s_add_u32 m0, s61, 30720
    s_add_u32 s53, s52, 491520
    buffer_load_dwordx4 v20, s[32:35], s53 offen lds
    s_add_u32 m0, s61, 31744
    s_add_u32 s53, s52, 507904
    buffer_load_dwordx4 v20, s[32:35], s53 offen lds
    s_add_u32 m0, s61, 32768
    s_add_u32 s53, s52, 524288
    buffer_load_dwordx4 v20, s[32:35], s53 offen lds
    s_add_u32 m0, s61, 33792
    s_add_u32 s53, s52, 540672
    buffer_load_dwordx4 v20, s[32:35], s53 offen lds
    s_add_u32 m0, s61, 34816
    s_add_u32 s53, s52, 557056
    buffer_load_dwordx4 v20, s[32:35], s53 offen lds
    s_add_u32 m0, s61, 35840
    s_add_u32 s53, s52, 573440
    buffer_load_dwordx4 v20, s[32:35], s53 offen lds
    s_waitcnt vmcnt(0)
    ds_read_b64_tr_b16 a[0:1], v22 offset:0
    ds_read_b64_tr_b16 a[2:3], v22 offset:1024
    ds_read_b64_tr_b16 a[4:5], v22 offset:8
    ds_read_b64_tr_b16 a[6:7], v22 offset:1032
    ds_read_b64_tr_b16 a[8:9], v22 offset:2048
    ds_read_b64_tr_b16 a[10:11], v22 offset:3072
    ds_read_b64_tr_b16 a[12:13], v22 offset:2056
    ds_read_b64_tr_b16 a[14:15], v22 offset:3080
    ds_read_b64_tr_b16 a[16:17], v22 offset:4096
    ds_read_b64_tr_b16 a[18:19], v22 offset:5120
    ds_read_b64_tr_b16 a[20:21], v22 offset:4104
    ds_read_b64_tr_b16 a[22:23], v22 offset:5128
    s_waitcnt lgkmcnt(0)
    ds_read_b64_tr_b16 a[24:25], v22 offset:6144
    ds_read_b64_tr_b16 a[26:27], v22 offset:7168
    ds_read_b64_tr_b16 a[28:29], v22 offset:6152
    ds_read_b64_tr_b16 a[30:31], v22 offset:7176
    ds_read_b64_tr_b16 a[32:33], v22 offset:8192
    ds_read_b64_tr_b16 a[34:35], v22 offset:9216
    ds_read_b64_tr_b16 a[36:37], v22 offset:8200
    ds_read_b64_tr_b16 a[38:39], v22 offset:9224
    ds_read_b64_tr_b16 a[40:41], v22 offset:10240
    ds_read_b64_tr_b16 a[42:43], v22 offset:11264
    ds_read_b64_tr_b16 a[44:45], v22 offset:10248
    ds_read_b64_tr_b16 a[46:47], v22 offset:11272
    s_waitcnt lgkmcnt(0)
    ds_read_b64_tr_b16 a[48:49], v22 offset:12288
    ds_read_b64_tr_b16 a[50:51], v22 offset:13312
    ds_read_b64_tr_b16 a[52:53], v22 offset:12296
    ds_read_b64_tr_b16 a[54:55], v22 offset:13320
    ds_read_b64_tr_b16 a[56:57], v22 offset:14336
    ds_read_b64_tr_b16 a[58:59], v22 offset:15360
    ds_read_b64_tr_b16 a[60:61], v22 offset:14344
    ds_read_b64_tr_b16 a[62:63], v22 offset:15368
    ds_read_b64_tr_b16 a[64:65], v22 offset:16384
    ds_read_b64_tr_b16 a[66:67], v22 offset:17408
    ds_read_b64_tr_b16 a[68:69], v22 offset:16392
    ds_read_b64_tr_b16 a[70:71], v22 offset:17416
    s_waitcnt lgkmcnt(0)
    ds_read_b64_tr_b16 a[72:73], v22 offset:18432
    ds_read_b64_tr_b16 a[74:75], v22 offset:19456
    ds_read_b64_tr_b16 a[76:77], v22 offset:18440
    ds_read_b64_tr_b16 a[78:79], v22 offset:19464
    ds_read_b64_tr_b16 a[80:81], v22 offset:20480
    ds_read_b64_tr_b16 a[82:83], v22 offset:21504
    ds_read_b64_tr_b16 a[84:85], v22 offset:20488
    ds_read_b64_tr_b16 a[86:87], v22 offset:21512
    ds_read_b64_tr_b16 a[88:89], v22 offset:22528
    ds_read_b64_tr_b16 a[90:91], v22 offset:23552
    ds_read_b64_tr_b16 a[92:93], v22 offset:22536
    ds_read_b64_tr_b16 a[94:95], v22 offset:23560
    s_waitcnt lgkmcnt(0)
    ds_read_b64_tr_b16 a[96:97], v22 offset:24576
    ds_read_b64_tr_b16 a[98:99], v22 offset:25600
    ds_read_b64_tr_b16 a[100:101], v22 offset:24584
    ds_read_b64_tr_b16 a[102:103], v22 offset:25608
    ds_read_b64_tr_b16 a[104:105], v22 offset:26624
    ds_read_b64_tr_b16 a[106:107], v22 offset:27648
    ds_read_b64_tr_b16 a[108:109], v22 offset:26632
    ds_read_b64_tr_b16 a[110:111], v22 offset:27656
    ds_read_b64_tr_b16 a[112:113], v22 offset:28672
    ds_read_b64_tr_b16 a[114:115], v22 offset:29696
    ds_read_b64_tr_b16 a[116:117], v22 offset:28680
    ds_read_b64_tr_b16 a[118:119], v22 offset:29704
    s_waitcnt lgkmcnt(0)
    ds_read_b64_tr_b16 a[120:121], v22 offset:30720
    ds_read_b64_tr_b16 a[122:123], v22 offset:31744
    ds_read_b64_tr_b16 a[124:125], v22 offset:30728
    ds_read_b64_tr_b16 a[126:127], v22 offset:31752
    ds_read_b64_tr_b16 a[128:129], v22 offset:32768
    ds_read_b64_tr_b16 a[130:131], v22 offset:33792
    ds_read_b64_tr_b16 a[132:133], v22 offset:32776
    ds_read_b64_tr_b16 a[134:135], v22 offset:33800
    ds_read_b64_tr_b16 a[136:137], v22 offset:34816
    ds_read_b64_tr_b16 a[138:139], v22 offset:35840
    ds_read_b64_tr_b16 a[140:141], v22 offset:34824
    ds_read_b64_tr_b16 a[142:143], v22 offset:35848
    s_waitcnt lgkmcnt(0)
    s_add_u32 m0, s61, 0
    s_add_u32 s53, s52, 589824
    buffer_load_dwordx4 v20, s[32:35], s53 offen lds
    s_add_u32 m0, s61, 1024
    s_add_u32 s53, s52, 606208
    buffer_load_dwordx4 v20, s[32:35], s53 offen lds
    s_add_u32 m0, s61, 2048
    s_add_u32 s53, s52, 622592
    buffer_load_dwordx4 v20, s[32:35], s53 offen lds
    s_add_u32 m0, s61, 3072
    s_add_u32 s53, s52, 638976
    buffer_load_dwordx4 v20, s[32:35], s53 offen lds
    s_add_u32 m0, s61, 4096
    s_add_u32 s53, s52, 655360
    buffer_load_dwordx4 v20, s[32:35], s53 offen lds
    s_add_u32 m0, s61, 5120
    s_add_u32 s53, s52, 671744
    buffer_load_dwordx4 v20, s[32:35], s53 offen lds
    s_add_u32 m0, s61, 6144
    s_add_u32 s53, s52, 688128
    buffer_load_dwordx4 v20, s[32:35], s53 offen lds
    s_add_u32 m0, s61, 7168
    s_add_u32 s53, s52, 704512
    buffer_load_dwordx4 v20, s[32:35], s53 offen lds
    s_add_u32 m0, s61, 8192
    s_add_u32 s53, s52, 720896
    buffer_load_dwordx4 v20, s[32:35], s53 offen lds
    s_add_u32 m0, s61, 9216
    s_add_u32 s53, s52, 737280
    buffer_load_dwordx4 v20, s[32:35], s53 offen lds
    s_add_u32 m0, s61, 10240
    s_add_u32 s53, s52, 753664
    buffer_load_dwordx4 v20, s[32:35], s53 offen lds
    s_add_u32 m0, s61, 11264
    s_add_u32 s53, s52, 770048
    buffer_load_dwordx4 v20, s[32:35], s53 offen lds
    s_add_u32 m0, s61, 12288
    s_add_u32 s53, s52, 786432
    buffer_load_dwordx4 v20, s[32:35], s53 offen lds
    s_add_u32 m0, s61, 13312
    s_add_u32 s53, s52, 802816
    buffer_load_dwordx4 v20, s[32:35], s53 offen lds
    s_add_u32 m0, s61, 14336
    s_add_u32 s53, s52, 819200
    buffer_load_dwordx4 v20, s[32:35], s53 offen lds
    s_add_u32 m0, s61, 15360
    s_add_u32 s53, s52, 835584
    buffer_load_dwordx4 v20, s[32:35], s53 offen lds
    s_add_u32 m0, s61, 16384
    s_add_u32 s53, s52, 851968
    buffer_load_dwordx4 v20, s[32:35], s53 offen lds
    s_add_u32 m0, s61, 17408
    s_add_u32 s53, s52, 868352
    buffer_load_dwordx4 v20, s[32:35], s53 offen lds
    s_add_u32 m0, s61, 18432
    s_add_u32 s53, s52, 884736
    buffer_load_dwordx4 v20, s[32:35], s53 offen lds
    s_add_u32 m0, s61, 19456
    s_add_u32 s53, s52, 901120
    buffer_load_dwordx4 v20, s[32:35], s53 offen lds
    s_add_u32 m0, s61, 20480
    s_add_u32 s53, s52, 917504
    buffer_load_dwordx4 v20, s[32:35], s53 offen lds
    s_add_u32 m0, s61, 21504
    s_add_u32 s53, s52, 933888
    buffer_load_dwordx4 v20, s[32:35], s53 offen lds
    s_add_u32 m0, s61, 22528
    s_add_u32 s53, s52, 950272
    buffer_load_dwordx4 v20, s[32:35], s53 offen lds
    s_add_u32 m0, s61, 23552
    s_add_u32 s53, s52, 966656
    buffer_load_dwordx4 v20, s[32:35], s53 offen lds
    s_add_u32 m0, s61, 24576
    s_add_u32 s53, s52, 983040
    buffer_load_dwordx4 v20, s[32:35], s53 offen lds
    s_add_u32 m0, s61, 25600
    s_add_u32 s53, s52, 999424
    buffer_load_dwordx4 v20, s[32:35], s53 offen lds
    s_add_u32 m0, s61, 26624
    s_add_u32 s53, s52, 1015808
    buffer_load_dwordx4 v20, s[32:35], s53 offen lds
    s_add_u32 m0, s61, 27648
    s_add_u32 s53, s52, 1032192
    buffer_load_dwordx4 v20, s[32:35], s53 offen lds
    s_add_u32 m0, s61, 28672
    s_add_u32 s53, s52, 1048576
    buffer_load_dwordx4 v20, s[32:35], s53 offen lds
    s_add_u32 m0, s61, 29696
    s_add_u32 s53, s52, 1064960
    buffer_load_dwordx4 v20, s[32:35], s53 offen lds
    s_add_u32 m0, s61, 30720
    s_add_u32 s53, s52, 1081344
    buffer_load_dwordx4 v20, s[32:35], s53 offen lds
    s_add_u32 m0, s61, 31744
    s_add_u32 s53, s52, 1097728
    buffer_load_dwordx4 v20, s[32:35], s53 offen lds
    s_add_u32 m0, s61, 32768
    s_add_u32 s53, s52, 1114112
    buffer_load_dwordx4 v20, s[32:35], s53 offen lds
    s_add_u32 m0, s61, 33792
    s_add_u32 s53, s52, 1130496
    buffer_load_dwordx4 v20, s[32:35], s53 offen lds
    s_add_u32 m0, s61, 34816
    s_add_u32 s53, s52, 1146880
    buffer_load_dwordx4 v20, s[32:35], s53 offen lds
    s_add_u32 m0, s61, 35840
    s_add_u32 s53, s52, 1163264
    buffer_load_dwordx4 v20, s[32:35], s53 offen lds
    s_waitcnt vmcnt(0)
    ds_read_b64_tr_b16 a[144:145], v22 offset:0
    ds_read_b64_tr_b16 a[146:147], v22 offset:1024
    ds_read_b64_tr_b16 a[148:149], v22 offset:8
    ds_read_b64_tr_b16 a[150:151], v22 offset:1032
    ds_read_b64_tr_b16 a[152:153], v22 offset:2048
    ds_read_b64_tr_b16 a[154:155], v22 offset:3072
    ds_read_b64_tr_b16 a[156:157], v22 offset:2056
    ds_read_b64_tr_b16 a[158:159], v22 offset:3080
    ds_read_b64_tr_b16 a[160:161], v22 offset:4096
    ds_read_b64_tr_b16 a[162:163], v22 offset:5120
    ds_read_b64_tr_b16 a[164:165], v22 offset:4104
    ds_read_b64_tr_b16 a[166:167], v22 offset:5128
    s_waitcnt lgkmcnt(0)
    ds_read_b64_tr_b16 a[168:169], v22 offset:6144
    ds_read_b64_tr_b16 a[170:171], v22 offset:7168
    ds_read_b64_tr_b16 a[172:173], v22 offset:6152
    ds_read_b64_tr_b16 a[174:175], v22 offset:7176
    ds_read_b64_tr_b16 a[176:177], v22 offset:8192
    ds_read_b64_tr_b16 a[178:179], v22 offset:9216
    ds_read_b64_tr_b16 a[180:181], v22 offset:8200
    ds_read_b64_tr_b16 a[182:183], v22 offset:9224
    ds_read_b64_tr_b16 a[184:185], v22 offset:10240
    ds_read_b64_tr_b16 a[186:187], v22 offset:11264
    ds_read_b64_tr_b16 a[188:189], v22 offset:10248
    ds_read_b64_tr_b16 a[190:191], v22 offset:11272
    s_waitcnt lgkmcnt(0)
    ds_read_b64_tr_b16 a[192:193], v22 offset:12288
    ds_read_b64_tr_b16 a[194:195], v22 offset:13312
    ds_read_b64_tr_b16 a[196:197], v22 offset:12296
    ds_read_b64_tr_b16 a[198:199], v22 offset:13320
    ds_read_b64_tr_b16 a[200:201], v22 offset:14336
    ds_read_b64_tr_b16 a[202:203], v22 offset:15360
    ds_read_b64_tr_b16 a[204:205], v22 offset:14344
    ds_read_b64_tr_b16 a[206:207], v22 offset:15368
    ds_read_b64_tr_b16 a[208:209], v22 offset:16384
    ds_read_b64_tr_b16 a[210:211], v22 offset:17408
    ds_read_b64_tr_b16 a[212:213], v22 offset:16392
    ds_read_b64_tr_b16 a[214:215], v22 offset:17416
    s_waitcnt lgkmcnt(0)
    ds_read_b64_tr_b16 a[216:217], v22 offset:18432
    ds_read_b64_tr_b16 a[218:219], v22 offset:19456
    ds_read_b64_tr_b16 a[220:221], v22 offset:18440
    ds_read_b64_tr_b16 a[222:223], v22 offset:19464
    ds_read_b64_tr_b16 a[224:225], v22 offset:20480
    ds_read_b64_tr_b16 a[226:227], v22 offset:21504
    ds_read_b64_tr_b16 a[228:229], v22 offset:20488
    ds_read_b64_tr_b16 a[230:231], v22 offset:21512
    ds_read_b64_tr_b16 a[232:233], v22 offset:22528
    ds_read_b64_tr_b16 a[234:235], v22 offset:23552
    ds_read_b64_tr_b16 a[236:237], v22 offset:22536
    ds_read_b64_tr_b16 a[238:239], v22 offset:23560
    s_waitcnt lgkmcnt(0)
    ds_read_b64_tr_b16 a[240:241], v22 offset:24576
    ds_read_b64_tr_b16 a[242:243], v22 offset:25600
    ds_read_b64_tr_b16 a[244:245], v22 offset:24584
    ds_read_b64_tr_b16 a[246:247], v22 offset:25608
    ds_read_b64_tr_b16 a[248:249], v22 offset:26624
    ds_read_b64_tr_b16 a[250:251], v22 offset:27648
    ds_read_b64_tr_b16 a[252:253], v22 offset:26632
    ds_read_b64_tr_b16 a[254:255], v22 offset:27656
    ds_read_b64_tr_b16 v[224:225], v22 offset:28672
    ds_read_b64_tr_b16 v[226:227], v22 offset:29696
    ds_read_b64_tr_b16 v[228:229], v22 offset:28680
    ds_read_b64_tr_b16 v[230:231], v22 offset:29704
    s_waitcnt lgkmcnt(0)
    ds_read_b64_tr_b16 v[232:233], v22 offset:30720
    ds_read_b64_tr_b16 v[234:235], v22 offset:31744
    ds_read_b64_tr_b16 v[236:237], v22 offset:30728
    ds_read_b64_tr_b16 v[238:239], v22 offset:31752
    ds_read_b64_tr_b16 v[240:241], v22 offset:32768
    ds_read_b64_tr_b16 v[242:243], v22 offset:33792
    ds_read_b64_tr_b16 v[244:245], v22 offset:32776
    ds_read_b64_tr_b16 v[246:247], v22 offset:33800
    ds_read_b64_tr_b16 v[248:249], v22 offset:34816
    ds_read_b64_tr_b16 v[250:251], v22 offset:35840
    ds_read_b64_tr_b16 v[252:253], v22 offset:34824
    ds_read_b64_tr_b16 v[254:255], v22 offset:35848
    s_waitcnt lgkmcnt(0)
    s_branch g2wd_72
g2w0_71:
    s_add_u32 m0, s61, 0
    s_mov_b32 s53, 0
    buffer_load_dwordx4 v20, s[36:39], s53 offen lds
    s_add_u32 m0, s61, 1024
    s_mov_b32 s53, 16384
    buffer_load_dwordx4 v20, s[36:39], s53 offen lds
    s_add_u32 m0, s61, 2048
    s_mov_b32 s53, 32768
    buffer_load_dwordx4 v20, s[36:39], s53 offen lds
    s_add_u32 m0, s61, 3072
    s_mov_b32 s53, 49152
    buffer_load_dwordx4 v20, s[36:39], s53 offen lds
    s_add_u32 m0, s61, 4096
    s_mov_b32 s53, 65536
    buffer_load_dwordx4 v20, s[36:39], s53 offen lds
    s_add_u32 m0, s61, 5120
    s_mov_b32 s53, 81920
    buffer_load_dwordx4 v20, s[36:39], s53 offen lds
    s_add_u32 m0, s61, 6144
    s_mov_b32 s53, 98304
    buffer_load_dwordx4 v20, s[36:39], s53 offen lds
    s_add_u32 m0, s61, 7168
    s_mov_b32 s53, 114688
    buffer_load_dwordx4 v20, s[36:39], s53 offen lds
    s_add_u32 m0, s61, 8192
    s_mov_b32 s53, 131072
    buffer_load_dwordx4 v20, s[36:39], s53 offen lds
    s_add_u32 m0, s61, 9216
    s_mov_b32 s53, 147456
    buffer_load_dwordx4 v20, s[36:39], s53 offen lds
    s_add_u32 m0, s61, 10240
    s_mov_b32 s53, 163840
    buffer_load_dwordx4 v20, s[36:39], s53 offen lds
    s_add_u32 m0, s61, 11264
    s_mov_b32 s53, 180224
    buffer_load_dwordx4 v20, s[36:39], s53 offen lds
    s_add_u32 m0, s61, 12288
    s_mov_b32 s53, 196608
    buffer_load_dwordx4 v20, s[36:39], s53 offen lds
    s_add_u32 m0, s61, 13312
    s_mov_b32 s53, 212992
    buffer_load_dwordx4 v20, s[36:39], s53 offen lds
    s_add_u32 m0, s61, 14336
    s_mov_b32 s53, 229376
    buffer_load_dwordx4 v20, s[36:39], s53 offen lds
    s_add_u32 m0, s61, 15360
    s_mov_b32 s53, 245760
    buffer_load_dwordx4 v20, s[36:39], s53 offen lds
    s_add_u32 m0, s61, 16384
    s_mov_b32 s53, 262144
    buffer_load_dwordx4 v20, s[36:39], s53 offen lds
    s_add_u32 m0, s61, 17408
    s_mov_b32 s53, 278528
    buffer_load_dwordx4 v20, s[36:39], s53 offen lds
    s_add_u32 m0, s61, 18432
    s_mov_b32 s53, 294912
    buffer_load_dwordx4 v20, s[36:39], s53 offen lds
    s_add_u32 m0, s61, 19456
    s_mov_b32 s53, 311296
    buffer_load_dwordx4 v20, s[36:39], s53 offen lds
    s_add_u32 m0, s61, 20480
    s_mov_b32 s53, 327680
    buffer_load_dwordx4 v20, s[36:39], s53 offen lds
    s_add_u32 m0, s61, 21504
    s_mov_b32 s53, 344064
    buffer_load_dwordx4 v20, s[36:39], s53 offen lds
    s_add_u32 m0, s61, 22528
    s_mov_b32 s53, 360448
    buffer_load_dwordx4 v20, s[36:39], s53 offen lds
    s_add_u32 m0, s61, 23552
    s_mov_b32 s53, 376832
    buffer_load_dwordx4 v20, s[36:39], s53 offen lds
    s_add_u32 m0, s61, 24576
    s_mov_b32 s53, 393216
    buffer_load_dwordx4 v20, s[36:39], s53 offen lds
    s_add_u32 m0, s61, 25600
    s_mov_b32 s53, 409600
    buffer_load_dwordx4 v20, s[36:39], s53 offen lds
    s_add_u32 m0, s61, 26624
    s_mov_b32 s53, 425984
    buffer_load_dwordx4 v20, s[36:39], s53 offen lds
    s_add_u32 m0, s61, 27648
    s_mov_b32 s53, 442368
    buffer_load_dwordx4 v20, s[36:39], s53 offen lds
    s_add_u32 m0, s61, 28672
    s_mov_b32 s53, 458752
    buffer_load_dwordx4 v20, s[36:39], s53 offen lds
    s_add_u32 m0, s61, 29696
    s_mov_b32 s53, 475136
    buffer_load_dwordx4 v20, s[36:39], s53 offen lds
    s_add_u32 m0, s61, 30720
    s_mov_b32 s53, 491520
    buffer_load_dwordx4 v20, s[36:39], s53 offen lds
    s_add_u32 m0, s61, 31744
    s_mov_b32 s53, 507904
    buffer_load_dwordx4 v20, s[36:39], s53 offen lds
    s_add_u32 m0, s61, 32768
    s_mov_b32 s53, 0
    buffer_load_dwordx4 v20, s[32:35], s53 offen lds
    s_add_u32 m0, s61, 33792
    s_mov_b32 s53, 16384
    buffer_load_dwordx4 v20, s[32:35], s53 offen lds
    s_add_u32 m0, s61, 34816
    s_mov_b32 s53, 32768
    buffer_load_dwordx4 v20, s[32:35], s53 offen lds
    s_add_u32 m0, s61, 35840
    s_mov_b32 s53, 49152
    buffer_load_dwordx4 v20, s[32:35], s53 offen lds
    s_waitcnt vmcnt(0)
    ds_read_b64_tr_b16 a[0:1], v21 offset:0
    ds_read_b64_tr_b16 a[2:3], v21 offset:512
    ds_read_b64_tr_b16 a[4:5], v21 offset:8
    ds_read_b64_tr_b16 a[6:7], v21 offset:520
    ds_read_b64_tr_b16 a[8:9], v21 offset:2048
    ds_read_b64_tr_b16 a[10:11], v21 offset:2560
    ds_read_b64_tr_b16 a[12:13], v21 offset:2056
    ds_read_b64_tr_b16 a[14:15], v21 offset:2568
    ds_read_b64_tr_b16 a[16:17], v21 offset:4096
    ds_read_b64_tr_b16 a[18:19], v21 offset:4608
    ds_read_b64_tr_b16 a[20:21], v21 offset:4104
    ds_read_b64_tr_b16 a[22:23], v21 offset:4616
    s_waitcnt lgkmcnt(0)
    ds_read_b64_tr_b16 a[24:25], v21 offset:6144
    ds_read_b64_tr_b16 a[26:27], v21 offset:6656
    ds_read_b64_tr_b16 a[28:29], v21 offset:6152
    ds_read_b64_tr_b16 a[30:31], v21 offset:6664
    ds_read_b64_tr_b16 a[32:33], v21 offset:8192
    ds_read_b64_tr_b16 a[34:35], v21 offset:8704
    ds_read_b64_tr_b16 a[36:37], v21 offset:8200
    ds_read_b64_tr_b16 a[38:39], v21 offset:8712
    ds_read_b64_tr_b16 a[40:41], v21 offset:10240
    ds_read_b64_tr_b16 a[42:43], v21 offset:10752
    ds_read_b64_tr_b16 a[44:45], v21 offset:10248
    ds_read_b64_tr_b16 a[46:47], v21 offset:10760
    s_waitcnt lgkmcnt(0)
    ds_read_b64_tr_b16 a[48:49], v21 offset:12288
    ds_read_b64_tr_b16 a[50:51], v21 offset:12800
    ds_read_b64_tr_b16 a[52:53], v21 offset:12296
    ds_read_b64_tr_b16 a[54:55], v21 offset:12808
    ds_read_b64_tr_b16 a[56:57], v21 offset:14336
    ds_read_b64_tr_b16 a[58:59], v21 offset:14848
    ds_read_b64_tr_b16 a[60:61], v21 offset:14344
    ds_read_b64_tr_b16 a[62:63], v21 offset:14856
    ds_read_b64_tr_b16 a[64:65], v21 offset:16384
    ds_read_b64_tr_b16 a[66:67], v21 offset:16896
    ds_read_b64_tr_b16 a[68:69], v21 offset:16392
    ds_read_b64_tr_b16 a[70:71], v21 offset:16904
    s_waitcnt lgkmcnt(0)
    ds_read_b64_tr_b16 a[72:73], v21 offset:18432
    ds_read_b64_tr_b16 a[74:75], v21 offset:18944
    ds_read_b64_tr_b16 a[76:77], v21 offset:18440
    ds_read_b64_tr_b16 a[78:79], v21 offset:18952
    ds_read_b64_tr_b16 a[80:81], v21 offset:20480
    ds_read_b64_tr_b16 a[82:83], v21 offset:20992
    ds_read_b64_tr_b16 a[84:85], v21 offset:20488
    ds_read_b64_tr_b16 a[86:87], v21 offset:21000
    ds_read_b64_tr_b16 a[88:89], v21 offset:22528
    ds_read_b64_tr_b16 a[90:91], v21 offset:23040
    ds_read_b64_tr_b16 a[92:93], v21 offset:22536
    ds_read_b64_tr_b16 a[94:95], v21 offset:23048
    s_waitcnt lgkmcnt(0)
    ds_read_b64_tr_b16 a[96:97], v21 offset:24576
    ds_read_b64_tr_b16 a[98:99], v21 offset:25088
    ds_read_b64_tr_b16 a[100:101], v21 offset:24584
    ds_read_b64_tr_b16 a[102:103], v21 offset:25096
    ds_read_b64_tr_b16 a[104:105], v21 offset:26624
    ds_read_b64_tr_b16 a[106:107], v21 offset:27136
    ds_read_b64_tr_b16 a[108:109], v21 offset:26632
    ds_read_b64_tr_b16 a[110:111], v21 offset:27144
    ds_read_b64_tr_b16 a[112:113], v21 offset:28672
    ds_read_b64_tr_b16 a[114:115], v21 offset:29184
    ds_read_b64_tr_b16 a[116:117], v21 offset:28680
    ds_read_b64_tr_b16 a[118:119], v21 offset:29192
    s_waitcnt lgkmcnt(0)
    ds_read_b64_tr_b16 a[120:121], v21 offset:30720
    ds_read_b64_tr_b16 a[122:123], v21 offset:31232
    ds_read_b64_tr_b16 a[124:125], v21 offset:30728
    ds_read_b64_tr_b16 a[126:127], v21 offset:31240
    ds_read_b64_tr_b16 a[128:129], v22 offset:32768
    ds_read_b64_tr_b16 a[130:131], v22 offset:33792
    ds_read_b64_tr_b16 a[132:133], v22 offset:32776
    ds_read_b64_tr_b16 a[134:135], v22 offset:33800
    ds_read_b64_tr_b16 a[136:137], v22 offset:34816
    ds_read_b64_tr_b16 a[138:139], v22 offset:35840
    ds_read_b64_tr_b16 a[140:141], v22 offset:34824
    ds_read_b64_tr_b16 a[142:143], v22 offset:35848
    s_waitcnt lgkmcnt(0)
    s_add_u32 m0, s61, 0
    s_mov_b32 s53, 65536
    buffer_load_dwordx4 v20, s[32:35], s53 offen lds
    s_add_u32 m0, s61, 1024
    s_mov_b32 s53, 81920
    buffer_load_dwordx4 v20, s[32:35], s53 offen lds
    s_add_u32 m0, s61, 2048
    s_mov_b32 s53, 98304
    buffer_load_dwordx4 v20, s[32:35], s53 offen lds
    s_add_u32 m0, s61, 3072
    s_mov_b32 s53, 114688
    buffer_load_dwordx4 v20, s[32:35], s53 offen lds
    s_add_u32 m0, s61, 4096
    s_mov_b32 s53, 131072
    buffer_load_dwordx4 v20, s[32:35], s53 offen lds
    s_add_u32 m0, s61, 5120
    s_mov_b32 s53, 147456
    buffer_load_dwordx4 v20, s[32:35], s53 offen lds
    s_add_u32 m0, s61, 6144
    s_mov_b32 s53, 163840
    buffer_load_dwordx4 v20, s[32:35], s53 offen lds
    s_add_u32 m0, s61, 7168
    s_mov_b32 s53, 180224
    buffer_load_dwordx4 v20, s[32:35], s53 offen lds
    s_add_u32 m0, s61, 8192
    s_mov_b32 s53, 196608
    buffer_load_dwordx4 v20, s[32:35], s53 offen lds
    s_add_u32 m0, s61, 9216
    s_mov_b32 s53, 212992
    buffer_load_dwordx4 v20, s[32:35], s53 offen lds
    s_add_u32 m0, s61, 10240
    s_mov_b32 s53, 229376
    buffer_load_dwordx4 v20, s[32:35], s53 offen lds
    s_add_u32 m0, s61, 11264
    s_mov_b32 s53, 245760
    buffer_load_dwordx4 v20, s[32:35], s53 offen lds
    s_add_u32 m0, s61, 12288
    s_mov_b32 s53, 262144
    buffer_load_dwordx4 v20, s[32:35], s53 offen lds
    s_add_u32 m0, s61, 13312
    s_mov_b32 s53, 278528
    buffer_load_dwordx4 v20, s[32:35], s53 offen lds
    s_add_u32 m0, s61, 14336
    s_mov_b32 s53, 294912
    buffer_load_dwordx4 v20, s[32:35], s53 offen lds
    s_add_u32 m0, s61, 15360
    s_mov_b32 s53, 311296
    buffer_load_dwordx4 v20, s[32:35], s53 offen lds
    s_add_u32 m0, s61, 16384
    s_mov_b32 s53, 327680
    buffer_load_dwordx4 v20, s[32:35], s53 offen lds
    s_add_u32 m0, s61, 17408
    s_mov_b32 s53, 344064
    buffer_load_dwordx4 v20, s[32:35], s53 offen lds
    s_add_u32 m0, s61, 18432
    s_mov_b32 s53, 360448
    buffer_load_dwordx4 v20, s[32:35], s53 offen lds
    s_add_u32 m0, s61, 19456
    s_mov_b32 s53, 376832
    buffer_load_dwordx4 v20, s[32:35], s53 offen lds
    s_add_u32 m0, s61, 20480
    s_mov_b32 s53, 393216
    buffer_load_dwordx4 v20, s[32:35], s53 offen lds
    s_add_u32 m0, s61, 21504
    s_mov_b32 s53, 409600
    buffer_load_dwordx4 v20, s[32:35], s53 offen lds
    s_add_u32 m0, s61, 22528
    s_mov_b32 s53, 425984
    buffer_load_dwordx4 v20, s[32:35], s53 offen lds
    s_add_u32 m0, s61, 23552
    s_mov_b32 s53, 442368
    buffer_load_dwordx4 v20, s[32:35], s53 offen lds
    s_add_u32 m0, s61, 24576
    s_mov_b32 s53, 458752
    buffer_load_dwordx4 v20, s[32:35], s53 offen lds
    s_add_u32 m0, s61, 25600
    s_mov_b32 s53, 475136
    buffer_load_dwordx4 v20, s[32:35], s53 offen lds
    s_add_u32 m0, s61, 26624
    s_mov_b32 s53, 491520
    buffer_load_dwordx4 v20, s[32:35], s53 offen lds
    s_add_u32 m0, s61, 27648
    s_mov_b32 s53, 507904
    buffer_load_dwordx4 v20, s[32:35], s53 offen lds
    s_add_u32 m0, s61, 28672
    s_mov_b32 s53, 524288
    buffer_load_dwordx4 v20, s[32:35], s53 offen lds
    s_add_u32 m0, s61, 29696
    s_mov_b32 s53, 540672
    buffer_load_dwordx4 v20, s[32:35], s53 offen lds
    s_add_u32 m0, s61, 30720
    s_mov_b32 s53, 557056
    buffer_load_dwordx4 v20, s[32:35], s53 offen lds
    s_add_u32 m0, s61, 31744
    s_mov_b32 s53, 573440
    buffer_load_dwordx4 v20, s[32:35], s53 offen lds
    s_add_u32 m0, s61, 32768
    s_mov_b32 s53, 589824
    buffer_load_dwordx4 v20, s[32:35], s53 offen lds
    s_add_u32 m0, s61, 33792
    s_mov_b32 s53, 606208
    buffer_load_dwordx4 v20, s[32:35], s53 offen lds
    s_add_u32 m0, s61, 34816
    s_mov_b32 s53, 622592
    buffer_load_dwordx4 v20, s[32:35], s53 offen lds
    s_add_u32 m0, s61, 35840
    s_mov_b32 s53, 638976
    buffer_load_dwordx4 v20, s[32:35], s53 offen lds
    s_waitcnt vmcnt(0)
    ds_read_b64_tr_b16 a[144:145], v22 offset:0
    ds_read_b64_tr_b16 a[146:147], v22 offset:1024
    ds_read_b64_tr_b16 a[148:149], v22 offset:8
    ds_read_b64_tr_b16 a[150:151], v22 offset:1032
    ds_read_b64_tr_b16 a[152:153], v22 offset:2048
    ds_read_b64_tr_b16 a[154:155], v22 offset:3072
    ds_read_b64_tr_b16 a[156:157], v22 offset:2056
    ds_read_b64_tr_b16 a[158:159], v22 offset:3080
    ds_read_b64_tr_b16 a[160:161], v22 offset:4096
    ds_read_b64_tr_b16 a[162:163], v22 offset:5120
    ds_read_b64_tr_b16 a[164:165], v22 offset:4104
    ds_read_b64_tr_b16 a[166:167], v22 offset:5128
    s_waitcnt lgkmcnt(0)
    ds_read_b64_tr_b16 a[168:169], v22 offset:6144
    ds_read_b64_tr_b16 a[170:171], v22 offset:7168
    ds_read_b64_tr_b16 a[172:173], v22 offset:6152
    ds_read_b64_tr_b16 a[174:175], v22 offset:7176
    ds_read_b64_tr_b16 a[176:177], v22 offset:8192
    ds_read_b64_tr_b16 a[178:179], v22 offset:9216
    ds_read_b64_tr_b16 a[180:181], v22 offset:8200
    ds_read_b64_tr_b16 a[182:183], v22 offset:9224
    ds_read_b64_tr_b16 a[184:185], v22 offset:10240
    ds_read_b64_tr_b16 a[186:187], v22 offset:11264
    ds_read_b64_tr_b16 a[188:189], v22 offset:10248
    ds_read_b64_tr_b16 a[190:191], v22 offset:11272
    s_waitcnt lgkmcnt(0)
    ds_read_b64_tr_b16 a[192:193], v22 offset:12288
    ds_read_b64_tr_b16 a[194:195], v22 offset:13312
    ds_read_b64_tr_b16 a[196:197], v22 offset:12296
    ds_read_b64_tr_b16 a[198:199], v22 offset:13320
    ds_read_b64_tr_b16 a[200:201], v22 offset:14336
    ds_read_b64_tr_b16 a[202:203], v22 offset:15360
    ds_read_b64_tr_b16 a[204:205], v22 offset:14344
    ds_read_b64_tr_b16 a[206:207], v22 offset:15368
    ds_read_b64_tr_b16 a[208:209], v22 offset:16384
    ds_read_b64_tr_b16 a[210:211], v22 offset:17408
    ds_read_b64_tr_b16 a[212:213], v22 offset:16392
    ds_read_b64_tr_b16 a[214:215], v22 offset:17416
    s_waitcnt lgkmcnt(0)
    ds_read_b64_tr_b16 a[216:217], v22 offset:18432
    ds_read_b64_tr_b16 a[218:219], v22 offset:19456
    ds_read_b64_tr_b16 a[220:221], v22 offset:18440
    ds_read_b64_tr_b16 a[222:223], v22 offset:19464
    ds_read_b64_tr_b16 a[224:225], v22 offset:20480
    ds_read_b64_tr_b16 a[226:227], v22 offset:21504
    ds_read_b64_tr_b16 a[228:229], v22 offset:20488
    ds_read_b64_tr_b16 a[230:231], v22 offset:21512
    ds_read_b64_tr_b16 a[232:233], v22 offset:22528
    ds_read_b64_tr_b16 a[234:235], v22 offset:23552
    ds_read_b64_tr_b16 a[236:237], v22 offset:22536
    ds_read_b64_tr_b16 a[238:239], v22 offset:23560
    s_waitcnt lgkmcnt(0)
    ds_read_b64_tr_b16 a[240:241], v22 offset:24576
    ds_read_b64_tr_b16 a[242:243], v22 offset:25600
    ds_read_b64_tr_b16 a[244:245], v22 offset:24584
    ds_read_b64_tr_b16 a[246:247], v22 offset:25608
    ds_read_b64_tr_b16 a[248:249], v22 offset:26624
    ds_read_b64_tr_b16 a[250:251], v22 offset:27648
    ds_read_b64_tr_b16 a[252:253], v22 offset:26632
    ds_read_b64_tr_b16 a[254:255], v22 offset:27656
    ds_read_b64_tr_b16 v[224:225], v22 offset:28672
    ds_read_b64_tr_b16 v[226:227], v22 offset:29696
    ds_read_b64_tr_b16 v[228:229], v22 offset:28680
    ds_read_b64_tr_b16 v[230:231], v22 offset:29704
    s_waitcnt lgkmcnt(0)
    ds_read_b64_tr_b16 v[232:233], v22 offset:30720
    ds_read_b64_tr_b16 v[234:235], v22 offset:31744
    ds_read_b64_tr_b16 v[236:237], v22 offset:30728
    ds_read_b64_tr_b16 v[238:239], v22 offset:31752
    ds_read_b64_tr_b16 v[240:241], v22 offset:32768
    ds_read_b64_tr_b16 v[242:243], v22 offset:33792
    ds_read_b64_tr_b16 v[244:245], v22 offset:32776
    ds_read_b64_tr_b16 v[246:247], v22 offset:33800
    ds_read_b64_tr_b16 v[248:249], v22 offset:34816
    ds_read_b64_tr_b16 v[250:251], v22 offset:35840
    ds_read_b64_tr_b16 v[252:253], v22 offset:34824
    ds_read_b64_tr_b16 v[254:255], v22 offset:35848
    s_waitcnt lgkmcnt(0)
g2wd_72:
    v_lshrrev_b32 v19, 2, v18
    v_lshlrev_b32 v26, 13, v19
    v_and_b32 v19, 3, v18
    v_lshl_add_u32 v26, v19, 10, v26
    v_lshl_add_u32 v26, v17, 4, v26
    v_add_u32 v26, s60, v26
    v_mov_b32 v25, 1
    s_lshr_b32 s50, s57, 4
    s_lshl_b32 s52, s48, 11
    v_lshlrev_b32 v27, 1, v23
    v_add_u32 v21, s52, v27
    s_waitcnt lgkmcnt(0)
    s_barrier
g2top_73:
    s_lshr_b32 s52, s50, 1
    s_lshl_b32 s52, s52, 8
    s_add_u32 s52, s52, 4096
    v_lshlrev_b32 v24, 2, v16
    v_add_u32 v24, s52, v24
    s_cmp_lg_u32 s48, 0
    s_nop 0
    s_cbranch_scc1 g2np_74
pf_75:
    buffer_load_dword v19, v24, s[28:31], 0 offen sc1
    s_waitcnt vmcnt(0)
    v_cmp_lt_u32 vcc, v19, v25
    s_nop 4
    s_cbranch_vccz pfok_76
    s_sub_u32 s79, s79, 1
    s_cbranch_scc1 L_abort
    s_sleep 2
    s_branch pf_75
pfok_76:
g2np_74:
    s_barrier
    s_mul_i32 s52, s50, 147456
    s_add_u32 s52, s52, s61
    s_add_u32 s52, s52, 100663296
    buffer_load_dwordx4 v[32:35], v23, s[28:31], s52 offen offset:0
    buffer_load_dwordx4 v[36:39], v23, s[28:31], s52 offen offset:1024
    buffer_load_dwordx4 v[40:43], v23, s[28:31], s52 offen offset:2048
    buffer_load_dwordx4 v[44:47], v23, s[28:31], s52 offen offset:3072
    s_add_u32 s52, s52, 4096
    buffer_load_dwordx4 v[48:51], v23, s[28:31], s52 offen offset:0
    buffer_load_dwordx4 v[52:55], v23, s[28:31], s52 offen offset:1024
    buffer_load_dwordx4 v[56:59], v23, s[28:31], s52 offen offset:2048
    buffer_load_dwordx4 v[60:63], v23, s[28:31], s52 offen offset:3072
    s_add_u32 s52, s52, 4096
    buffer_load_dwordx4 v[64:67], v23, s[28:31], s52 offen offset:0
    buffer_load_dwordx4 v[68:71], v23, s[28:31], s52 offen offset:1024
    buffer_load_dwordx4 v[72:75], v23, s[28:31], s52 offen offset:2048
    buffer_load_dwordx4 v[76:79], v23, s[28:31], s52 offen offset:3072
    s_add_u32 s52, s52, 4096
    buffer_load_dwordx4 v[80:83], v23, s[28:31], s52 offen offset:0
    buffer_load_dwordx4 v[84:87], v23, s[28:31], s52 offen offset:1024
    buffer_load_dwordx4 v[88:91], v23, s[28:31], s52 offen offset:2048
    buffer_load_dwordx4 v[92:95], v23, s[28:31], s52 offen offset:3072
    s_add_u32 s52, s52, 4096
    buffer_load_dwordx4 v[96:99], v23, s[28:31], s52 offen offset:0
    buffer_load_dwordx4 v[100:103], v23, s[28:31], s52 offen offset:1024
    buffer_load_dwordx4 v[104:107], v23, s[28:31], s52 offen offset:2048
    buffer_load_dwordx4 v[108:111], v23, s[28:31], s52 offen offset:3072
    s_add_u32 s52, s52, 4096
    buffer_load_dwordx4 v[112:115], v23, s[28:31], s52 offen offset:0
    buffer_load_dwordx4 v[116:119], v23, s[28:31], s52 offen offset:1024
    buffer_load_dwordx4 v[120:123], v23, s[28:31], s52 offen offset:2048
    buffer_load_dwordx4 v[124:127], v23, s[28:31], s52 offen offset:3072
    s_add_u32 s52, s52, 4096
    buffer_load_dwordx4 v[128:131], v23, s[28:31], s52 offen offset:0
    buffer_load_dwordx4 v[132:135], v23, s[28:31], s52 offen offset:1024
    buffer_load_dwordx4 v[136:139], v23, s[28:31], s52 offen offset:2048
    buffer_load_dwordx4 v[140:143], v23, s[28:31], s52 offen offset:3072
    s_add_u32 s52, s52, 4096
    buffer_load_dwordx4 v[144:147], v23, s[28:31], s52 offen offset:0
    buffer_load_dwordx4 v[148:151], v23, s[28:31], s52 offen offset:1024
    buffer_load_dwordx4 v[152:155], v23, s[28:31], s52 offen offset:2048
    buffer_load_dwordx4 v[156:159], v23, s[28:31], s52 offen offset:3072
    s_add_u32 s52, s52, 4096
    buffer_load_dwordx4 v[160:163], v23, s[28:31], s52 offen offset:0
    buffer_load_dwordx4 v[164:167], v23, s[28:31], s52 offen offset:1024
    buffer_load_dwordx4 v[168:171], v23, s[28:31], s52 offen offset:2048
    buffer_load_dwordx4 v[172:175], v23, s[28:31], s52 offen offset:3072
    s_add_u32 s52, s52, 4096
    s_waitcnt vmcnt(35)
    v_mfma_f32_16x16x32_bf16 v[176:179], a[0:3], v[32:35], 0
    v_mfma_f32_16x16x32_bf16 v[180:183], a[4:7], v[32:35], 0
    s_waitcnt vmcnt(34)
    v_mfma_f32_16x16x32_bf16 v[176:179], a[8:11], v[36:39], v[176:179]
    v_mfma_f32_16x16x32_bf16 v[180:183], a[12:15], v[36:39], v[180:183]
    s_waitcnt vmcnt(33)
    v_mfma_f32_16x16x32_bf16 v[176:179], a[16:19], v[40:43], v[176:179]
    v_mfma_f32_16x16x32_bf16 v[180:183], a[20:23], v[40:43], v[180:183]
    s_waitcnt vmcnt(32)
    v_mfma_f32_16x16x32_bf16 v[176:179], a[24:27], v[44:47], v[176:179]
    v_mfma_f32_16x16x32_bf16 v[180:183], a[28:31], v[44:47], v[180:183]
    s_waitcnt vmcnt(31)
    v_mfma_f32_16x16x32_bf16 v[176:179], a[32:35], v[48:51], v[176:179]
    v_mfma_f32_16x16x32_bf16 v[180:183], a[36:39], v[48:51], v[180:183]
    s_waitcnt vmcnt(30)
    v_mfma_f32_16x16x32_bf16 v[176:179], a[40:43], v[52:55], v[176:179]
    v_mfma_f32_16x16x32_bf16 v[180:183], a[44:47], v[52:55], v[180:183]
    s_waitcnt vmcnt(29)
    v_mfma_f32_16x16x32_bf16 v[176:179], a[48:51], v[56:59], v[176:179]
    v_mfma_f32_16x16x32_bf16 v[180:183], a[52:55], v[56:59], v[180:183]
    s_waitcnt vmcnt(28)
    v_mfma_f32_16x16x32_bf16 v[176:179], a[56:59], v[60:63], v[176:179]
    v_mfma_f32_16x16x32_bf16 v[180:183], a[60:63], v[60:63], v[180:183]
    s_waitcnt vmcnt(27)
    v_mfma_f32_16x16x32_bf16 v[176:179], a[64:67], v[64:67], v[176:179]
    v_mfma_f32_16x16x32_bf16 v[180:183], a[68:71], v[64:67], v[180:183]
    s_waitcnt vmcnt(26)
    v_mfma_f32_16x16x32_bf16 v[176:179], a[72:75], v[68:71], v[176:179]
    v_mfma_f32_16x16x32_bf16 v[180:183], a[76:79], v[68:71], v[180:183]
    s_waitcnt vmcnt(25)
    v_mfma_f32_16x16x32_bf16 v[176:179], a[80:83], v[72:75], v[176:179]
    v_mfma_f32_16x16x32_bf16 v[180:183], a[84:87], v[72:75], v[180:183]
    s_waitcnt vmcnt(24)
    v_mfma_f32_16x16x32_bf16 v[176:179], a[88:91], v[76:79], v[176:179]
    v_mfma_f32_16x16x32_bf16 v[180:183], a[92:95], v[76:79], v[180:183]
    s_waitcnt vmcnt(23)
    v_mfma_f32_16x16x32_bf16 v[176:179], a[96:99], v[80:83], v[176:179]
    v_mfma_f32_16x16x32_bf16 v[180:183], a[100:103], v[80:83], v[180:183]
    s_waitcnt vmcnt(22)
    v_mfma_f32_16x16x32_bf16 v[176:179], a[104:107], v[84:87], v[176:179]
    v_mfma_f32_16x16x32_bf16 v[180:183], a[108:111], v[84:87], v[180:183]
    s_waitcnt vmcnt(21)
    v_mfma_f32_16x16x32_bf16 v[176:179], a[112:115], v[88:91], v[176:179]
    v_mfma_f32_16x16x32_bf16 v[180:183], a[116:119], v[88:91], v[180:183]
    s_waitcnt vmcnt(20)
    v_mfma_f32_16x16x32_bf16 v[176:179], a[120:123], v[92:95], v[176:179]
    v_mfma_f32_16x16x32_bf16 v[180:183], a[124:127], v[92:95], v[180:183]
    s_waitcnt vmcnt(19)
    v_mfma_f32_16x16x32_bf16 v[176:179], a[128:131], v[96:99], v[176:179]
    v_mfma_f32_16x16x32_bf16 v[180:183], a[132:135], v[96:99], v[180:183]
    s_waitcnt vmcnt(18)
    v_mfma_f32_16x16x32_bf16 v[176:179], a[136:139], v[100:103], v[176:179]
    v_mfma_f32_16x16x32_bf16 v[180:183], a[140:143], v[100:103], v[180:183]
    s_waitcnt vmcnt(17)
    v_mfma_f32_16x16x32_bf16 v[176:179], a[144:147], v[104:107], v[176:179]
    v_mfma_f32_16x16x32_bf16 v[180:183], a[148:151], v[104:107], v[180:183]
    s_waitcnt vmcnt(16)
    v_mfma_f32_16x16x32_bf16 v[176:179], a[152:155], v[108:111], v[176:179]
    v_mfma_f32_16x16x32_bf16 v[180:183], a[156:159], v[108:111], v[180:183]
    s_waitcnt vmcnt(15)
    v_mfma_f32_16x16x32_bf16 v[176:179], a[160:163], v[112:115], v[176:179]
    v_mfma_f32_16x16x32_bf16 v[180:183], a[164:167], v[112:115], v[180:183]
    s_waitcnt vmcnt(14)
    v_mfma_f32_16x16x32_bf16 v[176:179], a[168:171], v[116:119], v[176:179]
    v_mfma_f32_16x16x32_bf16 v[180:183], a[172:175], v[116:119], v[180:183]
    s_waitcnt vmcnt(13)
    v_mfma_f32_16x16x32_bf16 v[176:179], a[176:179], v[120:123], v[176:179]
    v_mfma_f32_16x16x32_bf16 v[180:183], a[180:183], v[120:123], v[180:183]
    s_waitcnt vmcnt(12)
    v_mfma_f32_16x16x32_bf16 v[176:179], a[184:187], v[124:127], v[176:179]
    v_mfma_f32_16x16x32_bf16 v[180:183], a[188:191], v[124:127], v[180:183]
    s_waitcnt vmcnt(11)
    v_mfma_f32_16x16x32_bf16 v[176:179], a[192:195], v[128:131], v[176:179]
    v_mfma_f32_16x16x32_bf16 v[180:183], a[196:199], v[128:131], v[180:183]
    s_waitcnt vmcnt(10)
    v_mfma_f32_16x16x32_bf16 v[176:179], a[200:203], v[132:135], v[176:179]
    v_mfma_f32_16x16x32_bf16 v[180:183], a[204:207], v[132:135], v[180:183]
    s_waitcnt vmcnt(9)
    v_mfma_f32_16x16x32_bf16 v[176:179], a[208:211], v[136:139], v[176:179]
    v_mfma_f32_16x16x32_bf16 v[180:183], a[212:215], v[136:139], v[180:183]
    s_waitcnt vmcnt(8)
    v_mfma_f32_16x16x32_bf16 v[176:179], a[216:219], v[140:143], v[176:179]
    v_mfma_f32_16x16x32_bf16 v[180:183], a[220:223], v[140:143], v[180:183]
    s_waitcnt vmcnt(7)
    v_mfma_f32_16x16x32_bf16 v[176:179], a[224:227], v[144:147], v[176:179]
    v_mfma_f32_16x16x32_bf16 v[180:183], a[228:231], v[144:147], v[180:183]
    s_waitcnt vmcnt(6)
    v_mfma_f32_16x16x32_bf16 v[176:179], a[232:235], v[148:151], v[176:179]
    v_mfma_f32_16x16x32_bf16 v[180:183], a[236:239], v[148:151], v[180:183]
    s_waitcnt vmcnt(5)
    v_mfma_f32_16x16x32_bf16 v[176:179], a[240:243], v[152:155], v[176:179]
    v_mfma_f32_16x16x32_bf16 v[180:183], a[244:247], v[152:155], v[180:183]
    s_waitcnt vmcnt(4)
    v_mfma_f32_16x16x32_bf16 v[176:179], a[248:251], v[156:159], v[176:179]
    v_mfma_f32_16x16x32_bf16 v[180:183], a[252:255], v[156:159], v[180:183]
    s_waitcnt vmcnt(3)
    v_mfma_f32_16x16x32_bf16 v[176:179], v[224:227], v[160:163], v[176:179]
    v_mfma_f32_16x16x32_bf16 v[180:183], v[228:231], v[160:163], v[180:183]
    s_waitcnt vmcnt(2)
    v_mfma_f32_16x16x32_bf16 v[176:179], v[232:235], v[164:167], v[176:179]
    v_mfma_f32_16x16x32_bf16 v[180:183], v[236:239], v[164:167], v[180:183]
    s_waitcnt vmcnt(1)
    v_mfma_f32_16x16x32_bf16 v[176:179], v[240:243], v[168:171], v[176:179]
    v_mfma_f32_16x16x32_bf16 v[180:183], v[244:247], v[168:171], v[180:183]
    s_waitcnt vmcnt(0)
    v_mfma_f32_16x16x32_bf16 v[176:179], v[248:251], v[172:175], v[176:179]
    v_mfma_f32_16x16x32_bf16 v[180:183], v[252:255], v[172:175], v[180:183]
    s_nop 3
    ds_write_b128 v21, v[176:179]
    s_nop 2
    ds_write_b128 v21, v[180:183] offset:16
    s_waitcnt lgkmcnt(0)
    s_barrier
    s_cmp_lg_u32 s48, 0
    s_cbranch_scc1 g2sk_77
    ds_read_b128 v[184:187], v27 offset:2048
    ds_read_b128 v[188:191], v27 offset:2064
    ds_read_b128 v[192:195], v27 offset:4096
    ds_read_b128 v[196:199], v27 offset:4112
    ds_read_b128 v[200:203], v27 offset:6144
    ds_read_b128 v[204:207], v27 offset:6160
    s_waitcnt lgkmcnt(0)
    v_add_f32 v176, v176, v184
    v_add_f32 v192, v192, v200
    v_add_f32 v177, v177, v185
    v_add_f32 v193, v193, v201
    v_add_f32 v178, v178, v186
    v_add_f32 v194, v194, v202
    v_add_f32 v179, v179, v187
    v_add_f32 v195, v195, v203
    v_add_f32 v180, v180, v188
    v_add_f32 v196, v196, v204
    v_add_f32 v181, v181, v189
    v_add_f32 v197, v197, v205
    v_add_f32 v182, v182, v190
    v_add_f32 v198, v198, v206
    v_add_f32 v183, v183, v191
    v_add_f32 v199, v199, v207
    v_add_f32 v176, v176, v192
    v_add_f32 v177, v177, v193
    v_add_f32 v178, v178, v194
    v_add_f32 v179, v179, v195
    v_add_f32 v180, v180, v196
    v_add_f32 v181, v181, v197
    v_add_f32 v182, v182, v198
    v_add_f32 v183, v183, v199
    v_cvt_pk_bf16_f32 v184, v176, v177
    v_cvt_pk_bf16_f32 v185, v178, v179
    v_cvt_pk_bf16_f32 v186, v180, v181
    v_cvt_pk_bf16_f32 v187, v182, v183
    s_lshr_b32 s52, s50, 1
    s_lshl_b32 s52, s52, 15
    s_and_b32 s53, s50, 1
    s_lshl_b32 s53, s53, 12
    s_add_u32 s52, s52, s53
    buffer_store_dwordx4 v[184:187], v26, s[44:47], s52 offen
    s_nop 1
g2sk_77:
    s_add_u32 s50, s50, 7
    s_cmp_lt_u32 s50, 128
    s_cbranch_scc1 g2top_73
    s_branch L_end
L_notg2:
    s_barrier
    s_cmp_lg_u32 s48, 0
    s_cbranch_scc1 at_78
    v_mov_b32 v16, 0
    v_mov_b32 v17, 0
    s_mov_b64 exec, 1
    buffer_atomic_or v16, v17, s[40:43], 0 offen sc0
    s_waitcnt vmcnt(0)
    v_mov_b32 v17, 163328
    ds_write_b32 v17, v16
    s_mov_b64 exec, -1
    s_waitcnt lgkmcnt(0)
at_78:
    s_barrier
    v_mov_b32 v17, 163328
    ds_read_b32 v16, v17
    s_waitcnt lgkmcnt(0)
    v_readfirstlane_b32 s100, v16
    s_nop 0
    s_cmp_eq_u32 s100, -1
    s_nop 2
    s_cbranch_scc1 L_atb_go
    s_mov_b32 s51, s57
    s_branch L_claimloop
L_atb_go:
    s_lshl_b32 s52, s57, 2
    s_add_u32 s52, s52, s48
    s_and_b32 s49, s52, 31
    s_lshr_b32 s50, s52, 5
    s_mov_b32 s56, 0x3e0293ee
    s_mov_b32 s58, 0x3eb8aa3b
    s_mov_b32 s59, 0
    s_mov_b32 s72, 0
L_at_loop:
    s_cmp_lt_u32 s50, s59
    s_cbranch_scc1 arok_79
    v_mbcnt_lo_u32_b32 v16, -1, 0
    v_mbcnt_hi_u32_b32 v16, -1, v16
    v_lshrrev_b32 v17, 1, v16
    v_lshlrev_b32 v18, 6, v17
    v_and_b32 v17, 1, v16
    v_add_u32 v18, v18, v17
    s_lshl_b32 s52, s49, 1
    v_add_u32 v18, s52, v18
    v_lshlrev_b32 v17, 3, v16
    s_lshr_b32 s52, s49, 2
    s_add_u32 s52, s52, 144
    v_add_u32 v17, s52, v17
    v_cmp_lt_u32 vcc, 5, v16
    s_nop 1
    v_cndmask_b32 v18, v18, v17, vcc
    v_mov_b32 v17, 216
    v_cmp_lt_u32 vcc, 8, v16
    s_nop 1
    v_cndmask_b32 v18, v18, v17, vcc
    v_lshlrev_b32 v18, 4, v18
    s_nop 1
arlp_80:
    buffer_load_dwordx4 v[20:23], v18, s[28:31], 0 offen offset:0 sc1
    s_waitcnt vmcnt(0)
    v_lshlrev_b32 v20, 2, v20
    v_lshl_add_u32 v21, v21, 2, 1
    v_lshl_add_u32 v22, v22, 2, 2
    v_lshl_add_u32 v23, v23, 2, 3
    v_min3_u32 v20, v20, v21, v22
    v_min_u32 v20, v20, v23
    s_nop 1
    v_min_u32_dpp v20, v20, v20 row_ror:1 row_mask:0xf bank_mask:0xf
    s_nop 1
    v_min_u32_dpp v20, v20, v20 row_ror:2 row_mask:0xf bank_mask:0xf
    s_nop 1
    v_min_u32_dpp v20, v20, v20 row_ror:4 row_mask:0xf bank_mask:0xf
    s_nop 1
    v_min_u32_dpp v20, v20, v20 row_ror:8 row_mask:0xf bank_mask:0xf
    s_nop 0
    v_readfirstlane_b32 s59, v20
    s_nop 0
    s_cmp_lt_u32 s50, s59
    s_nop 2
    s_cbranch_scc1 arok_79
    s_sub_u32 s79, s79, 1
    s_cbranch_scc1 L_abort
    s_sleep 4
    s_branch arlp_80
arok_79:
    v_mbcnt_lo_u32_b32 v16, -1, 0
    v_mbcnt_hi_u32_b32 v16, -1, v16
    v_lshrrev_b32 v17, 5, v16
    v_and_b32 v18, 31, v16
    v_lshlrev_b32 v22, 4, v16
    v_mov_b32 v25, 0xff800000
    s_lshl_b32 s60, s49, 16
    s_lshl_b32 s52, s50, 10
    s_add_u32 s52, s52, s60
    s_add_u32 s52, s52, 88080384
    buffer_load_dwordx4 v[28:31], v22, s[28:31], s52 offen sc1
    v_and_b32 v19, 15, v16
    v_lshlrev_b32 v24, 4, v19
    v_lshl_add_u32 v24, v17, 8, v24
    s_add_i32 s52, s50, -8
    s_max_i32 s52, s52, 0
    s_lshl_b32 s52, s52, 10
    s_add_u32 s52, s52, s60
    s_add_u32 s53, s52, 90177536
    buffer_load_dwordx4 v[32:35], v22, s[28:31], s53 offen sc1
    s_add_u32 s53, s52, 92274688
    buffer_load_dwordx4 a[0:3], v24, s[28:31], s53 offen sc1
    buffer_load_dwordx4 a[4:7], v24, s[28:31], s53 offen offset:512 sc1
    s_add_i32 s52, s50, -7
    s_max_i32 s52, s52, 0
    s_lshl_b32 s52, s52, 10
    s_add_u32 s52, s52, s60
    s_add_u32 s53, s52, 90177536
    buffer_load_dwordx4 v[36:39], v22, s[28:31], s53 offen sc1
    s_add_u32 s53, s52, 92274688
    buffer_load_dwordx4 a[8:11], v24, s[28:31], s53 offen sc1
    buffer_load_dwordx4 a[12:15], v24, s[28:31], s53 offen offset:512 sc1
    s_add_i32 s52, s50, -6
    s_max_i32 s52, s52, 0
    s_lshl_b32 s52, s52, 10
    s_add_u32 s52, s52, s60
    s_add_u32 s53, s52, 90177536
    buffer_load_dwordx4 v[40:43], v22, s[28:31], s53 offen sc1
    s_add_u32 s53, s52, 92274688
    buffer_load_dwordx4 a[16:19], v24, s[28:31], s53 offen sc1
    buffer_load_dwordx4 a[20:23], v24, s[28:31], s53 offen offset:512 sc1
    s_add_i32 s52, s50, -5
    s_max_i32 s52, s52, 0
    s_lshl_b32 s52, s52, 10
    s_add_u32 s52, s52, s60
    s_add_u32 s53, s52, 90177536
    buffer_load_dwordx4 v[44:47], v22, s[28:31], s53 offen sc1
    s_add_u32 s53, s52, 92274688
    buffer_load_dwordx4 a[24:27], v24, s[28:31], s53 offen sc1
    buffer_load_dwordx4 a[28:31], v24, s[28:31], s53 offen offset:512 sc1
    s_add_i32 s52, s50, -4
    s_max_i32 s52, s52, 0
    s_lshl_b32 s52, s52, 10
    s_add_u32 s52, s52, s60
    s_add_u32 s53, s52, 90177536
    buffer_load_dwordx4 v[48:51], v22, s[28:31], s53 offen sc1
    s_add_u32 s53, s52, 92274688
    buffer_load_dwordx4 a[32:35], v24, s[28:31], s53 offen sc1
    buffer_load_dwordx4 a[36:39], v24, s[28:31], s53 offen offset:512 sc1
    s_add_i32 s52, s50, -3
    s_max_i32 s52, s52, 0
    s_lshl_b32 s52, s52, 10
    s_add_u32 s52, s52, s60
    s_add_u32 s53, s52, 90177536
    buffer_load_dwordx4 v[52:55], v22, s[28:31], s53 offen sc1
    s_add_u32 s53, s52, 92274688
    buffer_load_dwordx4 a[40:43], v24, s[28:31], s53 offen sc1
    buffer_load_dwordx4 a[44:47], v24, s[28:31], s53 offen offset:512 sc1
    s_add_i32 s52, s50, -2
    s_max_i32 s52, s52, 0
    s_lshl_b32 s52, s52, 10
    s_add_u32 s52, s52, s60
    s_add_u32 s53, s52, 90177536
    buffer_load_dwordx4 v[56:59], v22, s[28:31], s53 offen sc1
    s_add_u32 s53, s52, 92274688
    buffer_load_dwordx4 a[48:51], v24, s[28:31], s53 offen sc1
    buffer_load_dwordx4 a[52:55], v24, s[28:31], s53 offen offset:512 sc1
    s_add_i32 s52, s50, -1
    s_max_i32 s52, s52, 0
    s_lshl_b32 s52, s52, 10
    s_add_u32 s52, s52, s60
    s_add_u32 s53, s52, 90177536
    buffer_load_dwordx4 v[60:63], v22, s[28:31], s53 offen sc1
    s_add_u32 s53, s52, 92274688
    buffer_load_dwordx4 a[56:59], v24, s[28:31], s53 offen sc1
    buffer_load_dwordx4 a[60:63], v24, s[28:31], s53 offen offset:512 sc1
    s_add_i32 s52, s50, 0
    s_max_i32 s52, s52, 0
    s_lshl_b32 s52, s52, 10
    s_add_u32 s52, s52, s60
    s_add_u32 s53, s52, 90177536
    buffer_load_dwordx4 v[64:67], v22, s[28:31], s53 offen sc1
    s_add_u32 s53, s52, 92274688
    buffer_load_dwordx4 a[64:67], v24, s[28:31], s53 offen sc1
    buffer_load_dwordx4 a[68:71], v24, s[28:31], s53 offen offset:512 sc1
    v_lshrrev_b32 v19, 3, v18
    v_lshlrev_b32 v20, 5, v19
    v_and_b32 v19, 3, v18
    v_lshl_add_u32 v20, v19, 3, v20
    v_and_b32 v19, 4, v18
    v_add_u32 v21, v20, v19
    s_lshl_b32 s52, s50, 7
    s_add_u32 s52, s52, 655360
    buffer_load_dword v23, v21, s[28:31], s52 offen sc1
    v_lshlrev_b32 v20, 1, v20
    v_lshl_add_u32 v20, v17, 8, v20
    v_lshrrev_b32 v19, 2, v19
    s_mov_b32 s52, 147456
    v_mul_lo_u32 v19, v19, s52
    v_add_u32 v20, v20, v19
    s_waitcnt vmcnt(0)
    v_mfma_f32_32x32x16_bf16 v[68:83], v[32:35], v[28:31], 0
    v_mfma_f32_32x32x16_bf16 v[84:99], v[36:39], v[28:31], 0
    v_mfma_f32_32x32x16_bf16 v[100:115], v[40:43], v[28:31], 0
    v_mfma_f32_32x32x16_bf16 v[116:131], v[44:47], v[28:31], 0
    v_mfma_f32_32x32x16_bf16 v[132:147], v[48:51], v[28:31], 0
    v_mfma_f32_32x32x16_bf16 v[148:163], v[52:55], v[28:31], 0
    v_mfma_f32_32x32x16_bf16 v[164:179], v[56:59], v[28:31], 0
    v_mfma_f32_32x32x16_bf16 v[180:195], v[60:63], v[28:31], 0
    v_mfma_f32_32x32x16_bf16 v[196:211], v[64:67], v[28:31], 0
    v_lshlrev_b32 v19, 3, v17
    v_sub_u32 v19, v18, v19
    v_cmp_gt_i32 vcc, 0, v19
    s_nop 1
    v_cndmask_b32 v68, v25, v68, vcc
    s_nop 5
    v_cndmask_b32 v196, v196, v25, vcc
    v_cmp_gt_i32 vcc, 1, v19
    s_nop 1
    v_cndmask_b32 v69, v25, v69, vcc
    v_cndmask_b32 v197, v197, v25, vcc
    v_cmp_gt_i32 vcc, 2, v19
    s_nop 1
    v_cndmask_b32 v70, v25, v70, vcc
    v_cndmask_b32 v198, v198, v25, vcc
    v_cmp_gt_i32 vcc, 3, v19
    s_nop 1
    v_cndmask_b32 v71, v25, v71, vcc
    v_cndmask_b32 v199, v199, v25, vcc
    v_cmp_gt_i32 vcc, 4, v19
    s_nop 1
    v_cndmask_b32 v72, v25, v72, vcc
    v_cndmask_b32 v200, v200, v25, vcc
    v_cmp_gt_i32 vcc, 5, v19
    s_nop 1
    v_cndmask_b32 v73, v25, v73, vcc
    v_cndmask_b32 v201, v201, v25, vcc
    v_cmp_gt_i32 vcc, 6, v19
    s_nop 1
    v_cndmask_b32 v74, v25, v74, vcc
    v_cndmask_b32 v202, v202, v25, vcc
    v_cmp_gt_i32 vcc, 7, v19
    s_nop 1
    v_cndmask_b32 v75, v25, v75, vcc
    v_cndmask_b32 v203, v203, v25, vcc
    v_cmp_gt_i32 vcc, 16, v19
    s_nop 1
    v_cndmask_b32 v76, v25, v76, vcc
    v_cndmask_b32 v204, v204, v25, vcc
    v_cmp_gt_i32 vcc, 17, v19
    s_nop 1
    v_cndmask_b32 v77, v25, v77, vcc
    v_cndmask_b32 v205, v205, v25, vcc
    v_cmp_gt_i32 vcc, 18, v19
    s_nop 1
    v_cndmask_b32 v78, v25, v78, vcc
    v_cndmask_b32 v206, v206, v25, vcc
    v_cmp_gt_i32 vcc, 19, v19
    s_nop 1
    v_cndmask_b32 v79, v25, v79, vcc
    v_cndmask_b32 v207, v207, v25, vcc
    v_cmp_gt_i32 vcc, 20, v19
    s_nop 1
    v_cndmask_b32 v80, v25, v80, vcc
    v_cndmask_b32 v208, v208, v25, vcc
    v_cmp_gt_i32 vcc, 21, v19
    s_nop 1
    v_cndmask_b32 v81, v25, v81, vcc
    v_cndmask_b32 v209, v209, v25, vcc
    v_cmp_gt_i32 vcc, 22, v19
    s_nop 1
    v_cndmask_b32 v82, v25, v82, vcc
    v_cndmask_b32 v210, v210, v25, vcc
    v_cmp_gt_i32 vcc, 23, v19
    s_nop 1
    v_cndmask_b32 v83, v25, v83, vcc
    v_cndmask_b32 v211, v211, v25, vcc
    s_cmp_ge_u32 s50, 8
    s_nop 0
    s_cbranch_scc1 am_81
    v_mov_b32 v68, v25
    v_mov_b32 v69, v25
    v_mov_b32 v70, v25
    v_mov_b32 v71, v25
    v_mov_b32 v72, v25
    v_mov_b32 v73, v25
    v_mov_b32 v74, v25
    v_mov_b32 v75, v25
    v_mov_b32 v76, v25
    v_mov_b32 v77, v25
    v_mov_b32 v78, v25
    v_mov_b32 v79, v25
    v_mov_b32 v80, v25
    v_mov_b32 v81, v25
    v_mov_b32 v82, v25
    v_mov_b32 v83, v25
    s_nop 1
am_81:
    s_cmp_ge_u32 s50, 7
    s_cbranch_scc1 am_82
    v_mov_b32 v84, v25
    v_mov_b32 v85, v25
    v_mov_b32 v86, v25
    v_mov_b32 v87, v25
    v_mov_b32 v88, v25
    v_mov_b32 v89, v25
    v_mov_b32 v90, v25
    v_mov_b32 v91, v25
    v_mov_b32 v92, v25
    v_mov_b32 v93, v25
    v_mov_b32 v94, v25
    v_mov_b32 v95, v25
    v_mov_b32 v96, v25
    v_mov_b32 v97, v25
    v_mov_b32 v98, v25
    v_mov_b32 v99, v25
    s_nop 1
am_82:
    s_cmp_ge_u32 s50, 6
    s_cbranch_scc1 am_83
    v_mov_b32 v100, v25
    v_mov_b32 v101, v25
    v_mov_b32 v102, v25
    v_mov_b32 v103, v25
    v_mov_b32 v104, v25
    v_mov_b32 v105, v25
    v_mov_b32 v106, v25
    v_mov_b32 v107, v25
    v_mov_b32 v108, v25
    v_mov_b32 v109, v25
    v_mov_b32 v110, v25
    v_mov_b32 v111, v25
    v_mov_b32 v112, v25
    v_mov_b32 v113, v25
    v_mov_b32 v114, v25
    v_mov_b32 v115, v25
    s_nop 1
am_83:
    s_cmp_ge_u32 s50, 5
    s_cbranch_scc1 am_84
    v_mov_b32 v116, v25
    v_mov_b32 v117, v25
    v_mov_b32 v118, v25
    v_mov_b32 v119, v25
    v_mov_b32 v120, v25
    v_mov_b32 v121, v25
    v_mov_b32 v122, v25
    v_mov_b32 v123, v25
    v_mov_b32 v124, v25
    v_mov_b32 v125, v25
    v_mov_b32 v126, v25
    v_mov_b32 v127, v25
    v_mov_b32 v128, v25
    v_mov_b32 v129, v25
    v_mov_b32 v130, v25
    v_mov_b32 v131, v25
    s_nop 1
am_84:
    s_cmp_ge_u32 s50, 4
    s_cbranch_scc1 am_85
    v_mov_b32 v132, v25
    v_mov_b32 v133, v25
    v_mov_b32 v134, v25
    v_mov_b32 v135, v25
    v_mov_b32 v136, v25
    v_mov_b32 v137, v25
    v_mov_b32 v138, v25
    v_mov_b32 v139, v25
    v_mov_b32 v140, v25
    v_mov_b32 v141, v25
    v_mov_b32 v142, v25
    v_mov_b32 v143, v25
    v_mov_b32 v144, v25
    v_mov_b32 v145, v25
    v_mov_b32 v146, v25
    v_mov_b32 v147, v25
    s_nop 1
am_85:
    s_cmp_ge_u32 s50, 3
    s_cbranch_scc1 am_86
    v_mov_b32 v148, v25
    v_mov_b32 v149, v25
    v_mov_b32 v150, v25
    v_mov_b32 v151, v25
    v_mov_b32 v152, v25
    v_mov_b32 v153, v25
    v_mov_b32 v154, v25
    v_mov_b32 v155, v25
    v_mov_b32 v156, v25
    v_mov_b32 v157, v25
    v_mov_b32 v158, v25
    v_mov_b32 v159, v25
    v_mov_b32 v160, v25
    v_mov_b32 v161, v25
    v_mov_b32 v162, v25
    v_mov_b32 v163, v25
    s_nop 1
am_86:
    s_cmp_ge_u32 s50, 2
    s_cbranch_scc1 am_87
    v_mov_b32 v164, v25
    v_mov_b32 v165, v25
    v_mov_b32 v166, v25
    v_mov_b32 v167, v25
    v_mov_b32 v168, v25
    v_mov_b32 v169, v25
    v_mov_b32 v170, v25
    v_mov_b32 v171, v25
    v_mov_b32 v172, v25
    v_mov_b32 v173, v25
    v_mov_b32 v174, v25
    v_mov_b32 v175, v25
    v_mov_b32 v176, v25
    v_mov_b32 v177, v25
    v_mov_b32 v178, v25
    v_mov_b32 v179, v25
    s_nop 1
am_87:
    s_cmp_ge_u32 s50, 1
    s_cbranch_scc1 am_88
    v_mov_b32 v180, v25
    v_mov_b32 v181, v25
    v_mov_b32 v182, v25
    v_mov_b32 v183, v25
    v_mov_b32 v184, v25
    v_mov_b32 v185, v25
    v_mov_b32 v186, v25
    v_mov_b32 v187, v25
    v_mov_b32 v188, v25
    v_mov_b32 v189, v25
    v_mov_b32 v190, v25
    v_mov_b32 v191, v25
    v_mov_b32 v192, v25
    v_mov_b32 v193, v25
    v_mov_b32 v194, v25
    v_mov_b32 v195, v25
    s_nop 1
am_88:
    v_max3_f32 v236, v68, v69, v70
    v_max3_f32 v236, v236, v71, v72
    v_max3_f32 v236, v236, v73, v74
    v_max3_f32 v236, v236, v75, v76
    v_max3_f32 v236, v236, v77, v78
    v_max3_f32 v236, v236, v79, v80
    v_max3_f32 v236, v236, v81, v82
    v_max3_f32 v236, v236, v83, v84
    v_max3_f32 v236, v236, v85, v86
    v_max3_f32 v236, v236, v87, v88
    v_max3_f32 v236, v236, v89, v90
    v_max3_f32 v236, v236, v91, v92
    v_max3_f32 v236, v236, v93, v94
    v_max3_f32 v236, v236, v95, v96
    v_max3_f32 v236, v236, v97, v98
    v_max3_f32 v236, v236, v99, v100
    v_max3_f32 v236, v236, v101, v102
    v_max3_f32 v236, v236, v103, v104
    v_max3_f32 v236, v236, v105, v106
    v_max3_f32 v236, v236, v107, v108
    v_max3_f32 v236, v236, v109, v110
    v_max3_f32 v236, v236, v111, v112
    v_max3_f32 v236, v236, v113, v114
    v_max3_f32 v236, v236, v115, v116
    v_max3_f32 v236, v236, v117, v118
    v_max3_f32 v236, v236, v119, v120
    v_max3_f32 v236, v236, v121, v122
    v_max3_f32 v236, v236, v123, v124
    v_max3_f32 v236, v236, v125, v126
    v_max3_f32 v236, v236, v127, v128
    v_max3_f32 v236, v236, v129, v130
    v_max3_f32 v236, v236, v131, v132
    v_max3_f32 v236, v236, v133, v134
    v_max3_f32 v236, v236, v135, v136
    v_max3_f32 v236, v236, v137, v138
    v_max3_f32 v236, v236, v139, v140
    v_max3_f32 v236, v236, v141, v142
    v_max3_f32 v236, v236, v143, v144
    v_max3_f32 v236, v236, v145, v146
    v_max3_f32 v236, v236, v147, v148
    v_max3_f32 v236, v236, v149, v150
    v_max3_f32 v236, v236, v151, v152
    v_max3_f32 v236, v236, v153, v154
    v_max3_f32 v236, v236, v155, v156
    v_max3_f32 v236, v236, v157, v158
    v_max3_f32 v236, v236, v159, v160
    v_max3_f32 v236, v236, v161, v162
    v_max3_f32 v236, v236, v163, v164
    v_max3_f32 v236, v236, v165, v166
    v_max3_f32 v236, v236, v167, v168
    v_max3_f32 v236, v236, v169, v170
    v_max3_f32 v236, v236, v171, v172
    v_max3_f32 v236, v236, v173, v174
    v_max3_f32 v236, v236, v175, v176
    v_max3_f32 v236, v236, v177, v178
    v_max3_f32 v236, v236, v179, v180
    v_max3_f32 v236, v236, v181, v182
    v_max3_f32 v236, v236, v183, v184
    v_max3_f32 v236, v236, v185, v186
    v_max3_f32 v236, v236, v187, v188
    v_max3_f32 v236, v236, v189, v190
    v_max3_f32 v236, v236, v191, v192
    v_max3_f32 v236, v236, v193, v194
    v_max3_f32 v236, v236, v195, v196
    v_max3_f32 v236, v236, v197, v198
    v_max3_f32 v236, v236, v199, v200
    v_max3_f32 v236, v236, v201, v202
    v_max3_f32 v236, v236, v203, v204
    v_max3_f32 v236, v236, v205, v206
    v_max3_f32 v236, v236, v207, v208
    v_max3_f32 v236, v236, v209, v210
    v_max_f32 v236, v236, v211
    v_mov_b32 v237, v236
    s_nop 1
    v_permlane32_swap_b32 v237, v236
    v_max_f32 v236, v236, v237
    v_mul_f32 v236, s58, v236
    s_mov_b32 s52, 0xffff0000
    s_mov_b32 s53, 0xffff0000
    v_mov_b32 v19, 0x3f803f80
    s_mov_b64 exec, s[52:53]
    v_accvgpr_write_b32 a0, v19
    v_accvgpr_write_b32 a1, v19
    v_accvgpr_write_b32 a2, v19
    v_accvgpr_write_b32 a3, v19
    v_accvgpr_write_b32 a4, v19
    v_accvgpr_write_b32 a5, v19
    v_accvgpr_write_b32 a6, v19
    v_accvgpr_write_b32 a7, v19
    v_accvgpr_write_b32 a8, v19
    v_accvgpr_write_b32 a9, v19
    v_accvgpr_write_b32 a10, v19
    v_accvgpr_write_b32 a11, v19
    v_accvgpr_write_b32 a12, v19
    v_accvgpr_write_b32 a13, v19
    v_accvgpr_write_b32 a14, v19
    v_accvgpr_write_b32 a15, v19
    v_accvgpr_write_b32 a16, v19
    v_accvgpr_write_b32 a17, v19
    v_accvgpr_write_b32 a18, v19
    v_accvgpr_write_b32 a19, v19
    v_accvgpr_write_b32 a20, v19
    v_accvgpr_write_b32 a21, v19
    v_accvgpr_write_b32 a22, v19
    v_accvgpr_write_b32 a23, v19
    v_accvgpr_write_b32 a24, v19
    v_accvgpr_write_b32 a25, v19
    v_accvgpr_write_b32 a26, v19
    v_accvgpr_write_b32 a27, v19
    v_accvgpr_write_b32 a28, v19
    v_accvgpr_write_b32 a29, v19
    v_accvgpr_write_b32 a30, v19
    v_accvgpr_write_b32 a31, v19
    v_accvgpr_write_b32 a32, v19
    v_accvgpr_write_b32 a33, v19
    v_accvgpr_write_b32 a34, v19
    v_accvgpr_write_b32 a35, v19
    v_accvgpr_write_b32 a36, v19
    v_accvgpr_write_b32 a37, v19
    v_accvgpr_write_b32 a38, v19
    v_accvgpr_write_b32 a39, v19
    v_accvgpr_write_b32 a40, v19
    v_accvgpr_write_b32 a41, v19
    v_accvgpr_write_b32 a42, v19
    v_accvgpr_write_b32 a43, v19
    v_accvgpr_write_b32 a44, v19
    v_accvgpr_write_b32 a45, v19
    v_accvgpr_write_b32 a46, v19
    v_accvgpr_write_b32 a47, v19
    v_accvgpr_write_b32 a48, v19
    v_accvgpr_write_b32 a49, v19
    v_accvgpr_write_b32 a50, v19
    v_accvgpr_write_b32 a51, v19
    v_accvgpr_write_b32 a52, v19
    v_accvgpr_write_b32 a53, v19
    v_accvgpr_write_b32 a54, v19
    v_accvgpr_write_b32 a55, v19
    v_accvgpr_write_b32 a56, v19
    v_accvgpr_write_b32 a57, v19
    v_accvgpr_write_b32 a58, v19
    v_accvgpr_write_b32 a59, v19
    v_accvgpr_write_b32 a60, v19
    v_accvgpr_write_b32 a61, v19
    v_accvgpr_write_b32 a62, v19
    v_accvgpr_write_b32 a63, v19
    v_accvgpr_write_b32 a64, v19
    v_accvgpr_write_b32 a65, v19
    v_accvgpr_write_b32 a66, v19
    v_accvgpr_write_b32 a67, v19
    v_accvgpr_write_b32 a68, v19
    v_accvgpr_write_b32 a69, v19
    v_accvgpr_write_b32 a70, v19
    v_accvgpr_write_b32 a71, v19
    s_mov_b64 exec, -1
    v_fma_f32 v68, v68, s58, -v236
    v_fma_f32 v69, v69, s58, -v236
    v_fma_f32 v70, v70, s58, -v236
    v_fma_f32 v71, v71, s58, -v236
    v_fma_f32 v72, v72, s58, -v236
    v_fma_f32 v73, v73, s58, -v236
    v_fma_f32 v74, v74, s58, -v236
    v_fma_f32 v75, v75, s58, -v236
    v_fma_f32 v76, v76, s58, -v236
    v_fma_f32 v77, v77, s58, -v236
    v_fma_f32 v78, v78, s58, -v236
    v_fma_f32 v79, v79, s58, -v236
    v_fma_f32 v80, v80, s58, -v236
    v_fma_f32 v81, v81, s58, -v236
    v_fma_f32 v82, v82, s58, -v236
    v_fma_f32 v83, v83, s58, -v236
    v_exp_f32 v68, v68
    v_exp_f32 v69, v69
    v_exp_f32 v70, v70
    v_exp_f32 v71, v71
    v_exp_f32 v72, v72
    v_exp_f32 v73, v73
    v_exp_f32 v74, v74
    v_exp_f32 v75, v75
    v_exp_f32 v76, v76
    v_exp_f32 v77, v77
    v_exp_f32 v78, v78
    v_exp_f32 v79, v79
    v_exp_f32 v80, v80
    v_exp_f32 v81, v81
    v_exp_f32 v82, v82
    v_exp_f32 v83, v83
    v_cvt_pk_bf16_f32 v68, v68, v69
    v_cvt_pk_bf16_f32 v69, v70, v71
    v_cvt_pk_bf16_f32 v70, v72, v73
    v_cvt_pk_bf16_f32 v71, v74, v75
    v_cvt_pk_bf16_f32 v72, v76, v77
    v_cvt_pk_bf16_f32 v73, v78, v79
    v_cvt_pk_bf16_f32 v74, v80, v81
    v_cvt_pk_bf16_f32 v75, v82, v83
    v_mfma_f32_32x32x16_bf16 v[212:227], a[0:3], v[68:71], 0
    v_mfma_f32_32x32x16_bf16 v[212:227], a[4:7], v[72:75], v[212:227]
    v_fma_f32 v84, v84, s58, -v236
    v_fma_f32 v85, v85, s58, -v236
    v_fma_f32 v86, v86, s58, -v236
    v_fma_f32 v87, v87, s58, -v236
    v_fma_f32 v88, v88, s58, -v236
    v_fma_f32 v89, v89, s58, -v236
    v_fma_f32 v90, v90, s58, -v236
    v_fma_f32 v91, v91, s58, -v236
    v_fma_f32 v92, v92, s58, -v236
    v_fma_f32 v93, v93, s58, -v236
    v_fma_f32 v94, v94, s58, -v236
    v_fma_f32 v95, v95, s58, -v236
    v_fma_f32 v96, v96, s58, -v236
    v_fma_f32 v97, v97, s58, -v236
    v_fma_f32 v98, v98, s58, -v236
    v_fma_f32 v99, v99, s58, -v236
    v_exp_f32 v84, v84
    v_exp_f32 v85, v85
    v_exp_f32 v86, v86
    v_exp_f32 v87, v87
    v_exp_f32 v88, v88
    v_exp_f32 v89, v89
    v_exp_f32 v90, v90
    v_exp_f32 v91, v91
    v_exp_f32 v92, v92
    v_exp_f32 v93, v93
    v_exp_f32 v94, v94
    v_exp_f32 v95, v95
    v_exp_f32 v96, v96
    v_exp_f32 v97, v97
    v_exp_f32 v98, v98
    v_exp_f32 v99, v99
    v_cvt_pk_bf16_f32 v84, v84, v85
    v_cvt_pk_bf16_f32 v85, v86, v87
    v_cvt_pk_bf16_f32 v86, v88, v89
    v_cvt_pk_bf16_f32 v87, v90, v91
    v_cvt_pk_bf16_f32 v88, v92, v93
    v_cvt_pk_bf16_f32 v89, v94, v95
    v_cvt_pk_bf16_f32 v90, v96, v97
    v_cvt_pk_bf16_f32 v91, v98, v99
    v_mfma_f32_32x32x16_bf16 v[212:227], a[8:11], v[84:87], v[212:227]
    v_mfma_f32_32x32x16_bf16 v[212:227], a[12:15], v[88:91], v[212:227]
    v_fma_f32 v100, v100, s58, -v236
    v_fma_f32 v101, v101, s58, -v236
    v_fma_f32 v102, v102, s58, -v236
    v_fma_f32 v103, v103, s58, -v236
    v_fma_f32 v104, v104, s58, -v236
    v_fma_f32 v105, v105, s58, -v236
    v_fma_f32 v106, v106, s58, -v236
    v_fma_f32 v107, v107, s58, -v236
    v_fma_f32 v108, v108, s58, -v236
    v_fma_f32 v109, v109, s58, -v236
    v_fma_f32 v110, v110, s58, -v236
    v_fma_f32 v111, v111, s58, -v236
    v_fma_f32 v112, v112, s58, -v236
    v_fma_f32 v113, v113, s58, -v236
    v_fma_f32 v114, v114, s58, -v236
    v_fma_f32 v115, v115, s58, -v236
    v_exp_f32 v100, v100
    v_exp_f32 v101, v101
    v_exp_f32 v102, v102
    v_exp_f32 v103, v103
    v_exp_f32 v104, v104
    v_exp_f32 v105, v105
    v_exp_f32 v106, v106
    v_exp_f32 v107, v107
    v_exp_f32 v108, v108
    v_exp_f32 v109, v109
    v_exp_f32 v110, v110
    v_exp_f32 v111, v111
    v_exp_f32 v112, v112
    v_exp_f32 v113, v113
    v_exp_f32 v114, v114
    v_exp_f32 v115, v115
    v_cvt_pk_bf16_f32 v100, v100, v101
    v_cvt_pk_bf16_f32 v101, v102, v103
    v_cvt_pk_bf16_f32 v102, v104, v105
    v_cvt_pk_bf16_f32 v103, v106, v107
    v_cvt_pk_bf16_f32 v104, v108, v109
    v_cvt_pk_bf16_f32 v105, v110, v111
    v_cvt_pk_bf16_f32 v106, v112, v113
    v_cvt_pk_bf16_f32 v107, v114, v115
    v_mfma_f32_32x32x16_bf16 v[212:227], a[16:19], v[100:103], v[212:227]
    v_mfma_f32_32x32x16_bf16 v[212:227], a[20:23], v[104:107], v[212:227]
    v_fma_f32 v116, v116, s58, -v236
    v_fma_f32 v117, v117, s58, -v236
    v_fma_f32 v118, v118, s58, -v236
    v_fma_f32 v119, v119, s58, -v236
    v_fma_f32 v120, v120, s58, -v236
    v_fma_f32 v121, v121, s58, -v236
    v_fma_f32 v122, v122, s58, -v236
    v_fma_f32 v123, v123, s58, -v236
    v_fma_f32 v124, v124, s58, -v236
    v_fma_f32 v125, v125, s58, -v236
    v_fma_f32 v126, v126, s58, -v236
    v_fma_f32 v127, v127, s58, -v236
    v_fma_f32 v128, v128, s58, -v236
    v_fma_f32 v129, v129, s58, -v236
    v_fma_f32 v130, v130, s58, -v236
    v_fma_f32 v131, v131, s58, -v236
    v_exp_f32 v116, v116
    v_exp_f32 v117, v117
    v_exp_f32 v118, v118
    v_exp_f32 v119, v119
    v_exp_f32 v120, v120
    v_exp_f32 v121, v121
    v_exp_f32 v122, v122
    v_exp_f32 v123, v123
    v_exp_f32 v124, v124
    v_exp_f32 v125, v125
    v_exp_f32 v126, v126
    v_exp_f32 v127, v127
    v_exp_f32 v128, v128
    v_exp_f32 v129, v129
    v_exp_f32 v130, v130
    v_exp_f32 v131, v131
    v_cvt_pk_bf16_f32 v116, v116, v117
    v_cvt_pk_bf16_f32 v117, v118, v119
    v_cvt_pk_bf16_f32 v118, v120, v121
    v_cvt_pk_bf16_f32 v119, v122, v123
    v_cvt_pk_bf16_f32 v120, v124, v125
    v_cvt_pk_bf16_f32 v121, v126, v127
    v_cvt_pk_bf16_f32 v122, v128, v129
    v_cvt_pk_bf16_f32 v123, v130, v131
    v_mfma_f32_32x32x16_bf16 v[212:227], a[24:27], v[116:119], v[212:227]
    v_mfma_f32_32x32x16_bf16 v[212:227], a[28:31], v[120:123], v[212:227]
    v_fma_f32 v132, v132, s58, -v236
    v_fma_f32 v133, v133, s58, -v236
    v_fma_f32 v134, v134, s58, -v236
    v_fma_f32 v135, v135, s58, -v236
    v_fma_f32 v136, v136, s58, -v236
    v_fma_f32 v137, v137, s58, -v236
    v_fma_f32 v138, v138, s58, -v236
    v_fma_f32 v139, v139, s58, -v236
    v_fma_f32 v140, v140, s58, -v236
    v_fma_f32 v141, v141, s58, -v236
    v_fma_f32 v142, v142, s58, -v236
    v_fma_f32 v143, v143, s58, -v236
    v_fma_f32 v144, v144, s58, -v236
    v_fma_f32 v145, v145, s58, -v236
    v_fma_f32 v146, v146, s58, -v236
    v_fma_f32 v147, v147, s58, -v236
    v_exp_f32 v132, v132
    v_exp_f32 v133, v133
    v_exp_f32 v134, v134
    v_exp_f32 v135, v135
    v_exp_f32 v136, v136
    v_exp_f32 v137, v137
    v_exp_f32 v138, v138
    v_exp_f32 v139, v139
    v_exp_f32 v140, v140
    v_exp_f32 v141, v141
    v_exp_f32 v142, v142
    v_exp_f32 v143, v143
    v_exp_f32 v144, v144
    v_exp_f32 v145, v145
    v_exp_f32 v146, v146
    v_exp_f32 v147, v147
    v_cvt_pk_bf16_f32 v132, v132, v133
    v_cvt_pk_bf16_f32 v133, v134, v135
    v_cvt_pk_bf16_f32 v134, v136, v137
    v_cvt_pk_bf16_f32 v135, v138, v139
    v_cvt_pk_bf16_f32 v136, v140, v141
    v_cvt_pk_bf16_f32 v137, v142, v143
    v_cvt_pk_bf16_f32 v138, v144, v145
    v_cvt_pk_bf16_f32 v139, v146, v147
    v_mfma_f32_32x32x16_bf16 v[212:227], a[32:35], v[132:135], v[212:227]
    v_mfma_f32_32x32x16_bf16 v[212:227], a[36:39], v[136:139], v[212:227]
    v_fma_f32 v148, v148, s58, -v236
    v_fma_f32 v149, v149, s58, -v236
    v_fma_f32 v150, v150, s58, -v236
    v_fma_f32 v151, v151, s58, -v236
    v_fma_f32 v152, v152, s58, -v236
    v_fma_f32 v153, v153, s58, -v236
    v_fma_f32 v154, v154, s58, -v236
    v_fma_f32 v155, v155, s58, -v236
    v_fma_f32 v156, v156, s58, -v236
    v_fma_f32 v157, v157, s58, -v236
    v_fma_f32 v158, v158, s58, -v236
    v_fma_f32 v159, v159, s58, -v236
    v_fma_f32 v160, v160, s58, -v236
    v_fma_f32 v161, v161, s58, -v236
    v_fma_f32 v162, v162, s58, -v236
    v_fma_f32 v163, v163, s58, -v236
    v_exp_f32 v148, v148
    v_exp_f32 v149, v149
    v_exp_f32 v150, v150
    v_exp_f32 v151, v151
    v_exp_f32 v152, v152
    v_exp_f32 v153, v153
    v_exp_f32 v154, v154
    v_exp_f32 v155, v155
    v_exp_f32 v156, v156
    v_exp_f32 v157, v157
    v_exp_f32 v158, v158
    v_exp_f32 v159, v159
    v_exp_f32 v160, v160
    v_exp_f32 v161, v161
    v_exp_f32 v162, v162
    v_exp_f32 v163, v163
    v_cvt_pk_bf16_f32 v148, v148, v149
    v_cvt_pk_bf16_f32 v149, v150, v151
    v_cvt_pk_bf16_f32 v150, v152, v153
    v_cvt_pk_bf16_f32 v151, v154, v155
    v_cvt_pk_bf16_f32 v152, v156, v157
    v_cvt_pk_bf16_f32 v153, v158, v159
    v_cvt_pk_bf16_f32 v154, v160, v161
    v_cvt_pk_bf16_f32 v155, v162, v163
    v_mfma_f32_32x32x16_bf16 v[212:227], a[40:43], v[148:151], v[212:227]
    v_mfma_f32_32x32x16_bf16 v[212:227], a[44:47], v[152:155], v[212:227]
    v_fma_f32 v164, v164, s58, -v236
    v_fma_f32 v165, v165, s58, -v236
    v_fma_f32 v166, v166, s58, -v236
    v_fma_f32 v167, v167, s58, -v236
    v_fma_f32 v168, v168, s58, -v236
    v_fma_f32 v169, v169, s58, -v236
    v_fma_f32 v170, v170, s58, -v236
    v_fma_f32 v171, v171, s58, -v236
    v_fma_f32 v172, v172, s58, -v236
    v_fma_f32 v173, v173, s58, -v236
    v_fma_f32 v174, v174, s58, -v236
    v_fma_f32 v175, v175, s58, -v236
    v_fma_f32 v176, v176, s58, -v236
    v_fma_f32 v177, v177, s58, -v236
    v_fma_f32 v178, v178, s58, -v236
    v_fma_f32 v179, v179, s58, -v236
    v_exp_f32 v164, v164
    v_exp_f32 v165, v165
    v_exp_f32 v166, v166
    v_exp_f32 v167, v167
    v_exp_f32 v168, v168
    v_exp_f32 v169, v169
    v_exp_f32 v170, v170
    v_exp_f32 v171, v171
    v_exp_f32 v172, v172
    v_exp_f32 v173, v173
    v_exp_f32 v174, v174
    v_exp_f32 v175, v175
    v_exp_f32 v176, v176
    v_exp_f32 v177, v177
    v_exp_f32 v178, v178
    v_exp_f32 v179, v179
    v_cvt_pk_bf16_f32 v164, v164, v165
    v_cvt_pk_bf16_f32 v165, v166, v167
    v_cvt_pk_bf16_f32 v166, v168, v169
    v_cvt_pk_bf16_f32 v167, v170, v171
    v_cvt_pk_bf16_f32 v168, v172, v173
    v_cvt_pk_bf16_f32 v169, v174, v175
    v_cvt_pk_bf16_f32 v170, v176, v177
    v_cvt_pk_bf16_f32 v171, v178, v179
    v_mfma_f32_32x32x16_bf16 v[212:227], a[48:51], v[164:167], v[212:227]
    v_mfma_f32_32x32x16_bf16 v[212:227], a[52:55], v[168:171], v[212:227]
    v_fma_f32 v180, v180, s58, -v236
    v_fma_f32 v181, v181, s58, -v236
    v_fma_f32 v182, v182, s58, -v236
    v_fma_f32 v183, v183, s58, -v236
    v_fma_f32 v184, v184, s58, -v236
    v_fma_f32 v185, v185, s58, -v236
    v_fma_f32 v186, v186, s58, -v236
    v_fma_f32 v187, v187, s58, -v236
    v_fma_f32 v188, v188, s58, -v236
    v_fma_f32 v189, v189, s58, -v236
    v_fma_f32 v190, v190, s58, -v236
    v_fma_f32 v191, v191, s58, -v236
    v_fma_f32 v192, v192, s58, -v236
    v_fma_f32 v193, v193, s58, -v236
    v_fma_f32 v194, v194, s58, -v236
    v_fma_f32 v195, v195, s58, -v236
    v_exp_f32 v180, v180
    v_exp_f32 v181, v181
    v_exp_f32 v182, v182
    v_exp_f32 v183, v183
    v_exp_f32 v184, v184
    v_exp_f32 v185, v185
    v_exp_f32 v186, v186
    v_exp_f32 v187, v187
    v_exp_f32 v188, v188
    v_exp_f32 v189, v189
    v_exp_f32 v190, v190
    v_exp_f32 v191, v191
    v_exp_f32 v192, v192
    v_exp_f32 v193, v193
    v_exp_f32 v194, v194
    v_exp_f32 v195, v195
    v_cvt_pk_bf16_f32 v180, v180, v181
    v_cvt_pk_bf16_f32 v181, v182, v183
    v_cvt_pk_bf16_f32 v182, v184, v185
    v_cvt_pk_bf16_f32 v183, v186, v187
    v_cvt_pk_bf16_f32 v184, v188, v189
    v_cvt_pk_bf16_f32 v185, v190, v191
    v_cvt_pk_bf16_f32 v186, v192, v193
    v_cvt_pk_bf16_f32 v187, v194, v195
    v_mfma_f32_32x32x16_bf16 v[212:227], a[56:59], v[180:183], v[212:227]
    v_mfma_f32_32x32x16_bf16 v[212:227], a[60:63], v[184:187], v[212:227]
    v_fma_f32 v196, v196, s58, -v236
    v_fma_f32 v197, v197, s58, -v236
    v_fma_f32 v198, v198, s58, -v236
    v_fma_f32 v199, v199, s58, -v236
    v_fma_f32 v200, v200, s58, -v236
    v_fma_f32 v201, v201, s58, -v236
    v_fma_f32 v202, v202, s58, -v236
    v_fma_f32 v203, v203, s58, -v236
    v_fma_f32 v204, v204, s58, -v236
    v_fma_f32 v205, v205, s58, -v236
    v_fma_f32 v206, v206, s58, -v236
    v_fma_f32 v207, v207, s58, -v236
    v_fma_f32 v208, v208, s58, -v236
    v_fma_f32 v209, v209, s58, -v236
    v_fma_f32 v210, v210, s58, -v236
    v_fma_f32 v211, v211, s58, -v236
    v_exp_f32 v196, v196
    v_exp_f32 v197, v197
    v_exp_f32 v198, v198
    v_exp_f32 v199, v199
    v_exp_f32 v200, v200
    v_exp_f32 v201, v201
    v_exp_f32 v202, v202
    v_exp_f32 v203, v203
    v_exp_f32 v204, v204
    v_exp_f32 v205, v205
    v_exp_f32 v206, v206
    v_exp_f32 v207, v207
    v_exp_f32 v208, v208
    v_exp_f32 v209, v209
    v_exp_f32 v210, v210
    v_exp_f32 v211, v211
    v_cvt_pk_bf16_f32 v196, v196, v197
    v_cvt_pk_bf16_f32 v197, v198, v199
    v_cvt_pk_bf16_f32 v198, v200, v201
    v_cvt_pk_bf16_f32 v199, v202, v203
    v_cvt_pk_bf16_f32 v200, v204, v205
    v_cvt_pk_bf16_f32 v201, v206, v207
    v_cvt_pk_bf16_f32 v202, v208, v209
    v_cvt_pk_bf16_f32 v203, v210, v211
    v_mfma_f32_32x32x16_bf16 v[212:227], a[64:67], v[196:199], v[212:227]
    v_mfma_f32_32x32x16_bf16 v[212:227], a[68:71], v[200:203], v[212:227]
    s_nop 11
    v_rcp_f32 v236, v220
    s_nop 0
    v_mul_f32 v236, v236, v23
    v_mul_f32 v212, v212, v236
    v_mul_f32 v213, v213, v236
    v_mul_f32 v214, v214, v236
    v_mul_f32 v215, v215, v236
    v_mul_f32 v216, v216, v236
    v_mul_f32 v217, v217, v236
    v_mul_f32 v218, v218, v236
    v_mul_f32 v219, v219, v236
    v_cvt_pk_bf16_f32 v228, v212, v213
    v_cvt_pk_bf16_f32 v229, v214, v215
    v_cvt_pk_bf16_f32 v230, v216, v217
    v_cvt_pk_bf16_f32 v231, v218, v219
    s_mul_i32 s52, s50, 294912
    s_lshr_b32 s53, s49, 1
    s_lshl_b32 s53, s53, 10
    s_add_u32 s52, s52, s53
    s_and_b32 s53, s49, 1
    s_lshl_b32 s53, s53, 9
    s_add_u32 s52, s52, s53
    s_add_u32 s52, s52, 100663296
    buffer_store_dwordx4 v[228:231], v20, s[28:31], s52 offen sc1
    v_mbcnt_lo_u32_b32 v16, -1, 0
    v_mbcnt_hi_u32_b32 v16, -1, v16
    v_lshrrev_b32 v17, 4, v16
    v_and_b32 v18, 15, v16
    v_lshlrev_b32 v22, 4, v16
    s_lshl_b32 s52, s50, 5
    s_add_u32 s52, s52, s49
    s_lshl_b32 s60, s52, 13
    s_lshl_b32 s61, s52, 12
    s_add_u32 s66, s60, 50331648
    s_add_u32 s67, s60, 50335744
    s_add_u32 s68, s60, 16777216
    s_add_u32 s69, s60, 16781312
    buffer_load_dwordx4 v[32:35], v22, s[28:31], s66 offen offset:0 sc1
    buffer_load_dwordx4 v[64:67], v22, s[28:31], s68 offen offset:0 sc1
    buffer_load_dwordx4 v[36:39], v22, s[28:31], s66 offen offset:1024 sc1
    buffer_load_dwordx4 v[68:71], v22, s[28:31], s68 offen offset:1024 sc1
    buffer_load_dwordx4 v[40:43], v22, s[28:31], s66 offen offset:2048 sc1
    buffer_load_dwordx4 v[72:75], v22, s[28:31], s68 offen offset:2048 sc1
    buffer_load_dwordx4 v[44:47], v22, s[28:31], s66 offen offset:3072 sc1
    buffer_load_dwordx4 v[76:79], v22, s[28:31], s68 offen offset:3072 sc1
    buffer_load_dwordx4 v[48:51], v22, s[28:31], s67 offen offset:0 sc1
    buffer_load_dwordx4 v[80:83], v22, s[28:31], s69 offen offset:0 sc1
    buffer_load_dwordx4 v[52:55], v22, s[28:31], s67 offen offset:1024 sc1
    buffer_load_dwordx4 v[84:87], v22, s[28:31], s69 offen offset:1024 sc1
    buffer_load_dwordx4 v[56:59], v22, s[28:31], s67 offen offset:2048 sc1
    buffer_load_dwordx4 v[88:91], v22, s[28:31], s69 offen offset:2048 sc1
    buffer_load_dwordx4 v[60:63], v22, s[28:31], s67 offen offset:3072 sc1
    buffer_load_dwordx4 v[92:95], v22, s[28:31], s69 offen offset:3072 sc1
    s_add_u32 s66, s60, 33554432
    s_add_u32 s67, s60, 33558528
    s_lshl_b32 s52, s50, 7
    s_add_u32 s52, s52, 655360
    v_lshlrev_b32 v19, 3, v18
    buffer_load_dwordx2 v[24:25], v19, s[28:31], s52 offen sc1
    buffer_load_dwordx4 v[96:99], v22, s[28:31], s66 offen offset:0 sc1
    buffer_load_dwordx4 v[100:103], v22, s[28:31], s66 offen offset:1024 sc1
    buffer_load_dwordx4 v[104:107], v22, s[28:31], s66 offen offset:2048 sc1
    buffer_load_dwordx4 v[108:111], v22, s[28:31], s66 offen offset:3072 sc1
    buffer_load_dwordx4 v[112:115], v22, s[28:31], s67 offen offset:0 sc1
    buffer_load_dwordx4 v[116:119], v22, s[28:31], s67 offen offset:1024 sc1
    buffer_load_dwordx4 v[120:123], v22, s[28:31], s67 offen offset:2048 sc1
    buffer_load_dwordx4 v[124:127], v22, s[28:31], s67 offen offset:3072 sc1
    v_mov_b32 v196, 0x3f803f80
    v_mov_b32 v197, 0x3f803f80
    v_mov_b32 v198, 0x3f803f80
    v_mov_b32 v199, 0x3f803f80
    s_waitcnt vmcnt(9)
    s_lshl_b32 s52, s50, 8
    s_lshl_b32 s53, s49, 2
    s_add_u32 s52, s52, s53
    s_add_u32 s52, s52, 4224
    v_mov_b32 v20, s52
    v_mov_b32 v19, 1
    s_mov_b64 exec, 1
    buffer_store_dword v19, v20, s[28:31], 0 offen sc1
    s_mov_b64 exec, -1
    v_mfma_f32_16x16x32_bf16 v[160:163], v[64:67], v[32:35], 0
    v_mfma_f32_16x16x32_bf16 v[160:163], v[68:71], v[36:39], v[160:163]
    v_mfma_f32_16x16x32_bf16 v[160:163], v[72:75], v[40:43], v[160:163]
    v_mfma_f32_16x16x32_bf16 v[160:163], v[76:79], v[44:47], v[160:163]
    v_mfma_f32_16x16x32_bf16 v[164:167], v[80:83], v[32:35], 0
    v_mfma_f32_16x16x32_bf16 v[164:167], v[84:87], v[36:39], v[164:167]
    v_mfma_f32_16x16x32_bf16 v[164:167], v[88:91], v[40:43], v[164:167]
    v_mfma_f32_16x16x32_bf16 v[164:167], v[92:95], v[44:47], v[164:167]
    v_mfma_f32_16x16x32_bf16 v[172:175], v[64:67], v[48:51], 0
    v_mfma_f32_16x16x32_bf16 v[172:175], v[68:71], v[52:55], v[172:175]
    v_mfma_f32_16x16x32_bf16 v[172:175], v[72:75], v[56:59], v[172:175]
    v_mfma_f32_16x16x32_bf16 v[172:175], v[76:79], v[60:63], v[172:175]
    v_mfma_f32_16x16x32_bf16 v[176:179], v[80:83], v[48:51], 0
    v_mfma_f32_16x16x32_bf16 v[176:179], v[84:87], v[52:55], v[176:179]
    v_mfma_f32_16x16x32_bf16 v[176:179], v[88:91], v[56:59], v[176:179]
    v_mfma_f32_16x16x32_bf16 v[176:179], v[92:95], v[60:63], v[176:179]
    s_cmp_gt_u32 s72, s50
    s_nop 6
    s_cbranch_scc1 cwok_90
    s_lshl_b32 s52, s49, 7
    s_add_u32 s52, s52, 24576
    v_mov_b32 v20, s52
    s_nop 1
cw_89:
    buffer_load_dword v19, v20, s[28:31], 0 offen sc1
    s_waitcnt vmcnt(0)
    v_readfirstlane_b32 s72, v19
    s_nop 0
    s_cmp_gt_u32 s72, s50
    s_nop 2
    s_cbranch_scc1 cwok_90
    s_sub_u32 s79, s79, 1
    s_cbranch_scc1 L_abort
    s_add_u32 s52, s72, 3
    s_cmp_ge_u32 s52, s50
    s_cbranch_scc1 far_91
    s_sleep 32
    s_add_u32 s52, s72, 6
    s_cmp_ge_u32 s52, s50
    s_cbranch_scc1 far_91
    s_sleep 100
far_91:
    s_sleep 1
    s_branch cw_89
cwok_90:
    s_add_u32 s66, s61, 68157440
    s_add_u32 s67, s61, 77594624
    buffer_load_dwordx4 v[128:131], v22, s[28:31], s66 offen offset:0 sc1
    buffer_load_dwordx4 v[132:135], v22, s[28:31], s66 offen offset:1024 sc1
    buffer_load_dwordx4 v[136:139], v22, s[28:31], s66 offen offset:2048 sc1
    buffer_load_dwordx4 v[140:143], v22, s[28:31], s66 offen offset:3072 sc1
    buffer_load_dwordx4 v[144:147], v22, s[28:31], s67 offen offset:0 sc1
    buffer_load_dwordx4 v[148:151], v22, s[28:31], s67 offen offset:1024 sc1
    buffer_load_dwordx4 v[152:155], v22, s[28:31], s67 offen offset:2048 sc1
    buffer_load_dwordx4 v[156:159], v22, s[28:31], s67 offen offset:3072 sc1
    v_lshrrev_b32 v19, 2, v18
    v_sub_u32 v19, v19, v17
    v_lshlrev_b32 v19, 3, v19
    v_and_b32 v21, 3, v18
    v_add_u32 v19, v19, v21
    v_mov_b32 v21, 0xff800000
    v_cmp_gt_i32 vcc, 0, v19
    s_nop 1
    v_cndmask_b32 v160, v160, v21, vcc
    v_cmp_gt_i32 vcc, 1, v19
    s_nop 1
    v_cndmask_b32 v161, v161, v21, vcc
    v_cmp_gt_i32 vcc, 2, v19
    s_nop 1
    v_cndmask_b32 v162, v162, v21, vcc
    v_cmp_gt_i32 vcc, 3, v19
    s_nop 1
    v_cndmask_b32 v163, v163, v21, vcc
    v_cmp_gt_i32 vcc, 4, v19
    s_nop 1
    v_cndmask_b32 v164, v164, v21, vcc
    v_cmp_gt_i32 vcc, 5, v19
    s_nop 1
    v_cndmask_b32 v165, v165, v21, vcc
    v_cmp_gt_i32 vcc, 6, v19
    s_nop 1
    v_cndmask_b32 v166, v166, v21, vcc
    v_cmp_gt_i32 vcc, 7, v19
    s_nop 1
    v_cndmask_b32 v167, v167, v21, vcc
    v_cmp_gt_i32 vcc, -4, v19
    s_nop 1
    v_cndmask_b32 v172, v172, v21, vcc
    v_cmp_gt_i32 vcc, -3, v19
    s_nop 1
    v_cndmask_b32 v173, v173, v21, vcc
    v_cmp_gt_i32 vcc, -2, v19
    s_nop 1
    v_cndmask_b32 v174, v174, v21, vcc
    v_cmp_gt_i32 vcc, -1, v19
    s_nop 1
    v_cndmask_b32 v175, v175, v21, vcc
    v_cmp_gt_i32 vcc, 0, v19
    s_nop 1
    v_cndmask_b32 v176, v176, v21, vcc
    v_cmp_gt_i32 vcc, 1, v19
    s_nop 1
    v_cndmask_b32 v177, v177, v21, vcc
    v_cmp_gt_i32 vcc, 2, v19
    s_nop 1
    v_cndmask_b32 v178, v178, v21, vcc
    v_cmp_gt_i32 vcc, 3, v19
    s_nop 1
    v_cndmask_b32 v179, v179, v21, vcc
    s_waitcnt vmcnt(4)
    v_mfma_f32_16x16x32_bf16 v[168:171], v[128:131], v[32:35], 0
    v_mfma_f32_16x16x32_bf16 v[168:171], v[132:135], v[36:39], v[168:171]
    v_mfma_f32_16x16x32_bf16 v[168:171], v[136:139], v[40:43], v[168:171]
    v_mfma_f32_16x16x32_bf16 v[168:171], v[140:143], v[44:47], v[168:171]
    v_mfma_f32_16x16x32_bf16 v[180:183], v[128:131], v[48:51], 0
    v_mfma_f32_16x16x32_bf16 v[180:183], v[132:135], v[52:55], v[180:183]
    v_mfma_f32_16x16x32_bf16 v[180:183], v[136:139], v[56:59], v[180:183]
    v_mfma_f32_16x16x32_bf16 v[180:183], v[140:143], v[60:63], v[180:183]
    v_max3_f32 v220, v160, v161, v162
    v_max3_f32 v220, v220, v163, v164
    v_max3_f32 v220, v220, v165, v166
    v_max3_f32 v220, v220, v167, v168
    v_max_f32 v220, v220, v169
    v_mov_b32 v221, v220
    s_nop 1
    v_permlane32_swap_b32 v221, v220
    v_max_f32 v220, v220, v221
    v_mov_b32 v221, v220
    s_nop 1
    v_permlane16_swap_b32 v221, v220
    v_max_f32 v220, v220, v221
    v_mul_f32 v220, s56, v220
    v_fma_f32 v160, v160, s56, -v220
    v_fma_f32 v161, v161, s56, -v220
    v_fma_f32 v162, v162, s56, -v220
    v_fma_f32 v163, v163, s56, -v220
    v_fma_f32 v164, v164, s56, -v220
    v_fma_f32 v165, v165, s56, -v220
    v_fma_f32 v166, v166, s56, -v220
    v_fma_f32 v167, v167, s56, -v220
    v_fma_f32 v168, v168, s56, -v220
    v_fma_f32 v169, v169, s56, -v220
    v_exp_f32 v160, v160
    v_exp_f32 v161, v161
    v_exp_f32 v162, v162
    v_exp_f32 v163, v163
    v_exp_f32 v164, v164
    v_exp_f32 v165, v165
    v_exp_f32 v166, v166
    v_exp_f32 v167, v167
    v_exp_f32 v168, v168
    v_exp_f32 v169, v169
    v_cvt_pk_bf16_f32 v184, v160, v161
    v_cvt_pk_bf16_f32 v185, v162, v163
    v_cvt_pk_bf16_f32 v186, v164, v165
    v_cvt_pk_bf16_f32 v187, v166, v167
    v_cvt_pk_bf16_f32 v192, v168, v169
    v_mov_b32 v193, 0
    v_mfma_f32_16x16x32_bf16 v[200:203], v[196:199], v[184:187], 0
    s_nop 5
    v_mfma_f32_16x16x16_bf16 v[200:203], v[196:197], v[192:193], v[200:203]
    v_max3_f32 v220, v172, v173, v174
    v_max3_f32 v220, v220, v175, v176
    v_max3_f32 v220, v220, v177, v178
    v_max3_f32 v220, v220, v179, v180
    v_max_f32 v220, v220, v181
    v_mov_b32 v221, v220
    s_nop 1
    v_permlane32_swap_b32 v221, v220
    v_max_f32 v220, v220, v221
    v_mov_b32 v221, v220
    s_nop 1
    v_permlane16_swap_b32 v221, v220
    v_max_f32 v220, v220, v221
    v_mul_f32 v220, s56, v220
    v_fma_f32 v172, v172, s56, -v220
    v_fma_f32 v173, v173, s56, -v220
    v_fma_f32 v174, v174, s56, -v220
    v_fma_f32 v175, v175, s56, -v220
    v_fma_f32 v176, v176, s56, -v220
    v_fma_f32 v177, v177, s56, -v220
    v_fma_f32 v178, v178, s56, -v220
    v_fma_f32 v179, v179, s56, -v220
    v_fma_f32 v180, v180, s56, -v220
    v_fma_f32 v181, v181, s56, -v220
    v_exp_f32 v172, v172
    v_exp_f32 v173, v173
    v_exp_f32 v174, v174
    v_exp_f32 v175, v175
    v_exp_f32 v176, v176
    v_exp_f32 v177, v177
    v_exp_f32 v178, v178
    v_exp_f32 v179, v179
    v_exp_f32 v180, v180
    v_exp_f32 v181, v181
    v_cvt_pk_bf16_f32 v188, v172, v173
    v_cvt_pk_bf16_f32 v189, v174, v175
    v_cvt_pk_bf16_f32 v190, v176, v177
    v_cvt_pk_bf16_f32 v191, v178, v179
    v_cvt_pk_bf16_f32 v194, v180, v181
    v_mov_b32 v195, 0
    v_mfma_f32_16x16x32_bf16 v[204:207], v[196:199], v[188:191], 0
    s_nop 5
    v_mfma_f32_16x16x16_bf16 v[204:207], v[196:197], v[194:195], v[204:207]
    s_waitcnt vmcnt(0)
    v_rcp_f32 v200, v200
    v_sub_f32 v24, 1.0, v24
    v_mul_f32 v200, v200, v24
    s_nop 3
    v_rcp_f32 v204, v204
    v_sub_f32 v25, 1.0, v25
    v_mul_f32 v204, v204, v25
    s_mul_i32 s52, s50, 294912
    s_lshl_b32 s53, s49, 12
    s_add_u32 s52, s52, s53
    s_add_u32 s66, s52, 100679680
    s_add_u32 s67, s52, 100827136
    v_mfma_f32_16x16x32_bf16 v[32:35], v[96:99], v[184:187], 0
    v_mfma_f32_16x16x32_bf16 v[36:39], v[100:103], v[184:187], 0
    v_mfma_f32_16x16x16_bf16 v[32:35], v[144:145], v[192:193], v[32:35]
    v_mfma_f32_16x16x16_bf16 v[36:39], v[146:147], v[192:193], v[36:39]
    s_nop 3
    v_mul_f32 v32, v32, v200
    v_mul_f32 v33, v33, v200
    v_mul_f32 v34, v34, v200
    v_mul_f32 v35, v35, v200
    v_mul_f32 v36, v36, v200
    v_mul_f32 v37, v37, v200
    v_mul_f32 v38, v38, v200
    v_mul_f32 v39, v39, v200
    v_cvt_pk_bf16_f32 v40, v32, v33
    v_cvt_pk_bf16_f32 v41, v34, v35
    v_cvt_pk_bf16_f32 v42, v36, v37
    v_cvt_pk_bf16_f32 v43, v38, v39
    buffer_store_dwordx4 v[40:43], v22, s[28:31], s66 offen offset:0 sc1
    v_mfma_f32_16x16x32_bf16 v[44:47], v[104:107], v[184:187], 0
    v_mfma_f32_16x16x32_bf16 v[48:51], v[108:111], v[184:187], 0
    v_mfma_f32_16x16x16_bf16 v[44:47], v[148:149], v[192:193], v[44:47]
    v_mfma_f32_16x16x16_bf16 v[48:51], v[150:151], v[192:193], v[48:51]
    s_nop 3
    v_mul_f32 v44, v44, v200
    v_mul_f32 v45, v45, v200
    v_mul_f32 v46, v46, v200
    v_mul_f32 v47, v47, v200
    v_mul_f32 v48, v48, v200
    v_mul_f32 v49, v49, v200
    v_mul_f32 v50, v50, v200
    v_mul_f32 v51, v51, v200
    v_cvt_pk_bf16_f32 v52, v44, v45
    v_cvt_pk_bf16_f32 v53, v46, v47
    v_cvt_pk_bf16_f32 v54, v48, v49
    v_cvt_pk_bf16_f32 v55, v50, v51
    buffer_store_dwordx4 v[52:55], v22, s[28:31], s66 offen offset:1024 sc1
    v_mfma_f32_16x16x32_bf16 v[56:59], v[112:115], v[184:187], 0
    v_mfma_f32_16x16x32_bf16 v[60:63], v[116:119], v[184:187], 0
    v_mfma_f32_16x16x16_bf16 v[56:59], v[152:153], v[192:193], v[56:59]
    v_mfma_f32_16x16x16_bf16 v[60:63], v[154:155], v[192:193], v[60:63]
    s_nop 3
    v_mul_f32 v56, v56, v200
    v_mul_f32 v57, v57, v200
    v_mul_f32 v58, v58, v200
    v_mul_f32 v59, v59, v200
    v_mul_f32 v60, v60, v200
    v_mul_f32 v61, v61, v200
    v_mul_f32 v62, v62, v200
    v_mul_f32 v63, v63, v200
    v_cvt_pk_bf16_f32 v64, v56, v57
    v_cvt_pk_bf16_f32 v65, v58, v59
    v_cvt_pk_bf16_f32 v66, v60, v61
    v_cvt_pk_bf16_f32 v67, v62, v63
    buffer_store_dwordx4 v[64:67], v22, s[28:31], s66 offen offset:2048 sc1
    v_mfma_f32_16x16x32_bf16 v[68:71], v[120:123], v[184:187], 0
    v_mfma_f32_16x16x32_bf16 v[72:75], v[124:127], v[184:187], 0
    v_mfma_f32_16x16x16_bf16 v[68:71], v[156:157], v[192:193], v[68:71]
    v_mfma_f32_16x16x16_bf16 v[72:75], v[158:159], v[192:193], v[72:75]
    s_nop 3
    v_mul_f32 v68, v68, v200
    v_mul_f32 v69, v69, v200
    v_mul_f32 v70, v70, v200
    v_mul_f32 v71, v71, v200
    v_mul_f32 v72, v72, v200
    v_mul_f32 v73, v73, v200
    v_mul_f32 v74, v74, v200
    v_mul_f32 v75, v75, v200
    v_cvt_pk_bf16_f32 v76, v68, v69
    v_cvt_pk_bf16_f32 v77, v70, v71
    v_cvt_pk_bf16_f32 v78, v72, v73
    v_cvt_pk_bf16_f32 v79, v74, v75
    buffer_store_dwordx4 v[76:79], v22, s[28:31], s66 offen offset:3072 sc1
    v_mfma_f32_16x16x32_bf16 v[32:35], v[96:99], v[188:191], 0
    v_mfma_f32_16x16x32_bf16 v[36:39], v[100:103], v[188:191], 0
    v_mfma_f32_16x16x16_bf16 v[32:35], v[144:145], v[194:195], v[32:35]
    v_mfma_f32_16x16x16_bf16 v[36:39], v[146:147], v[194:195], v[36:39]
    s_nop 3
    v_mul_f32 v32, v32, v204
    v_mul_f32 v33, v33, v204
    v_mul_f32 v34, v34, v204
    v_mul_f32 v35, v35, v204
    v_mul_f32 v36, v36, v204
    v_mul_f32 v37, v37, v204
    v_mul_f32 v38, v38, v204
    v_mul_f32 v39, v39, v204
    v_cvt_pk_bf16_f32 v40, v32, v33
    v_cvt_pk_bf16_f32 v41, v34, v35
    v_cvt_pk_bf16_f32 v42, v36, v37
    v_cvt_pk_bf16_f32 v43, v38, v39
    buffer_store_dwordx4 v[40:43], v22, s[28:31], s67 offen offset:0 sc1
    v_mfma_f32_16x16x32_bf16 v[44:47], v[104:107], v[188:191], 0
    v_mfma_f32_16x16x32_bf16 v[48:51], v[108:111], v[188:191], 0
    v_mfma_f32_16x16x16_bf16 v[44:47], v[148:149], v[194:195], v[44:47]
    v_mfma_f32_16x16x16_bf16 v[48:51], v[150:151], v[194:195], v[48:51]
    s_nop 3
    v_mul_f32 v44, v44, v204
    v_mul_f32 v45, v45, v204
    v_mul_f32 v46, v46, v204
    v_mul_f32 v47, v47, v204
    v_mul_f32 v48, v48, v204
    v_mul_f32 v49, v49, v204
    v_mul_f32 v50, v50, v204
    v_mul_f32 v51, v51, v204
    v_cvt_pk_bf16_f32 v52, v44, v45
    v_cvt_pk_bf16_f32 v53, v46, v47
    v_cvt_pk_bf16_f32 v54, v48, v49
    v_cvt_pk_bf16_f32 v55, v50, v51
    buffer_store_dwordx4 v[52:55], v22, s[28:31], s67 offen offset:1024 sc1
    v_mfma_f32_16x16x32_bf16 v[56:59], v[112:115], v[188:191], 0
    v_mfma_f32_16x16x32_bf16 v[60:63], v[116:119], v[188:191], 0
    v_mfma_f32_16x16x16_bf16 v[56:59], v[152:153], v[194:195], v[56:59]
    v_mfma_f32_16x16x16_bf16 v[60:63], v[154:155], v[194:195], v[60:63]
    s_nop 3
    v_mul_f32 v56, v56, v204
    v_mul_f32 v57, v57, v204
    v_mul_f32 v58, v58, v204
    v_mul_f32 v59, v59, v204
    v_mul_f32 v60, v60, v204
    v_mul_f32 v61, v61, v204
    v_mul_f32 v62, v62, v204
    v_mul_f32 v63, v63, v204
    v_cvt_pk_bf16_f32 v64, v56, v57
    v_cvt_pk_bf16_f32 v65, v58, v59
    v_cvt_pk_bf16_f32 v66, v60, v61
    v_cvt_pk_bf16_f32 v67, v62, v63
    buffer_store_dwordx4 v[64:67], v22, s[28:31], s67 offen offset:2048 sc1
    v_mfma_f32_16x16x32_bf16 v[68:71], v[120:123], v[188:191], 0
    v_mfma_f32_16x16x32_bf16 v[72:75], v[124:127], v[188:191], 0
    v_mfma_f32_16x16x16_bf16 v[68:71], v[156:157], v[194:195], v[68:71]
    v_mfma_f32_16x16x16_bf16 v[72:75], v[158:159], v[194:195], v[72:75]
    s_nop 3
    v_mul_f32 v68, v68, v204
    v_mul_f32 v69, v69, v204
    v_mul_f32 v70, v70, v204
    v_mul_f32 v71, v71, v204
    v_mul_f32 v72, v72, v204
    v_mul_f32 v73, v73, v204
    v_mul_f32 v74, v74, v204
    v_mul_f32 v75, v75, v204
    v_cvt_pk_bf16_f32 v76, v68, v69
    v_cvt_pk_bf16_f32 v77, v70, v71
    v_cvt_pk_bf16_f32 v78, v72, v73
    v_cvt_pk_bf16_f32 v79, v74, v75
    buffer_store_dwordx4 v[76:79], v22, s[28:31], s67 offen offset:3072 sc1
    s_waitcnt vmcnt(0)
    s_lshl_b32 s52, s50, 8
    s_lshl_b32 s53, s49, 2
    s_add_u32 s52, s52, s53
    s_add_u32 s52, s52, 4096
    v_mov_b32 v20, s52
    v_mov_b32 v19, 1
    s_mov_b64 exec, 1
    buffer_store_dword v19, v20, s[28:31], 0 offen sc1
    s_mov_b64 exec, -1
    s_add_u32 s50, s50, 14
    s_cmp_lt_u32 s50, 64
    s_cbranch_scc1 L_at_loop
    s_branch L_end
L_claimfail:
    s_waitcnt vmcnt(0)
L_claimloop:
    s_and_b32 s52, s2, 31
    s_lshr_b32 s53, s100, s52
    s_sub_u32 s54, 32, s52
    s_and_b32 s54, s54, 31
    s_lshl_b32 s54, s100, s54
    s_or_b32 s53, s53, s54
    s_ff0_i32_b32 s49, s53
    s_cmp_lt_i32 s49, 0
    s_cbranch_scc1 L_worker2
    s_add_u32 s49, s49, s52
    s_and_b32 s49, s49, 31
    s_lshl_b32 s71, 1, s49
    s_barrier
    s_cmp_lg_u32 s48, 0
    s_cbranch_scc1 at_92
    v_mov_b32 v16, s71
    v_mov_b32 v17, 0
    s_mov_b64 exec, 1
    buffer_atomic_or v16, v17, s[40:43], 0 offen sc0
    s_waitcnt vmcnt(0)
    v_mov_b32 v17, 163328
    ds_write_b32 v17, v16
    s_mov_b64 exec, -1
    s_waitcnt lgkmcnt(0)
at_92:
    s_barrier
    v_mov_b32 v17, 163328
    ds_read_b32 v16, v17
    s_waitcnt lgkmcnt(0)
    v_readfirstlane_b32 s100, v16
    s_nop 0
    s_and_b32 s52, s100, s71
    s_nop 2
    s_cbranch_scc0 L_claim
    s_branch L_claimloop
L_abort:
L_end:
    s_endpgm
L_codeend:
.section .rodata,"a"
.p2align 6
.amdhsa_kernel gated_mix__sliding_block__memory_aug_recurrent_mem_tr__prompt_kernel
  .amdhsa_next_free_vgpr 512
  .amdhsa_next_free_sgpr 102
  .amdhsa_accum_offset 256
  .amdhsa_group_segment_fixed_size 0
  .amdhsa_kernarg_size 112
  .amdhsa_user_sgpr_count 2
  .amdhsa_user_sgpr_kernarg_segment_ptr 1
  .amdhsa_system_sgpr_workgroup_id_x 1
.end_amdhsa_kernel
```
